```python
import torch

def _softmax(x, axis=-1):
    return torch.softmax(x, dim=axis)

def _gelu(x):
    return torch.nn.functional.gelu(x, approximate='tanh')

def _silu(x):
    return torch.nn.functional.silu(x)

def _sigmoid(x):
    return torch.sigmoid(x)

def _layernorm(x, axis=-1, eps=1e-05):
    m = x.mean(dim=axis, keepdim=True)
    v = x.var(dim=axis, keepdim=True, unbiased=False)
    return (x - m) / torch.sqrt(v + eps)

def _scatter_add(tgt, idx, src, axis=0):
    return tgt.clone().index_add_(axis, idx, src)

def _segment_sum(src, seg, n):
    out = torch.zeros((n,) + src.shape[1:], dtype=src.dtype)
    return out.index_add_(0, seg, src)

def _pad(x, pw):
    flat = tuple((v for pair in reversed(pw) for v in pair))
    return torch.nn.functional.pad(x, flat)
kernel_name = 'adaLN_cond__ssm_conv_s4d__dense_activation_relu__prompt'

def setup_inputs():

    _w = lambda a: (lambda t: t.to(torch.bfloat16) if t.is_floating_point() else t)(torch.as_tensor(a))

    def _A_setup():
        Bsz, L, D, N = (1, 2048, 576, 128)
        return {'u': _w((lambda *s: torch.randn(*s, dtype=torch.bfloat16) * 0.05)(Bsz, L, D)), 'log_A_real': _w((lambda *s: torch.randn(*s, dtype=torch.bfloat16) * 3.2)(D, N) * 0.5), 'A_imag': _w((lambda *s: torch.randn(*s, dtype=torch.bfloat16) * 0.1)(D, N) * 3.14), 'C_real': _w((lambda *s: torch.randn(*s, dtype=torch.bfloat16) * 0.8)(D, N) / N ** 0.5), 'C_imag': _w((lambda *s: torch.randn(*s, dtype=torch.bfloat16) * 0.8)(D, N) / N ** 0.5), 'log_dt': _w((lambda *s: torch.randn(*s, dtype=torch.bfloat16) * 0.1)(D) * 0.5 - 4.0), 'D_skip': _w((lambda *s: torch.randn(*s, dtype=torch.bfloat16) * 0.1)(D))}
    _A_in = _A_setup()

    def _B_setup():
        B, S, D, Dff = (1, 2048, 576, 4608)
        return {'x': _w((lambda *s: torch.randn(*s, dtype=torch.bfloat16) * 0.05)(B, S, D)), 'w1': _w((lambda *s: torch.randn(*s, dtype=torch.bfloat16) * 0.05)(D, Dff)), 'w2': _w((lambda *s: torch.randn(*s, dtype=torch.bfloat16) * 0.05)(Dff, D))}
    _B_in = _B_setup()
    return {'A_u': _A_in['u'], 'A_log_A_real': _A_in['log_A_real'], 'A_A_imag': _A_in['A_imag'], 'A_C_real': _A_in['C_real'], 'A_C_imag': _A_in['C_imag'], 'A_log_dt': _A_in['log_dt'], 'A_D_skip': _A_in['D_skip'], 'B_x': _B_in['x'], 'B_w1': _B_in['w1'], 'B_w2': _B_in['w2'], 'c': _w((lambda *s: torch.randn(*s, dtype=torch.bfloat16) * 0.2)(1, 576) * 8.0), 'w_mod': _w((lambda *s: torch.randn(*s, dtype=torch.bfloat16) * 0.2)(576, 6 * 576) * 576 ** (-0.5) * 8.0)}

def reference(A_u, A_log_A_real, A_A_imag, A_C_real, A_C_imag, A_log_dt, A_D_skip, B_x, B_w1, B_w2, c, w_mod):

    def _A_ref(u, log_A_real, A_imag, C_real, C_imag, log_dt, D_skip):
        L = u.shape[1]
        dt = torch.exp(log_dt)
        A = -torch.exp(log_A_real) + 1j * A_imag
        C = (C_real + 1j * C_imag) * dt[:, None]
        pos = (lambda x, dt: x.to(dt))(torch.arange(L), log_dt.dtype)
        P = torch.exp((A * dt[:, None])[:, :, None] * pos[None, None, :])
        K = 2.0 * torch.einsum('dn,dnl->dl', C, P).real
        L2 = 2 * L
        u_t = (lambda x, *d: x.permute(*d))(u, 0, 2, 1)
        Kf = (lambda x, *a, **k: torch.fft.rfft(x.float(), *a, **k))(K, L2)
        Uf = (lambda x, *a, **k: torch.fft.rfft(x.float(), *a, **k))(u_t, L2)
        y = (lambda x, *a, **k: torch.fft.irfft(x, *a, **k).to(torch.bfloat16))(Uf * Kf[None, :, :], L2)[:, :, :L]
        y = (lambda x, *d: x.permute(*d))(y, 0, 2, 1)
        return y + u * D_skip[None, None, :]

    def _B_ref(x, w1, w2):
        h = torch.einsum('bsd,df->bsf', x, w1)
        zero = torch.zeros_like(h)
        h = torch.maximum(h, zero)
        return torch.einsum('bsf,fd->bsd', h, w2)
    x = A_u
    mod = (_silu(c) @ w_mod).reshape(c.shape[0], 6, 1, -1)
    sa, ca, ga, sb, cb, gb = (mod[:, 0].clone(), mod[:, 1].clone(), mod[:, 2].clone(), mod[:, 3].clone(), mod[:, 4].clone(), mod[:, 5].clone())
    h = _layernorm(x, axis=-1) * (1 + ca) + sa
    x = x + ga * _A_ref(h, A_log_A_real, A_A_imag, A_C_real, A_C_imag, A_log_dt, A_D_skip)
    h = _layernorm(x, axis=-1) * (1 + cb) + sb
    x = x + gb * _B_ref(h, B_w1, B_w2)
    return x
```

```asm
; @launch kernel=ka_kernel grid=(252,1,1) block=(512,1,1) lds=104704
; @launch kernel=kb_kernel grid=(256,1,1) block=(256,1,1) lds=149504
.amdgcn_target "amdgcn-amd-amdhsa--gfx950"
.text
.globl ka_kernel
.p2align 8
.type ka_kernel,@function
ka_kernel:
    s_cmp_ge_u32 s2, 252
    s_cbranch_scc1 KA_done
    s_load_dwordx16 s[16:31], s[0:1], 0
    s_load_dwordx8 s[32:39], s[0:1], 64
    s_load_dwordx4 s[40:43], s[0:1], 104
    v_mov_b32 v253, v0
    v_lshrrev_b32 v1, 6, v0
    v_and_b32 v0, 63, v0
    s_nop 0
    v_readfirstlane_b32 s6, v1
    s_cmp_ge_u32 s2, 108
    s_cbranch_scc1 KA_cv
    s_cmp_gt_u32 s6, 3
    s_cbranch_scc1 KA_svc
    s_cmp_lt_u32 s6, 3
    s_cbranch_scc1 KA_st2
    s_getpc_b64 s[8:9]
KA_pc:
    s_mov_b32 s10, CODE_END-KA_pc
    s_mov_b32 s11, 0x20000
    s_lshr_b32 s3, s2, 3
    s_lshl_b32 s3, s3, 12
    v_lshl_add_u32 v1, v0, 6, s3
    buffer_load_dword v255, v1, s[8:11], 0 offen
    s_endpgm
KA_cv:
    s_sub_u32 s48, s2, 108
    s_and_b32 s49, s48, 7
    s_mul_i32 s49, s49, 18
    s_lshr_b32 s48, s48, 3
    s_add_u32 s48, s48, s49
    s_cmp_ge_u32 s6, 4
    s_cbranch_scc1 KA_help
    s_lshl_b32 s49, s48, 2
    s_add_u32 s49, s49, s6
    s_lshl_b32 s50, s49, 8
    v_lshl_add_u32 v1, v0, 2, s50
    s_lshl_b32 s50, s49, 1
    v_mov_b32 v2, s50
    s_waitcnt lgkmcnt(0)
    global_load_dword v3, v1, s[18:19] nt
    global_load_dword v4, v1, s[20:21] nt
    global_load_dword v6, v1, s[22:23] nt
    global_load_dword v7, v1, s[24:25] nt
    global_load_ushort v5, v2, s[26:27]
    global_load_ushort v194, v2, s[28:29]
    s_add_u32 s12, s42, 0
    s_addc_u32 s13, s43, 0
    s_mov_b32 s14, 268435456
    s_mov_b32 s15, 0x20000
    s_add_u32 s44, s40, 0
    s_addc_u32 s45, s41, 0
    s_mov_b32 s46, 256
    s_mov_b32 s47, 0x20000
    s_mul_i32 s34, s6, 17408
    s_mov_b32 m0, s34
    s_mul_i32 s33, s6, 8704
    s_add_u32 s33, s33, 69632
    v_and_b32 v9, 31, v0
    v_mul_u32_u24 v9, 272, v9
    v_lshrrev_b32 v10, 5, v0
    v_lshl_add_u32 v9, v10, 4, v9
    v_add_u32 v9, s34, v9
    s_mov_b32 s35, 1069066811
    s_mov_b32 s36, 1042479491
    v_mov_b32 v112, 0
    v_mov_b32 v113, 0
    v_lshl_add_u32 v11, v0, 3, s33
    ds_write_b64 v11, v[112:113]
    s_waitcnt vmcnt(0)
    v_and_b32 v190, 0xffff0000, v3
    v_lshlrev_b32 v3, 16, v3
    v_and_b32 v191, 0xffff0000, v4
    v_lshlrev_b32 v4, 16, v4
    v_and_b32 v192, 0xffff0000, v6
    v_lshlrev_b32 v6, 16, v6
    v_and_b32 v193, 0xffff0000, v7
    v_lshlrev_b32 v7, 16, v7
    v_lshlrev_b32 v5, 16, v5
    v_mul_f32 v3, s35, v3
    v_mul_f32 v190, s35, v190
    v_mul_f32 v5, s35, v5
    v_exp_f32 v3, v3
    v_exp_f32 v190, v190
    v_exp_f32 v5, v5
    v_max_f32 v11, abs(v6), abs(v7)
    v_max3_f32 v11, abs(v192), abs(v193), v11
    v_cvt_pk_bf16_f32 v3, v3, v3
    v_lshlrev_b32 v3, 16, v3
    v_cvt_pk_bf16_f32 v190, v190, v190
    v_lshlrev_b32 v190, 16, v190
    v_cvt_pk_bf16_f32 v5, v5, v5
    v_lshlrev_b32 v5, 16, v5
    v_mul_f32 v3, v3, v5
    v_mul_f32 v4, v4, v5
    v_mul_f32 v3, s35, v3
    v_mul_f32 v4, s36, v4
    v_mul_f32 v190, v190, v5
    v_mul_f32 v191, v191, v5
    v_mul_f32 v190, s35, v190
    v_mul_f32 v191, s36, v191
    s_nop 1
    v_max_f32_dpp v11, v11, v11 row_ror:8 row_mask:0xf bank_mask:0xf
    s_nop 1
    v_max_f32_dpp v11, v11, v11 row_ror:4 row_mask:0xf bank_mask:0xf
    s_nop 1
    v_max_f32_dpp v11, v11, v11 row_ror:2 row_mask:0xf bank_mask:0xf
    s_nop 1
    v_max_f32_dpp v11, v11, v11 row_ror:1 row_mask:0xf bank_mask:0xf
    s_nop 0
    v_readlane_b32 s37, v11, 0
    v_readlane_b32 s38, v11, 16
    v_readlane_b32 s39, v11, 32
    v_readlane_b32 s21, v11, 48
    s_max_u32 s37, s37, s38
    s_max_u32 s39, s39, s21
    s_max_u32 s37, s37, s39
    v_frexp_exp_i32_f32 v11, s37
    v_sub_u32 v20, 0, v11
    v_ldexp_f32 v6, v6, v20
    v_ldexp_f32 v7, v7, v20
    v_ldexp_f32 v192, v192, v20
    v_ldexp_f32 v193, v193, v20
    v_add_f32 v5, v5, v5
    v_ldexp_f32 v5, v5, v11
    v_mul_f32 v20, 1.0, v3
    v_mul_f32 v21, 1.0, v4
    v_mul_f32 v22, 8.0, v3
    v_mul_f32 v23, 8.0, v4
    v_mul_f32 v24, 256.0, v3
    v_mul_f32 v25, 256.0, v4
    v_mul_f32 v26, 16.0, v3
    v_mul_f32 v27, 16.0, v4
    v_exp_f32 v20, -v20
    v_fract_f32 v21, v21
    v_exp_f32 v22, -v22
    v_fract_f32 v23, v23
    v_exp_f32 v24, -v24
    v_fract_f32 v25, v25
    v_exp_f32 v26, -v26
    v_fract_f32 v27, v27
    v_cos_f32 v12, v21
    v_sin_f32 v13, v21
    v_cos_f32 v14, v23
    v_sin_f32 v15, v23
    v_cos_f32 v16, v25
    v_sin_f32 v17, v25
    v_cos_f32 v18, v27
    v_sin_f32 v19, v27
    v_mul_f32 v12, v20, v12
    v_mul_f32 v13, v20, v13
    v_mul_f32 v14, v22, v14
    v_mul_f32 v15, v22, v15
    v_mul_f32 v16, v24, v16
    v_mul_f32 v17, v24, v17
    v_mul_f32 v18, v26, v18
    v_mul_f32 v19, v26, v19
    v_pk_mul_f32 v[22:23], v[12:13], v[12:13] op_sel:[0,0] op_sel_hi:[1,0]
    v_pk_fma_f32 v[22:23], v[12:13], v[12:13], v[22:23] op_sel:[1,1,0] op_sel_hi:[0,1,1] neg_lo:[1,0,0]
    v_pk_mul_f32 v[24:25], v[22:23], v[22:23] op_sel:[0,0] op_sel_hi:[1,0]
    v_pk_fma_f32 v[24:25], v[22:23], v[22:23], v[24:25] op_sel:[1,1,0] op_sel_hi:[0,1,1] neg_lo:[1,0,0]
    v_mov_b32 v90, 1.0
    v_mov_b32 v91, 0
    v_mov_b32 v94, v14
    v_mov_b32 v95, v15
    v_cvt_pk_f16_f32 v104, v90, v91
    v_cvt_pk_f16_f32 v100, v6, -v7
    ds_write_addtid_b32 v104 offset:8704
    ds_write_addtid_b32 v100 offset:0
    ds_write_addtid_b32 v100 offset:2992
    ds_write_addtid_b32 v100 offset:4080
    v_cvt_pk_f16_f32 v105, v94, v95
    v_pk_mul_f32 v[30:31], v[6:7], v[12:13] op_sel:[0,0] op_sel_hi:[1,0]
    ds_write_addtid_b32 v105 offset:8976
    v_pk_fma_f32 v[30:31], v[6:7], v[12:13], v[30:31] op_sel:[1,1,0] op_sel_hi:[0,1,1] neg_lo:[1,0,0]
    v_cvt_pk_f16_f32 v101, v30, -v31
    ds_write_addtid_b32 v101 offset:272
    v_pk_mul_f32 v[92:93], v[90:91], v[18:19] op_sel:[0,0] op_sel_hi:[1,0]
    v_pk_mul_f32 v[32:33], v[6:7], v[16:17] op_sel:[0,0] op_sel_hi:[1,0]
    v_pk_fma_f32 v[92:93], v[90:91], v[18:19], v[92:93] op_sel:[1,1,0] op_sel_hi:[0,1,1] neg_lo:[1,0,0]
    v_pk_fma_f32 v[32:33], v[6:7], v[16:17], v[32:33] op_sel:[1,1,0] op_sel_hi:[0,1,1] neg_lo:[1,0,0]
    v_cvt_pk_f16_f32 v106, v92, v93
    v_cvt_pk_f16_f32 v102, v32, -v33
    ds_write_addtid_b32 v106 offset:9248
    ds_write_addtid_b32 v102 offset:2176
    v_pk_mul_f32 v[96:97], v[94:95], v[18:19] op_sel:[0,0] op_sel_hi:[1,0]
    v_pk_mul_f32 v[34:35], v[30:31], v[12:13] op_sel:[0,0] op_sel_hi:[1,0]
    v_pk_fma_f32 v[96:97], v[94:95], v[18:19], v[96:97] op_sel:[1,1,0] op_sel_hi:[0,1,1] neg_lo:[1,0,0]
    v_pk_fma_f32 v[34:35], v[30:31], v[12:13], v[34:35] op_sel:[1,1,0] op_sel_hi:[0,1,1] neg_lo:[1,0,0]
    v_cvt_pk_f16_f32 v107, v96, v97
    v_cvt_pk_f16_f32 v103, v34, -v35
    ds_write_addtid_b32 v107 offset:9520
    ds_write_addtid_b32 v103 offset:544
    v_pk_mul_f32 v[90:91], v[92:93], v[18:19] op_sel:[0,0] op_sel_hi:[1,0]
    v_pk_mul_f32 v[36:37], v[32:33], v[16:17] op_sel:[0,0] op_sel_hi:[1,0]
    v_pk_fma_f32 v[90:91], v[92:93], v[18:19], v[90:91] op_sel:[1,1,0] op_sel_hi:[0,1,1] neg_lo:[1,0,0]
    v_pk_fma_f32 v[36:37], v[32:33], v[16:17], v[36:37] op_sel:[1,1,0] op_sel_hi:[0,1,1] neg_lo:[1,0,0]
    v_cvt_pk_f16_f32 v104, v90, v91
    v_cvt_pk_f16_f32 v100, v36, -v37
    ds_write_addtid_b32 v104 offset:9792
    ds_write_addtid_b32 v100 offset:4352
    v_pk_mul_f32 v[94:95], v[96:97], v[18:19] op_sel:[0,0] op_sel_hi:[1,0]
    v_pk_mul_f32 v[38:39], v[34:35], v[12:13] op_sel:[0,0] op_sel_hi:[1,0]
    v_pk_fma_f32 v[94:95], v[96:97], v[18:19], v[94:95] op_sel:[1,1,0] op_sel_hi:[0,1,1] neg_lo:[1,0,0]
    v_pk_fma_f32 v[38:39], v[34:35], v[12:13], v[38:39] op_sel:[1,1,0] op_sel_hi:[0,1,1] neg_lo:[1,0,0]
    v_cvt_pk_f16_f32 v105, v94, v95
    v_cvt_pk_f16_f32 v101, v38, -v39
    ds_write_addtid_b32 v105 offset:10064
    ds_write_addtid_b32 v101 offset:816
    v_pk_mul_f32 v[92:93], v[90:91], v[18:19] op_sel:[0,0] op_sel_hi:[1,0]
    v_pk_mul_f32 v[40:41], v[36:37], v[16:17] op_sel:[0,0] op_sel_hi:[1,0]
    v_pk_fma_f32 v[92:93], v[90:91], v[18:19], v[92:93] op_sel:[1,1,0] op_sel_hi:[0,1,1] neg_lo:[1,0,0]
    v_pk_fma_f32 v[40:41], v[36:37], v[16:17], v[40:41] op_sel:[1,1,0] op_sel_hi:[0,1,1] neg_lo:[1,0,0]
    v_cvt_pk_f16_f32 v106, v92, v93
    v_cvt_pk_f16_f32 v102, v40, -v41
    ds_write_addtid_b32 v106 offset:10336
    ds_write_addtid_b32 v102 offset:4896
    v_pk_mul_f32 v[96:97], v[94:95], v[18:19] op_sel:[0,0] op_sel_hi:[1,0]
    v_pk_mul_f32 v[42:43], v[38:39], v[12:13] op_sel:[0,0] op_sel_hi:[1,0]
    v_pk_fma_f32 v[96:97], v[94:95], v[18:19], v[96:97] op_sel:[1,1,0] op_sel_hi:[0,1,1] neg_lo:[1,0,0]
    v_pk_fma_f32 v[42:43], v[38:39], v[12:13], v[42:43] op_sel:[1,1,0] op_sel_hi:[0,1,1] neg_lo:[1,0,0]
    v_cvt_pk_f16_f32 v107, v96, v97
    v_cvt_pk_f16_f32 v103, v42, -v43
    ds_write_addtid_b32 v107 offset:10608
    ds_write_addtid_b32 v103 offset:1088
    v_pk_mul_f32 v[90:91], v[92:93], v[18:19] op_sel:[0,0] op_sel_hi:[1,0]
    v_pk_mul_f32 v[44:45], v[40:41], v[16:17] op_sel:[0,0] op_sel_hi:[1,0]
    v_pk_fma_f32 v[90:91], v[92:93], v[18:19], v[90:91] op_sel:[1,1,0] op_sel_hi:[0,1,1] neg_lo:[1,0,0]
    v_pk_fma_f32 v[44:45], v[40:41], v[16:17], v[44:45] op_sel:[1,1,0] op_sel_hi:[0,1,1] neg_lo:[1,0,0]
    v_cvt_pk_f16_f32 v104, v90, v91
    v_cvt_pk_f16_f32 v100, v44, -v45
    ds_write_addtid_b32 v104 offset:10880
    ds_write_addtid_b32 v100 offset:6528
    v_pk_mul_f32 v[94:95], v[96:97], v[18:19] op_sel:[0,0] op_sel_hi:[1,0]
    v_pk_mul_f32 v[46:47], v[42:43], v[12:13] op_sel:[0,0] op_sel_hi:[1,0]
    v_pk_fma_f32 v[94:95], v[96:97], v[18:19], v[94:95] op_sel:[1,1,0] op_sel_hi:[0,1,1] neg_lo:[1,0,0]
    v_pk_fma_f32 v[46:47], v[42:43], v[12:13], v[46:47] op_sel:[1,1,0] op_sel_hi:[0,1,1] neg_lo:[1,0,0]
    v_cvt_pk_f16_f32 v105, v94, v95
    v_cvt_pk_f16_f32 v101, v46, -v47
    ds_write_addtid_b32 v105 offset:11152
    ds_write_addtid_b32 v101 offset:1360
    v_pk_mul_f32 v[92:93], v[90:91], v[18:19] op_sel:[0,0] op_sel_hi:[1,0]
    v_pk_mul_f32 v[48:49], v[44:45], v[16:17] op_sel:[0,0] op_sel_hi:[1,0]
    v_pk_fma_f32 v[92:93], v[90:91], v[18:19], v[92:93] op_sel:[1,1,0] op_sel_hi:[0,1,1] neg_lo:[1,0,0]
    v_pk_fma_f32 v[48:49], v[44:45], v[16:17], v[48:49] op_sel:[1,1,0] op_sel_hi:[0,1,1] neg_lo:[1,0,0]
    v_cvt_pk_f16_f32 v106, v92, v93
    v_cvt_pk_f16_f32 v102, v48, -v49
    ds_write_addtid_b32 v106 offset:11424
    ds_write_addtid_b32 v102 offset:6800
    v_pk_mul_f32 v[96:97], v[94:95], v[18:19] op_sel:[0,0] op_sel_hi:[1,0]
    v_pk_mul_f32 v[50:51], v[46:47], v[12:13] op_sel:[0,0] op_sel_hi:[1,0]
    v_pk_fma_f32 v[96:97], v[94:95], v[18:19], v[96:97] op_sel:[1,1,0] op_sel_hi:[0,1,1] neg_lo:[1,0,0]
    v_pk_fma_f32 v[50:51], v[46:47], v[12:13], v[50:51] op_sel:[1,1,0] op_sel_hi:[0,1,1] neg_lo:[1,0,0]
    v_cvt_pk_f16_f32 v107, v96, v97
    v_cvt_pk_f16_f32 v103, v50, -v51
    ds_write_addtid_b32 v107 offset:11696
    ds_write_addtid_b32 v103 offset:1632
    v_pk_mul_f32 v[90:91], v[92:93], v[18:19] op_sel:[0,0] op_sel_hi:[1,0]
    v_pk_mul_f32 v[52:53], v[48:49], v[16:17] op_sel:[0,0] op_sel_hi:[1,0]
    v_pk_fma_f32 v[90:91], v[92:93], v[18:19], v[90:91] op_sel:[1,1,0] op_sel_hi:[0,1,1] neg_lo:[1,0,0]
    v_pk_fma_f32 v[52:53], v[48:49], v[16:17], v[52:53] op_sel:[1,1,0] op_sel_hi:[0,1,1] neg_lo:[1,0,0]
    v_cvt_pk_f16_f32 v104, v90, v91
    v_cvt_pk_f16_f32 v100, v52, -v53
    ds_write_addtid_b32 v104 offset:11968
    ds_write_addtid_b32 v100 offset:7072
    v_pk_mul_f32 v[94:95], v[96:97], v[18:19] op_sel:[0,0] op_sel_hi:[1,0]
    v_pk_mul_f32 v[54:55], v[50:51], v[12:13] op_sel:[0,0] op_sel_hi:[1,0]
    v_pk_fma_f32 v[94:95], v[96:97], v[18:19], v[94:95] op_sel:[1,1,0] op_sel_hi:[0,1,1] neg_lo:[1,0,0]
    v_pk_fma_f32 v[54:55], v[50:51], v[12:13], v[54:55] op_sel:[1,1,0] op_sel_hi:[0,1,1] neg_lo:[1,0,0]
    v_cvt_pk_f16_f32 v105, v94, v95
    v_cvt_pk_f16_f32 v101, v54, -v55
    ds_write_addtid_b32 v105 offset:12240
    ds_write_addtid_b32 v101 offset:1904
    v_pk_mul_f32 v[92:93], v[90:91], v[18:19] op_sel:[0,0] op_sel_hi:[1,0]
    v_pk_mul_f32 v[56:57], v[52:53], v[16:17] op_sel:[0,0] op_sel_hi:[1,0]
    v_pk_fma_f32 v[92:93], v[90:91], v[18:19], v[92:93] op_sel:[1,1,0] op_sel_hi:[0,1,1] neg_lo:[1,0,0]
    v_pk_fma_f32 v[56:57], v[52:53], v[16:17], v[56:57] op_sel:[1,1,0] op_sel_hi:[0,1,1] neg_lo:[1,0,0]
    v_cvt_pk_f16_f32 v106, v92, v93
    v_cvt_pk_f16_f32 v102, v56, -v57
    ds_write_addtid_b32 v106 offset:12512
    ds_write_addtid_b32 v102 offset:7344
    v_pk_mul_f32 v[96:97], v[94:95], v[18:19] op_sel:[0,0] op_sel_hi:[1,0]
    v_pk_mul_f32 v[58:59], v[32:33], v[22:23] op_sel:[0,0] op_sel_hi:[1,0]
    v_pk_fma_f32 v[96:97], v[94:95], v[18:19], v[96:97] op_sel:[1,1,0] op_sel_hi:[0,1,1] neg_lo:[1,0,0]
    v_pk_fma_f32 v[58:59], v[32:33], v[22:23], v[58:59] op_sel:[1,1,0] op_sel_hi:[0,1,1] neg_lo:[1,0,0]
    v_cvt_pk_f16_f32 v107, v96, v97
    v_cvt_pk_f16_f32 v103, v58, -v59
    ds_write_addtid_b32 v107 offset:12784
    ds_write_addtid_b32 v103 offset:2448
    v_pk_mul_f32 v[90:91], v[92:93], v[18:19] op_sel:[0,0] op_sel_hi:[1,0]
    v_pk_mul_f32 v[60:61], v[32:33], v[24:25] op_sel:[0,0] op_sel_hi:[1,0]
    v_pk_fma_f32 v[90:91], v[92:93], v[18:19], v[90:91] op_sel:[1,1,0] op_sel_hi:[0,1,1] neg_lo:[1,0,0]
    v_pk_fma_f32 v[60:61], v[32:33], v[24:25], v[60:61] op_sel:[1,1,0] op_sel_hi:[0,1,1] neg_lo:[1,0,0]
    v_cvt_pk_f16_f32 v104, v90, v91
    v_cvt_pk_f16_f32 v100, v60, -v61
    ds_write_addtid_b32 v104 offset:13056
    ds_write_addtid_b32 v100 offset:2720
    ds_write_addtid_b32 v100 offset:3264
    v_pk_mul_f32 v[94:95], v[96:97], v[18:19] op_sel:[0,0] op_sel_hi:[1,0]
    v_pk_mul_f32 v[62:63], v[58:59], v[24:25] op_sel:[0,0] op_sel_hi:[1,0]
    v_pk_fma_f32 v[94:95], v[96:97], v[18:19], v[94:95] op_sel:[1,1,0] op_sel_hi:[0,1,1] neg_lo:[1,0,0]
    v_pk_fma_f32 v[62:63], v[58:59], v[24:25], v[62:63] op_sel:[1,1,0] op_sel_hi:[0,1,1] neg_lo:[1,0,0]
    v_cvt_pk_f16_f32 v105, v94, v95
    v_cvt_pk_f16_f32 v101, v62, -v63
    ds_write_addtid_b32 v105 offset:13328
    ds_write_addtid_b32 v101 offset:3536
    v_pk_mul_f32 v[92:93], v[90:91], v[18:19] op_sel:[0,0] op_sel_hi:[1,0]
    v_pk_mul_f32 v[64:65], v[32:33], v[14:15] op_sel:[0,0] op_sel_hi:[1,0]
    v_pk_fma_f32 v[92:93], v[90:91], v[18:19], v[92:93] op_sel:[1,1,0] op_sel_hi:[0,1,1] neg_lo:[1,0,0]
    v_pk_fma_f32 v[64:65], v[32:33], v[14:15], v[64:65] op_sel:[1,1,0] op_sel_hi:[0,1,1] neg_lo:[1,0,0]
    v_cvt_pk_f16_f32 v106, v92, v93
    v_cvt_pk_f16_f32 v102, v64, -v65
    ds_write_addtid_b32 v106 offset:13600
    ds_write_addtid_b32 v102 offset:3808
    v_pk_mul_f32 v[96:97], v[94:95], v[18:19] op_sel:[0,0] op_sel_hi:[1,0]
    v_pk_mul_f32 v[66:67], v[36:37], v[24:25] op_sel:[0,0] op_sel_hi:[1,0]
    v_pk_fma_f32 v[96:97], v[94:95], v[18:19], v[96:97] op_sel:[1,1,0] op_sel_hi:[0,1,1] neg_lo:[1,0,0]
    v_pk_fma_f32 v[66:67], v[36:37], v[24:25], v[66:67] op_sel:[1,1,0] op_sel_hi:[0,1,1] neg_lo:[1,0,0]
    v_cvt_pk_f16_f32 v107, v96, v97
    v_cvt_pk_f16_f32 v103, v66, -v67
    ds_write_addtid_b32 v107 offset:13872
    ds_write_addtid_b32 v103 offset:4624
    ds_write_addtid_b32 v103 offset:5440
    v_pk_mul_f32 v[90:91], v[92:93], v[18:19] op_sel:[0,0] op_sel_hi:[1,0]
    v_pk_mul_f32 v[68:69], v[36:37], v[14:15] op_sel:[0,0] op_sel_hi:[1,0]
    v_pk_fma_f32 v[90:91], v[92:93], v[18:19], v[90:91] op_sel:[1,1,0] op_sel_hi:[0,1,1] neg_lo:[1,0,0]
    v_pk_fma_f32 v[68:69], v[36:37], v[14:15], v[68:69] op_sel:[1,1,0] op_sel_hi:[0,1,1] neg_lo:[1,0,0]
    v_cvt_pk_f16_f32 v104, v90, v91
    v_cvt_pk_f16_f32 v100, v68, -v69
    ds_write_addtid_b32 v104 offset:14144
    ds_write_addtid_b32 v100 offset:5712
    v_pk_mul_f32 v[94:95], v[96:97], v[18:19] op_sel:[0,0] op_sel_hi:[1,0]
    v_pk_mul_f32 v[70:71], v[40:41], v[24:25] op_sel:[0,0] op_sel_hi:[1,0]
    v_pk_fma_f32 v[94:95], v[96:97], v[18:19], v[94:95] op_sel:[1,1,0] op_sel_hi:[0,1,1] neg_lo:[1,0,0]
    v_pk_fma_f32 v[70:71], v[40:41], v[24:25], v[70:71] op_sel:[1,1,0] op_sel_hi:[0,1,1] neg_lo:[1,0,0]
    v_cvt_pk_f16_f32 v105, v94, v95
    v_cvt_pk_f16_f32 v101, v70, -v71
    ds_write_addtid_b32 v105 offset:14416
    ds_write_addtid_b32 v101 offset:5168
    ds_write_addtid_b32 v101 offset:5984
    v_pk_mul_f32 v[92:93], v[90:91], v[18:19] op_sel:[0,0] op_sel_hi:[1,0]
    v_pk_mul_f32 v[72:73], v[40:41], v[14:15] op_sel:[0,0] op_sel_hi:[1,0]
    v_pk_fma_f32 v[92:93], v[90:91], v[18:19], v[92:93] op_sel:[1,1,0] op_sel_hi:[0,1,1] neg_lo:[1,0,0]
    v_pk_fma_f32 v[72:73], v[40:41], v[14:15], v[72:73] op_sel:[1,1,0] op_sel_hi:[0,1,1] neg_lo:[1,0,0]
    v_cvt_pk_f16_f32 v106, v92, v93
    v_cvt_pk_f16_f32 v102, v72, -v73
    ds_write_addtid_b32 v106 offset:14688
    ds_write_addtid_b32 v102 offset:6256
    v_pk_mul_f32 v[96:97], v[94:95], v[18:19] op_sel:[0,0] op_sel_hi:[1,0]
    v_pk_mul_f32 v[74:75], v[44:45], v[14:15] op_sel:[0,0] op_sel_hi:[1,0]
    v_pk_fma_f32 v[96:97], v[94:95], v[18:19], v[96:97] op_sel:[1,1,0] op_sel_hi:[0,1,1] neg_lo:[1,0,0]
    v_pk_fma_f32 v[74:75], v[44:45], v[14:15], v[74:75] op_sel:[1,1,0] op_sel_hi:[0,1,1] neg_lo:[1,0,0]
    v_cvt_pk_f16_f32 v107, v96, v97
    v_cvt_pk_f16_f32 v103, v74, -v75
    ds_write_addtid_b32 v107 offset:14960
    ds_write_addtid_b32 v103 offset:7616
    v_pk_mul_f32 v[90:91], v[92:93], v[18:19] op_sel:[0,0] op_sel_hi:[1,0]
    v_pk_mul_f32 v[76:77], v[48:49], v[14:15] op_sel:[0,0] op_sel_hi:[1,0]
    v_pk_fma_f32 v[90:91], v[92:93], v[18:19], v[90:91] op_sel:[1,1,0] op_sel_hi:[0,1,1] neg_lo:[1,0,0]
    v_pk_fma_f32 v[76:77], v[48:49], v[14:15], v[76:77] op_sel:[1,1,0] op_sel_hi:[0,1,1] neg_lo:[1,0,0]
    v_cvt_pk_f16_f32 v104, v90, v91
    v_cvt_pk_f16_f32 v100, v76, -v77
    ds_write_addtid_b32 v104 offset:15232
    ds_write_addtid_b32 v100 offset:7888
    v_pk_mul_f32 v[94:95], v[96:97], v[18:19] op_sel:[0,0] op_sel_hi:[1,0]
    v_pk_mul_f32 v[78:79], v[52:53], v[14:15] op_sel:[0,0] op_sel_hi:[1,0]
    v_pk_fma_f32 v[94:95], v[96:97], v[18:19], v[94:95] op_sel:[1,1,0] op_sel_hi:[0,1,1] neg_lo:[1,0,0]
    v_pk_fma_f32 v[78:79], v[52:53], v[14:15], v[78:79] op_sel:[1,1,0] op_sel_hi:[0,1,1] neg_lo:[1,0,0]
    v_cvt_pk_f16_f32 v105, v94, v95
    v_cvt_pk_f16_f32 v101, v78, -v79
    ds_write_addtid_b32 v105 offset:15504
    ds_write_addtid_b32 v101 offset:8160
    v_pk_mul_f32 v[92:93], v[90:91], v[18:19] op_sel:[0,0] op_sel_hi:[1,0]
    v_pk_mul_f32 v[80:81], v[56:57], v[14:15] op_sel:[0,0] op_sel_hi:[1,0]
    v_pk_fma_f32 v[92:93], v[90:91], v[18:19], v[92:93] op_sel:[1,1,0] op_sel_hi:[0,1,1] neg_lo:[1,0,0]
    v_pk_fma_f32 v[80:81], v[56:57], v[14:15], v[80:81] op_sel:[1,1,0] op_sel_hi:[0,1,1] neg_lo:[1,0,0]
    v_cvt_pk_f16_f32 v106, v92, v93
    v_cvt_pk_f16_f32 v102, v80, -v81
    ds_write_addtid_b32 v106 offset:15776
    ds_write_addtid_b32 v102 offset:8432
    v_pk_mul_f32 v[96:97], v[94:95], v[18:19] op_sel:[0,0] op_sel_hi:[1,0]
    v_pk_fma_f32 v[96:97], v[94:95], v[18:19], v[96:97] op_sel:[1,1,0] op_sel_hi:[0,1,1] neg_lo:[1,0,0]
    v_cvt_pk_f16_f32 v107, v96, v97
    ds_write_addtid_b32 v107 offset:16048
    v_pk_mul_f32 v[90:91], v[92:93], v[18:19] op_sel:[0,0] op_sel_hi:[1,0]
    v_pk_fma_f32 v[90:91], v[92:93], v[18:19], v[90:91] op_sel:[1,1,0] op_sel_hi:[0,1,1] neg_lo:[1,0,0]
    v_cvt_pk_f16_f32 v104, v90, v91
    ds_write_addtid_b32 v104 offset:16320
    v_pk_mul_f32 v[94:95], v[96:97], v[18:19] op_sel:[0,0] op_sel_hi:[1,0]
    v_pk_fma_f32 v[94:95], v[96:97], v[18:19], v[94:95] op_sel:[1,1,0] op_sel_hi:[0,1,1] neg_lo:[1,0,0]
    v_cvt_pk_f16_f32 v105, v94, v95
    ds_write_addtid_b32 v105 offset:16592
    v_pk_mul_f32 v[92:93], v[90:91], v[18:19] op_sel:[0,0] op_sel_hi:[1,0]
    v_pk_fma_f32 v[92:93], v[90:91], v[18:19], v[92:93] op_sel:[1,1,0] op_sel_hi:[0,1,1] neg_lo:[1,0,0]
    v_cvt_pk_f16_f32 v106, v92, v93
    ds_write_addtid_b32 v106 offset:16864
    v_pk_mul_f32 v[96:97], v[94:95], v[18:19] op_sel:[0,0] op_sel_hi:[1,0]
    v_pk_fma_f32 v[96:97], v[94:95], v[18:19], v[96:97] op_sel:[1,1,0] op_sel_hi:[0,1,1] neg_lo:[1,0,0]
    v_cvt_pk_f16_f32 v107, v96, v97
    ds_write_addtid_b32 v107 offset:17136
    ds_read_b128 v[128:131], v9 offset:0
    ds_read_b128 v[132:135], v9 offset:8704
    ds_read_b128 v[136:139], v9 offset:32
    ds_read_b128 v[140:143], v9 offset:8736
    ds_read_b128 v[144:147], v9 offset:64
    ds_read_b128 v[148:151], v9 offset:8768
    ds_read_b128 v[152:155], v9 offset:96
    ds_read_b128 v[156:159], v9 offset:8800
    ds_read_b128 v[160:163], v9 offset:128
    ds_read_b128 v[164:167], v9 offset:8832
    ds_read_b128 v[168:171], v9 offset:160
    ds_read_b128 v[172:175], v9 offset:8864
    ds_read_b128 v[176:179], v9 offset:192
    ds_read_b128 v[180:183], v9 offset:8896
    ds_read_b128 v[184:187], v9 offset:224
    ds_read_b128 v[196:199], v9 offset:8928
    v_mul_f32 v20, 1.0, v190
    v_mul_f32 v21, 1.0, v191
    v_mul_f32 v22, 8.0, v190
    v_mul_f32 v23, 8.0, v191
    v_mul_f32 v24, 256.0, v190
    v_mul_f32 v25, 256.0, v191
    v_mul_f32 v26, 16.0, v190
    v_mul_f32 v27, 16.0, v191
    v_exp_f32 v20, -v20
    v_fract_f32 v21, v21
    v_exp_f32 v22, -v22
    v_fract_f32 v23, v23
    v_exp_f32 v24, -v24
    v_fract_f32 v25, v25
    v_exp_f32 v26, -v26
    v_fract_f32 v27, v27
    v_cos_f32 v12, v21
    v_sin_f32 v13, v21
    v_cos_f32 v14, v23
    v_sin_f32 v15, v23
    v_cos_f32 v16, v25
    v_sin_f32 v17, v25
    v_cos_f32 v18, v27
    v_sin_f32 v19, v27
    v_mul_f32 v12, v20, v12
    v_mul_f32 v13, v20, v13
    v_mul_f32 v14, v22, v14
    v_mul_f32 v15, v22, v15
    v_mul_f32 v16, v24, v16
    v_mul_f32 v17, v24, v17
    v_mul_f32 v18, v26, v18
    v_mul_f32 v19, v26, v19
    v_pk_mul_f32 v[22:23], v[12:13], v[12:13] op_sel:[0,0] op_sel_hi:[1,0]
    v_pk_fma_f32 v[22:23], v[12:13], v[12:13], v[22:23] op_sel:[1,1,0] op_sel_hi:[0,1,1] neg_lo:[1,0,0]
    v_pk_mul_f32 v[24:25], v[22:23], v[22:23] op_sel:[0,0] op_sel_hi:[1,0]
    v_pk_fma_f32 v[24:25], v[22:23], v[22:23], v[24:25] op_sel:[1,1,0] op_sel_hi:[0,1,1] neg_lo:[1,0,0]
    v_mov_b32 v90, 1.0
    v_mov_b32 v91, 0
    v_mov_b32 v94, v14
    v_mov_b32 v95, v15
    v_cvt_pk_f16_f32 v104, v90, v91
    v_cvt_pk_f16_f32 v100, v192, -v193
    ds_write_addtid_b32 v104 offset:8704
    ds_write_addtid_b32 v100 offset:0
    ds_write_addtid_b32 v100 offset:2992
    ds_write_addtid_b32 v100 offset:4080
    v_cvt_pk_f16_f32 v105, v94, v95
    v_pk_mul_f32 v[30:31], v[192:193], v[12:13] op_sel:[0,0] op_sel_hi:[1,0]
    ds_write_addtid_b32 v105 offset:8976
    v_pk_fma_f32 v[30:31], v[192:193], v[12:13], v[30:31] op_sel:[1,1,0] op_sel_hi:[0,1,1] neg_lo:[1,0,0]
    v_cvt_pk_f16_f32 v101, v30, -v31
    ds_write_addtid_b32 v101 offset:272
    s_waitcnt lgkmcnt(6)
    v_mfma_f32_32x32x16_f16 v[112:127], v[128:131], v[132:135], 0
    v_pk_mul_f32 v[92:93], v[90:91], v[18:19] op_sel:[0,0] op_sel_hi:[1,0]
    v_pk_mul_f32 v[32:33], v[192:193], v[16:17] op_sel:[0,0] op_sel_hi:[1,0]
    v_pk_fma_f32 v[92:93], v[90:91], v[18:19], v[92:93] op_sel:[1,1,0] op_sel_hi:[0,1,1] neg_lo:[1,0,0]
    v_pk_fma_f32 v[32:33], v[192:193], v[16:17], v[32:33] op_sel:[1,1,0] op_sel_hi:[0,1,1] neg_lo:[1,0,0]
    v_cvt_pk_f16_f32 v106, v92, v93
    v_cvt_pk_f16_f32 v102, v32, -v33
    ds_write_addtid_b32 v106 offset:9248
    ds_write_addtid_b32 v102 offset:2176
    v_pk_mul_f32 v[96:97], v[94:95], v[18:19] op_sel:[0,0] op_sel_hi:[1,0]
    v_pk_mul_f32 v[34:35], v[30:31], v[12:13] op_sel:[0,0] op_sel_hi:[1,0]
    v_pk_fma_f32 v[96:97], v[94:95], v[18:19], v[96:97] op_sel:[1,1,0] op_sel_hi:[0,1,1] neg_lo:[1,0,0]
    v_pk_fma_f32 v[34:35], v[30:31], v[12:13], v[34:35] op_sel:[1,1,0] op_sel_hi:[0,1,1] neg_lo:[1,0,0]
    v_cvt_pk_f16_f32 v107, v96, v97
    v_cvt_pk_f16_f32 v103, v34, -v35
    ds_write_addtid_b32 v107 offset:9520
    ds_write_addtid_b32 v103 offset:544
    v_pk_mul_f32 v[90:91], v[92:93], v[18:19] op_sel:[0,0] op_sel_hi:[1,0]
    v_pk_mul_f32 v[36:37], v[32:33], v[16:17] op_sel:[0,0] op_sel_hi:[1,0]
    v_pk_fma_f32 v[90:91], v[92:93], v[18:19], v[90:91] op_sel:[1,1,0] op_sel_hi:[0,1,1] neg_lo:[1,0,0]
    v_pk_fma_f32 v[36:37], v[32:33], v[16:17], v[36:37] op_sel:[1,1,0] op_sel_hi:[0,1,1] neg_lo:[1,0,0]
    v_cvt_pk_f16_f32 v104, v90, v91
    v_cvt_pk_f16_f32 v100, v36, -v37
    ds_write_addtid_b32 v104 offset:9792
    ds_write_addtid_b32 v100 offset:4352
    v_pk_mul_f32 v[94:95], v[96:97], v[18:19] op_sel:[0,0] op_sel_hi:[1,0]
    v_pk_mul_f32 v[38:39], v[34:35], v[12:13] op_sel:[0,0] op_sel_hi:[1,0]
    v_pk_fma_f32 v[94:95], v[96:97], v[18:19], v[94:95] op_sel:[1,1,0] op_sel_hi:[0,1,1] neg_lo:[1,0,0]
    v_pk_fma_f32 v[38:39], v[34:35], v[12:13], v[38:39] op_sel:[1,1,0] op_sel_hi:[0,1,1] neg_lo:[1,0,0]
    v_cvt_pk_f16_f32 v105, v94, v95
    v_cvt_pk_f16_f32 v101, v38, -v39
    ds_write_addtid_b32 v105 offset:10064
    ds_write_addtid_b32 v101 offset:816
    v_mfma_f32_32x32x16_f16 v[112:127], v[136:139], v[140:143], v[112:127]
    v_pk_mul_f32 v[92:93], v[90:91], v[18:19] op_sel:[0,0] op_sel_hi:[1,0]
    v_pk_mul_f32 v[40:41], v[36:37], v[16:17] op_sel:[0,0] op_sel_hi:[1,0]
    v_pk_fma_f32 v[92:93], v[90:91], v[18:19], v[92:93] op_sel:[1,1,0] op_sel_hi:[0,1,1] neg_lo:[1,0,0]
    v_pk_fma_f32 v[40:41], v[36:37], v[16:17], v[40:41] op_sel:[1,1,0] op_sel_hi:[0,1,1] neg_lo:[1,0,0]
    v_cvt_pk_f16_f32 v106, v92, v93
    v_cvt_pk_f16_f32 v102, v40, -v41
    ds_write_addtid_b32 v106 offset:10336
    ds_write_addtid_b32 v102 offset:4896
    v_pk_mul_f32 v[96:97], v[94:95], v[18:19] op_sel:[0,0] op_sel_hi:[1,0]
    v_pk_mul_f32 v[42:43], v[38:39], v[12:13] op_sel:[0,0] op_sel_hi:[1,0]
    v_pk_fma_f32 v[96:97], v[94:95], v[18:19], v[96:97] op_sel:[1,1,0] op_sel_hi:[0,1,1] neg_lo:[1,0,0]
    v_pk_fma_f32 v[42:43], v[38:39], v[12:13], v[42:43] op_sel:[1,1,0] op_sel_hi:[0,1,1] neg_lo:[1,0,0]
    v_cvt_pk_f16_f32 v107, v96, v97
    v_cvt_pk_f16_f32 v103, v42, -v43
    ds_write_addtid_b32 v107 offset:10608
    ds_write_addtid_b32 v103 offset:1088
    v_pk_mul_f32 v[90:91], v[92:93], v[18:19] op_sel:[0,0] op_sel_hi:[1,0]
    v_pk_mul_f32 v[44:45], v[40:41], v[16:17] op_sel:[0,0] op_sel_hi:[1,0]
    v_pk_fma_f32 v[90:91], v[92:93], v[18:19], v[90:91] op_sel:[1,1,0] op_sel_hi:[0,1,1] neg_lo:[1,0,0]
    v_pk_fma_f32 v[44:45], v[40:41], v[16:17], v[44:45] op_sel:[1,1,0] op_sel_hi:[0,1,1] neg_lo:[1,0,0]
    v_cvt_pk_f16_f32 v104, v90, v91
    v_cvt_pk_f16_f32 v100, v44, -v45
    ds_write_addtid_b32 v104 offset:10880
    ds_write_addtid_b32 v100 offset:6528
    v_pk_mul_f32 v[94:95], v[96:97], v[18:19] op_sel:[0,0] op_sel_hi:[1,0]
    v_pk_mul_f32 v[46:47], v[42:43], v[12:13] op_sel:[0,0] op_sel_hi:[1,0]
    v_pk_fma_f32 v[94:95], v[96:97], v[18:19], v[94:95] op_sel:[1,1,0] op_sel_hi:[0,1,1] neg_lo:[1,0,0]
    v_pk_fma_f32 v[46:47], v[42:43], v[12:13], v[46:47] op_sel:[1,1,0] op_sel_hi:[0,1,1] neg_lo:[1,0,0]
    v_cvt_pk_f16_f32 v105, v94, v95
    v_cvt_pk_f16_f32 v101, v46, -v47
    ds_write_addtid_b32 v105 offset:11152
    ds_write_addtid_b32 v101 offset:1360
    v_mfma_f32_32x32x16_f16 v[112:127], v[144:147], v[148:151], v[112:127]
    v_pk_mul_f32 v[92:93], v[90:91], v[18:19] op_sel:[0,0] op_sel_hi:[1,0]
    v_pk_mul_f32 v[48:49], v[44:45], v[16:17] op_sel:[0,0] op_sel_hi:[1,0]
    v_pk_fma_f32 v[92:93], v[90:91], v[18:19], v[92:93] op_sel:[1,1,0] op_sel_hi:[0,1,1] neg_lo:[1,0,0]
    v_pk_fma_f32 v[48:49], v[44:45], v[16:17], v[48:49] op_sel:[1,1,0] op_sel_hi:[0,1,1] neg_lo:[1,0,0]
    v_cvt_pk_f16_f32 v106, v92, v93
    v_cvt_pk_f16_f32 v102, v48, -v49
    ds_write_addtid_b32 v106 offset:11424
    ds_write_addtid_b32 v102 offset:6800
    v_pk_mul_f32 v[96:97], v[94:95], v[18:19] op_sel:[0,0] op_sel_hi:[1,0]
    v_pk_mul_f32 v[50:51], v[46:47], v[12:13] op_sel:[0,0] op_sel_hi:[1,0]
    v_pk_fma_f32 v[96:97], v[94:95], v[18:19], v[96:97] op_sel:[1,1,0] op_sel_hi:[0,1,1] neg_lo:[1,0,0]
    v_pk_fma_f32 v[50:51], v[46:47], v[12:13], v[50:51] op_sel:[1,1,0] op_sel_hi:[0,1,1] neg_lo:[1,0,0]
    v_cvt_pk_f16_f32 v107, v96, v97
    v_cvt_pk_f16_f32 v103, v50, -v51
    ds_write_addtid_b32 v107 offset:11696
    ds_write_addtid_b32 v103 offset:1632
    v_pk_mul_f32 v[90:91], v[92:93], v[18:19] op_sel:[0,0] op_sel_hi:[1,0]
    v_pk_mul_f32 v[52:53], v[48:49], v[16:17] op_sel:[0,0] op_sel_hi:[1,0]
    v_pk_fma_f32 v[90:91], v[92:93], v[18:19], v[90:91] op_sel:[1,1,0] op_sel_hi:[0,1,1] neg_lo:[1,0,0]
    v_pk_fma_f32 v[52:53], v[48:49], v[16:17], v[52:53] op_sel:[1,1,0] op_sel_hi:[0,1,1] neg_lo:[1,0,0]
    v_cvt_pk_f16_f32 v104, v90, v91
    v_cvt_pk_f16_f32 v100, v52, -v53
    ds_write_addtid_b32 v104 offset:11968
    ds_write_addtid_b32 v100 offset:7072
    v_pk_mul_f32 v[94:95], v[96:97], v[18:19] op_sel:[0,0] op_sel_hi:[1,0]
    v_pk_mul_f32 v[54:55], v[50:51], v[12:13] op_sel:[0,0] op_sel_hi:[1,0]
    v_pk_fma_f32 v[94:95], v[96:97], v[18:19], v[94:95] op_sel:[1,1,0] op_sel_hi:[0,1,1] neg_lo:[1,0,0]
    v_pk_fma_f32 v[54:55], v[50:51], v[12:13], v[54:55] op_sel:[1,1,0] op_sel_hi:[0,1,1] neg_lo:[1,0,0]
    v_cvt_pk_f16_f32 v105, v94, v95
    v_cvt_pk_f16_f32 v101, v54, -v55
    ds_write_addtid_b32 v105 offset:12240
    ds_write_addtid_b32 v101 offset:1904
    v_mfma_f32_32x32x16_f16 v[112:127], v[152:155], v[156:159], v[112:127]
    v_pk_mul_f32 v[92:93], v[90:91], v[18:19] op_sel:[0,0] op_sel_hi:[1,0]
    v_pk_mul_f32 v[56:57], v[52:53], v[16:17] op_sel:[0,0] op_sel_hi:[1,0]
    v_pk_fma_f32 v[92:93], v[90:91], v[18:19], v[92:93] op_sel:[1,1,0] op_sel_hi:[0,1,1] neg_lo:[1,0,0]
    v_pk_fma_f32 v[56:57], v[52:53], v[16:17], v[56:57] op_sel:[1,1,0] op_sel_hi:[0,1,1] neg_lo:[1,0,0]
    v_cvt_pk_f16_f32 v106, v92, v93
    v_cvt_pk_f16_f32 v102, v56, -v57
    ds_write_addtid_b32 v106 offset:12512
    ds_write_addtid_b32 v102 offset:7344
    v_pk_mul_f32 v[96:97], v[94:95], v[18:19] op_sel:[0,0] op_sel_hi:[1,0]
    v_pk_mul_f32 v[58:59], v[32:33], v[22:23] op_sel:[0,0] op_sel_hi:[1,0]
    v_pk_fma_f32 v[96:97], v[94:95], v[18:19], v[96:97] op_sel:[1,1,0] op_sel_hi:[0,1,1] neg_lo:[1,0,0]
    v_pk_fma_f32 v[58:59], v[32:33], v[22:23], v[58:59] op_sel:[1,1,0] op_sel_hi:[0,1,1] neg_lo:[1,0,0]
    v_cvt_pk_f16_f32 v107, v96, v97
    v_cvt_pk_f16_f32 v103, v58, -v59
    ds_write_addtid_b32 v107 offset:12784
    ds_write_addtid_b32 v103 offset:2448
    v_pk_mul_f32 v[90:91], v[92:93], v[18:19] op_sel:[0,0] op_sel_hi:[1,0]
    v_pk_mul_f32 v[60:61], v[32:33], v[24:25] op_sel:[0,0] op_sel_hi:[1,0]
    v_pk_fma_f32 v[90:91], v[92:93], v[18:19], v[90:91] op_sel:[1,1,0] op_sel_hi:[0,1,1] neg_lo:[1,0,0]
    v_pk_fma_f32 v[60:61], v[32:33], v[24:25], v[60:61] op_sel:[1,1,0] op_sel_hi:[0,1,1] neg_lo:[1,0,0]
    v_cvt_pk_f16_f32 v104, v90, v91
    v_cvt_pk_f16_f32 v100, v60, -v61
    ds_write_addtid_b32 v104 offset:13056
    ds_write_addtid_b32 v100 offset:2720
    ds_write_addtid_b32 v100 offset:3264
    v_pk_mul_f32 v[94:95], v[96:97], v[18:19] op_sel:[0,0] op_sel_hi:[1,0]
    v_pk_mul_f32 v[62:63], v[58:59], v[24:25] op_sel:[0,0] op_sel_hi:[1,0]
    v_pk_fma_f32 v[94:95], v[96:97], v[18:19], v[94:95] op_sel:[1,1,0] op_sel_hi:[0,1,1] neg_lo:[1,0,0]
    v_pk_fma_f32 v[62:63], v[58:59], v[24:25], v[62:63] op_sel:[1,1,0] op_sel_hi:[0,1,1] neg_lo:[1,0,0]
    v_cvt_pk_f16_f32 v105, v94, v95
    v_cvt_pk_f16_f32 v101, v62, -v63
    ds_write_addtid_b32 v105 offset:13328
    ds_write_addtid_b32 v101 offset:3536
    v_mfma_f32_32x32x16_f16 v[112:127], v[160:163], v[164:167], v[112:127]
    v_pk_mul_f32 v[92:93], v[90:91], v[18:19] op_sel:[0,0] op_sel_hi:[1,0]
    v_pk_mul_f32 v[64:65], v[32:33], v[14:15] op_sel:[0,0] op_sel_hi:[1,0]
    v_pk_fma_f32 v[92:93], v[90:91], v[18:19], v[92:93] op_sel:[1,1,0] op_sel_hi:[0,1,1] neg_lo:[1,0,0]
    v_pk_fma_f32 v[64:65], v[32:33], v[14:15], v[64:65] op_sel:[1,1,0] op_sel_hi:[0,1,1] neg_lo:[1,0,0]
    v_cvt_pk_f16_f32 v106, v92, v93
    v_cvt_pk_f16_f32 v102, v64, -v65
    ds_write_addtid_b32 v106 offset:13600
    ds_write_addtid_b32 v102 offset:3808
    v_pk_mul_f32 v[96:97], v[94:95], v[18:19] op_sel:[0,0] op_sel_hi:[1,0]
    v_pk_mul_f32 v[66:67], v[36:37], v[24:25] op_sel:[0,0] op_sel_hi:[1,0]
    v_pk_fma_f32 v[96:97], v[94:95], v[18:19], v[96:97] op_sel:[1,1,0] op_sel_hi:[0,1,1] neg_lo:[1,0,0]
    v_pk_fma_f32 v[66:67], v[36:37], v[24:25], v[66:67] op_sel:[1,1,0] op_sel_hi:[0,1,1] neg_lo:[1,0,0]
    v_cvt_pk_f16_f32 v107, v96, v97
    v_cvt_pk_f16_f32 v103, v66, -v67
    ds_write_addtid_b32 v107 offset:13872
    ds_write_addtid_b32 v103 offset:4624
    ds_write_addtid_b32 v103 offset:5440
    v_pk_mul_f32 v[90:91], v[92:93], v[18:19] op_sel:[0,0] op_sel_hi:[1,0]
    v_pk_mul_f32 v[68:69], v[36:37], v[14:15] op_sel:[0,0] op_sel_hi:[1,0]
    v_pk_fma_f32 v[90:91], v[92:93], v[18:19], v[90:91] op_sel:[1,1,0] op_sel_hi:[0,1,1] neg_lo:[1,0,0]
    v_pk_fma_f32 v[68:69], v[36:37], v[14:15], v[68:69] op_sel:[1,1,0] op_sel_hi:[0,1,1] neg_lo:[1,0,0]
    v_cvt_pk_f16_f32 v104, v90, v91
    v_cvt_pk_f16_f32 v100, v68, -v69
    ds_write_addtid_b32 v104 offset:14144
    ds_write_addtid_b32 v100 offset:5712
    v_pk_mul_f32 v[94:95], v[96:97], v[18:19] op_sel:[0,0] op_sel_hi:[1,0]
    v_pk_mul_f32 v[70:71], v[40:41], v[24:25] op_sel:[0,0] op_sel_hi:[1,0]
    v_pk_fma_f32 v[94:95], v[96:97], v[18:19], v[94:95] op_sel:[1,1,0] op_sel_hi:[0,1,1] neg_lo:[1,0,0]
    v_pk_fma_f32 v[70:71], v[40:41], v[24:25], v[70:71] op_sel:[1,1,0] op_sel_hi:[0,1,1] neg_lo:[1,0,0]
    v_cvt_pk_f16_f32 v105, v94, v95
    v_cvt_pk_f16_f32 v101, v70, -v71
    ds_write_addtid_b32 v105 offset:14416
    ds_write_addtid_b32 v101 offset:5168
    ds_write_addtid_b32 v101 offset:5984
    v_mfma_f32_32x32x16_f16 v[112:127], v[168:171], v[172:175], v[112:127]
    v_pk_mul_f32 v[92:93], v[90:91], v[18:19] op_sel:[0,0] op_sel_hi:[1,0]
    v_pk_mul_f32 v[72:73], v[40:41], v[14:15] op_sel:[0,0] op_sel_hi:[1,0]
    v_pk_fma_f32 v[92:93], v[90:91], v[18:19], v[92:93] op_sel:[1,1,0] op_sel_hi:[0,1,1] neg_lo:[1,0,0]
    v_pk_fma_f32 v[72:73], v[40:41], v[14:15], v[72:73] op_sel:[1,1,0] op_sel_hi:[0,1,1] neg_lo:[1,0,0]
    v_cvt_pk_f16_f32 v106, v92, v93
    v_cvt_pk_f16_f32 v102, v72, -v73
    ds_write_addtid_b32 v106 offset:14688
    ds_write_addtid_b32 v102 offset:6256
    v_pk_mul_f32 v[96:97], v[94:95], v[18:19] op_sel:[0,0] op_sel_hi:[1,0]
    v_pk_mul_f32 v[74:75], v[44:45], v[14:15] op_sel:[0,0] op_sel_hi:[1,0]
    v_pk_fma_f32 v[96:97], v[94:95], v[18:19], v[96:97] op_sel:[1,1,0] op_sel_hi:[0,1,1] neg_lo:[1,0,0]
    v_pk_fma_f32 v[74:75], v[44:45], v[14:15], v[74:75] op_sel:[1,1,0] op_sel_hi:[0,1,1] neg_lo:[1,0,0]
    v_cvt_pk_f16_f32 v107, v96, v97
    v_cvt_pk_f16_f32 v103, v74, -v75
    ds_write_addtid_b32 v107 offset:14960
    ds_write_addtid_b32 v103 offset:7616
    v_pk_mul_f32 v[90:91], v[92:93], v[18:19] op_sel:[0,0] op_sel_hi:[1,0]
    v_pk_mul_f32 v[76:77], v[48:49], v[14:15] op_sel:[0,0] op_sel_hi:[1,0]
    v_pk_fma_f32 v[90:91], v[92:93], v[18:19], v[90:91] op_sel:[1,1,0] op_sel_hi:[0,1,1] neg_lo:[1,0,0]
    v_pk_fma_f32 v[76:77], v[48:49], v[14:15], v[76:77] op_sel:[1,1,0] op_sel_hi:[0,1,1] neg_lo:[1,0,0]
    v_cvt_pk_f16_f32 v104, v90, v91
    v_cvt_pk_f16_f32 v100, v76, -v77
    ds_write_addtid_b32 v104 offset:15232
    ds_write_addtid_b32 v100 offset:7888
    v_pk_mul_f32 v[94:95], v[96:97], v[18:19] op_sel:[0,0] op_sel_hi:[1,0]
    v_pk_mul_f32 v[78:79], v[52:53], v[14:15] op_sel:[0,0] op_sel_hi:[1,0]
    v_pk_fma_f32 v[94:95], v[96:97], v[18:19], v[94:95] op_sel:[1,1,0] op_sel_hi:[0,1,1] neg_lo:[1,0,0]
    v_pk_fma_f32 v[78:79], v[52:53], v[14:15], v[78:79] op_sel:[1,1,0] op_sel_hi:[0,1,1] neg_lo:[1,0,0]
    v_cvt_pk_f16_f32 v105, v94, v95
    v_cvt_pk_f16_f32 v101, v78, -v79
    ds_write_addtid_b32 v105 offset:15504
    ds_write_addtid_b32 v101 offset:8160
    v_mfma_f32_32x32x16_f16 v[112:127], v[176:179], v[180:183], v[112:127]
    v_pk_mul_f32 v[92:93], v[90:91], v[18:19] op_sel:[0,0] op_sel_hi:[1,0]
    v_pk_mul_f32 v[80:81], v[56:57], v[14:15] op_sel:[0,0] op_sel_hi:[1,0]
    v_pk_fma_f32 v[92:93], v[90:91], v[18:19], v[92:93] op_sel:[1,1,0] op_sel_hi:[0,1,1] neg_lo:[1,0,0]
    v_pk_fma_f32 v[80:81], v[56:57], v[14:15], v[80:81] op_sel:[1,1,0] op_sel_hi:[0,1,1] neg_lo:[1,0,0]
    v_cvt_pk_f16_f32 v106, v92, v93
    v_cvt_pk_f16_f32 v102, v80, -v81
    ds_write_addtid_b32 v106 offset:15776
    ds_write_addtid_b32 v102 offset:8432
    v_pk_mul_f32 v[96:97], v[94:95], v[18:19] op_sel:[0,0] op_sel_hi:[1,0]
    v_pk_fma_f32 v[96:97], v[94:95], v[18:19], v[96:97] op_sel:[1,1,0] op_sel_hi:[0,1,1] neg_lo:[1,0,0]
    v_cvt_pk_f16_f32 v107, v96, v97
    ds_write_addtid_b32 v107 offset:16048
    v_pk_mul_f32 v[90:91], v[92:93], v[18:19] op_sel:[0,0] op_sel_hi:[1,0]
    v_pk_fma_f32 v[90:91], v[92:93], v[18:19], v[90:91] op_sel:[1,1,0] op_sel_hi:[0,1,1] neg_lo:[1,0,0]
    v_cvt_pk_f16_f32 v104, v90, v91
    ds_write_addtid_b32 v104 offset:16320
    v_pk_mul_f32 v[94:95], v[96:97], v[18:19] op_sel:[0,0] op_sel_hi:[1,0]
    v_pk_fma_f32 v[94:95], v[96:97], v[18:19], v[94:95] op_sel:[1,1,0] op_sel_hi:[0,1,1] neg_lo:[1,0,0]
    v_cvt_pk_f16_f32 v105, v94, v95
    ds_write_addtid_b32 v105 offset:16592
    v_mfma_f32_32x32x16_f16 v[112:127], v[184:187], v[196:199], v[112:127]
    v_pk_mul_f32 v[92:93], v[90:91], v[18:19] op_sel:[0,0] op_sel_hi:[1,0]
    v_pk_fma_f32 v[92:93], v[90:91], v[18:19], v[92:93] op_sel:[1,1,0] op_sel_hi:[0,1,1] neg_lo:[1,0,0]
    v_cvt_pk_f16_f32 v106, v92, v93
    ds_write_addtid_b32 v106 offset:16864
    v_pk_mul_f32 v[96:97], v[94:95], v[18:19] op_sel:[0,0] op_sel_hi:[1,0]
    v_pk_fma_f32 v[96:97], v[94:95], v[18:19], v[96:97] op_sel:[1,1,0] op_sel_hi:[0,1,1] neg_lo:[1,0,0]
    v_cvt_pk_f16_f32 v107, v96, v97
    ds_write_addtid_b32 v107 offset:17136
    ds_read_b128 v[128:131], v9 offset:0
    ds_read_b128 v[132:135], v9 offset:8704
    ds_read_b128 v[136:139], v9 offset:32
    ds_read_b128 v[140:143], v9 offset:8736
    ds_read_b128 v[144:147], v9 offset:64
    ds_read_b128 v[148:151], v9 offset:8768
    ds_read_b128 v[152:155], v9 offset:96
    ds_read_b128 v[156:159], v9 offset:8800
    ds_read_b128 v[160:163], v9 offset:128
    ds_read_b128 v[164:167], v9 offset:8832
    ds_read_b128 v[168:171], v9 offset:160
    ds_read_b128 v[172:175], v9 offset:8864
    ds_read_b128 v[176:179], v9 offset:192
    ds_read_b128 v[180:183], v9 offset:8896
    ds_read_b128 v[184:187], v9 offset:224
    ds_read_b128 v[196:199], v9 offset:8928
    s_waitcnt lgkmcnt(14)
    v_mfma_f32_32x32x16_f16 v[112:127], v[128:131], v[132:135], v[112:127]
    s_waitcnt lgkmcnt(12)
    v_mfma_f32_32x32x16_f16 v[112:127], v[136:139], v[140:143], v[112:127]
    s_waitcnt lgkmcnt(10)
    v_mfma_f32_32x32x16_f16 v[112:127], v[144:147], v[148:151], v[112:127]
    s_waitcnt lgkmcnt(8)
    v_mfma_f32_32x32x16_f16 v[112:127], v[152:155], v[156:159], v[112:127]
    s_waitcnt lgkmcnt(6)
    v_mfma_f32_32x32x16_f16 v[112:127], v[160:163], v[164:167], v[112:127]
    s_waitcnt lgkmcnt(4)
    v_mfma_f32_32x32x16_f16 v[112:127], v[168:171], v[172:175], v[112:127]
    s_waitcnt lgkmcnt(2)
    v_mfma_f32_32x32x16_f16 v[112:127], v[176:179], v[180:183], v[112:127]
    s_waitcnt lgkmcnt(0)
    v_mfma_f32_32x32x16_f16 v[112:127], v[184:187], v[196:199], v[112:127]
    s_nop 7
    s_nop 7
    s_nop 1
    v_pk_mul_f32 v[112:113], v[112:113], v[4:5] op_sel:[0,1] op_sel_hi:[1,1]
    v_pk_mul_f32 v[114:115], v[114:115], v[4:5] op_sel:[0,1] op_sel_hi:[1,1]
    v_pk_mul_f32 v[116:117], v[116:117], v[4:5] op_sel:[0,1] op_sel_hi:[1,1]
    v_pk_mul_f32 v[118:119], v[118:119], v[4:5] op_sel:[0,1] op_sel_hi:[1,1]
    v_pk_mul_f32 v[120:121], v[120:121], v[4:5] op_sel:[0,1] op_sel_hi:[1,1]
    v_pk_mul_f32 v[122:123], v[122:123], v[4:5] op_sel:[0,1] op_sel_hi:[1,1]
    v_pk_mul_f32 v[124:125], v[124:125], v[4:5] op_sel:[0,1] op_sel_hi:[1,1]
    v_pk_mul_f32 v[126:127], v[126:127], v[4:5] op_sel:[0,1] op_sel_hi:[1,1]
    v_and_b32 v15, 31, v0
    v_lshlrev_b32 v15, 4, v15
    v_lshl_add_u32 v15, v10, 3, v15
    v_sub_u32 v15, 504, v15
    v_add_u32 v15, s34, v15
    v_cmp_eq_u32 vcc, 1, v10
    v_and_b32 v16, 33, v0
    v_cmp_eq_u32 s[54:55], 32, v16
    v_cvt_pk_bf16_f32 v20, v115, v114
    v_cvt_pk_bf16_f32 v21, v113, v112
    ds_write_b64 v15, v[20:21] offset:3584
    v_cvt_pk_bf16_f32 v22, v118, v117
    v_cvt_pk_bf16_f32 v23, v116, v116
    ds_write_b64 v15, v[22:23] offset:3072
    v_cndmask_b32 v30, v120, v121, vcc
    v_cvt_pk_bf16_f32 v24, v121, v30
    v_cvt_pk_bf16_f32 v25, v120, v120
    ds_write_b64 v15, v[24:25] offset:2560
    v_cndmask_b32 v30, v122, v123, vcc
    v_cvt_pk_bf16_f32 v26, v123, v30
    v_cvt_pk_bf16_f32 v27, v122, v122
    ds_write_b64 v15, v[26:27] offset:2048
    v_mov_b32 v32, v124
    v_mov_b32 v36, v124
    v_mov_b32 v33, v125
    v_mov_b32 v37, v125
    v_mov_b32 v34, v126
    v_mov_b32 v38, v126
    v_mov_b32 v35, v127
    v_mov_b32 v39, v127
    s_nop 1
    v_permlane32_swap_b32 v32, v36
    v_permlane32_swap_b32 v33, v37
    v_permlane32_swap_b32 v34, v38
    v_permlane32_swap_b32 v35, v39
    v_cndmask_b32 v30, v124, v32, s[54:55]
    v_cvt_pk_bf16_f32 v40, v124, v124
    v_cvt_pk_bf16_f32 v41, v124, v30
    ds_write_b64 v15, v[40:41] offset:1536
    v_cndmask_b32 v30, v125, v33, s[54:55]
    v_cvt_pk_bf16_f32 v42, v125, v125
    v_cvt_pk_bf16_f32 v43, v125, v30
    ds_write_b64 v15, v[42:43] offset:1024
    v_cndmask_b32 v30, v126, v34, s[54:55]
    v_cvt_pk_bf16_f32 v44, v126, v126
    v_cvt_pk_bf16_f32 v45, v126, v30
    ds_write_b64 v15, v[44:45] offset:512
    v_cndmask_b32 v30, v127, v35, s[54:55]
    v_cvt_pk_bf16_f32 v46, v127, v127
    v_cvt_pk_bf16_f32 v47, v127, v30
    ds_write_b64 v15, v[46:47] offset:0
    v_and_b32 v1, 15, v0
    v_lshrrev_b32 v2, 4, v0
    v_mul_u32_u24 v16, 4160, v2
    v_lshl_add_u32 v16, v1, 2, v16
    v_add_u32 v16, s34, v16
    v_mov_b32 v17, 0
    ds_write_b32 v16, v17 offset:4096
    v_lshl_add_u32 v16, v0, 4, s34
    ds_read_b128 v[128:131], v16 offset:0
    ds_read_b64 v[132:133], v16 offset:16
    ds_read_b128 v[136:139], v16 offset:1024
    ds_read_b64 v[140:141], v16 offset:1040
    ds_read_b128 v[144:147], v16 offset:2048
    ds_read_b64 v[148:149], v16 offset:2064
    ds_read_b128 v[152:155], v16 offset:3072
    ds_read_b64 v[156:157], v16 offset:3088
    s_waitcnt lgkmcnt(6)
    v_alignbit_b32 v160, v129, v128, 16
    v_alignbit_b32 v161, v130, v129, 16
    v_alignbit_b32 v162, v131, v130, 16
    v_alignbit_b32 v163, v132, v131, 16
    ds_write_b128 v16, v[160:163] offset:4160
    v_mov_b32 v164, v129
    v_mov_b32 v165, v130
    v_mov_b32 v166, v131
    v_mov_b32 v167, v132
    ds_write_b128 v16, v[164:167] offset:8320
    v_alignbit_b32 v168, v130, v129, 16
    v_alignbit_b32 v169, v131, v130, 16
    v_alignbit_b32 v170, v132, v131, 16
    v_alignbit_b32 v171, v133, v132, 16
    ds_write_b128 v16, v[168:171] offset:12480
    s_waitcnt lgkmcnt(7)
    v_alignbit_b32 v172, v137, v136, 16
    v_alignbit_b32 v173, v138, v137, 16
    v_alignbit_b32 v174, v139, v138, 16
    v_alignbit_b32 v175, v140, v139, 16
    ds_write_b128 v16, v[172:175] offset:5184
    v_mov_b32 v176, v137
    v_mov_b32 v177, v138
    v_mov_b32 v178, v139
    v_mov_b32 v179, v140
    ds_write_b128 v16, v[176:179] offset:9344
    v_alignbit_b32 v180, v138, v137, 16
    v_alignbit_b32 v181, v139, v138, 16
    v_alignbit_b32 v182, v140, v139, 16
    v_alignbit_b32 v183, v141, v140, 16
    ds_write_b128 v16, v[180:183] offset:13504
    s_waitcnt lgkmcnt(8)
    v_alignbit_b32 v160, v145, v144, 16
    v_alignbit_b32 v161, v146, v145, 16
    v_alignbit_b32 v162, v147, v146, 16
    v_alignbit_b32 v163, v148, v147, 16
    ds_write_b128 v16, v[160:163] offset:6208
    v_mov_b32 v164, v145
    v_mov_b32 v165, v146
    v_mov_b32 v166, v147
    v_mov_b32 v167, v148
    ds_write_b128 v16, v[164:167] offset:10368
    v_alignbit_b32 v168, v146, v145, 16
    v_alignbit_b32 v169, v147, v146, 16
    v_alignbit_b32 v170, v148, v147, 16
    v_alignbit_b32 v171, v149, v148, 16
    ds_write_b128 v16, v[168:171] offset:14528
    s_waitcnt lgkmcnt(9)
    v_alignbit_b32 v172, v153, v152, 16
    v_alignbit_b32 v173, v154, v153, 16
    v_alignbit_b32 v174, v155, v154, 16
    v_alignbit_b32 v175, v156, v155, 16
    ds_write_b128 v16, v[172:175] offset:7232
    v_mov_b32 v176, v153
    v_mov_b32 v177, v154
    v_mov_b32 v178, v155
    v_mov_b32 v179, v156
    ds_write_b128 v16, v[176:179] offset:11392
    v_alignbit_b32 v180, v154, v153, 16
    v_alignbit_b32 v181, v155, v154, 16
    v_alignbit_b32 v182, v156, v155, 16
    v_alignbit_b32 v183, v157, v156, 16
    ds_write_b128 v16, v[180:183] offset:15552
    v_lshlrev_b32 v11, 5, v1
    v_lshl_add_u32 v14, v2, 4, v11
    v_add_u32 v14, s33, v14
    v_lshl_add_u32 v11, v2, 3, v11
    v_add_u32 v11, s33, v11
    v_sub_u32 v15, 15, v1
    v_and_b32 v16, 3, v15
    v_mul_u32_u24 v16, 4158, v16
    v_lshl_add_u32 v16, v15, 1, v16
    v_lshl_add_u32 v16, v2, 4, v16
    v_add_u32 v16, s34, v16
    s_bfe_u32 s54, s49, 0x10001
    s_bfe_u32 s55, s49, 0x10003
    s_lshl_b32 s55, s55, 1
    s_or_b32 s54, s54, s55
    v_lshrrev_b32 v20, 2, v1
    v_and_b32 v21, 1, v2
    v_lshl_add_u32 v20, v21, 2, v20
    v_mul_u32_u24 v20, 73728, v20
    v_and_b32 v21, 3, v1
    v_xor_b32 v21, s54, v21
    v_lshl_add_u32 v20, v21, 5, v20
    v_lshl_add_u32 v20, v10, 4, v20
    s_lshl_b32 s29, s49, 7
    s_add_u32 s29, s29, 7602176
    v_lshlrev_b32 v194, 16, v194
    s_lshl_b32 s53, s6, 5
    s_add_u32 s53, s53, 104448
    v_mov_b32 v22, s53
    v_readfirstlane_b32 s36, v194
    ds_read_b64 v[128:129], v16 offset:4032
    ds_read_b64 v[130:131], v16 offset:4040
    ds_read_b64 v[132:133], v16 offset:3520
    ds_read_b64 v[134:135], v16 offset:3528
    ds_read_b64 v[136:137], v16 offset:3008
    ds_read_b64 v[138:139], v16 offset:3016
    ds_read_b64 v[140:141], v16 offset:2496
    ds_read_b64 v[142:143], v16 offset:2504
    ds_read_b64 v[144:145], v16 offset:1984
    ds_read_b64 v[146:147], v16 offset:1992
    ds_read_b64 v[148:149], v16 offset:1472
    ds_read_b64 v[150:151], v16 offset:1480
    ds_read_b64 v[152:153], v16 offset:960
    ds_read_b64 v[154:155], v16 offset:968
    ds_read_b64 v[156:157], v16 offset:448
    ds_read_b64 v[158:159], v16 offset:456
    s_barrier
    ds_read_b128 v[160:163], v14 offset:480
    ds_read_b128 v[164:167], v14 offset:992
    ds_read_b128 v[168:171], v14 offset:1504
    ds_read_b128 v[172:175], v14 offset:2016
    ds_read_b128 v[176:179], v14 offset:2528
    ds_read_b128 v[180:183], v14 offset:3040
    ds_read_b128 v[184:187], v14 offset:3552
    ds_read_b128 v[188:191], v14 offset:4064
    ds_read_b32 v22, v22
    .p2align 0x5+1
AL_off1:
    s_waitcnt lgkmcnt(0)
    v_mfma_f32_16x16x32_bf16 v[32:35], v[128:131], v[160:163], 0
    ds_read_b128 v[224:227], v14 offset:416
    v_mfma_f32_16x16x32_bf16 v[36:39], v[128:131], v[164:167], 0
    ds_read_b128 v[228:231], v14 offset:928
    v_mfma_f32_16x16x32_bf16 v[40:43], v[128:131], v[168:171], 0
    ds_read_b128 v[232:235], v14 offset:1440
    v_mfma_f32_16x16x32_bf16 v[44:47], v[128:131], v[172:175], 0
    ds_read_b128 v[236:239], v14 offset:1952
    v_mfma_f32_16x16x32_bf16 v[48:51], v[128:131], v[176:179], 0
    ds_read_b128 v[240:243], v14 offset:2464
    v_mfma_f32_16x16x32_bf16 v[52:55], v[128:131], v[180:183], 0
    ds_read_b128 v[244:247], v14 offset:2976
    v_mfma_f32_16x16x32_bf16 v[56:59], v[128:131], v[184:187], 0
    ds_read_b128 v[248:251], v14 offset:3488
    v_mfma_f32_16x16x32_bf16 v[60:63], v[128:131], v[188:191], 0
    ds_read_b128 v[252:255], v14 offset:4000
    v_mfma_f32_16x16x32_bf16 v[36:39], v[132:135], v[160:163], v[36:39]
    ds_read_b64 v[192:193], v16 offset:3968
    v_mfma_f32_16x16x32_bf16 v[40:43], v[132:135], v[164:167], v[40:43]
    ds_read_b64 v[194:195], v16 offset:3976
    v_mfma_f32_16x16x32_bf16 v[44:47], v[132:135], v[168:171], v[44:47]
    ds_read_b64 v[196:197], v16 offset:3456
    v_mfma_f32_16x16x32_bf16 v[48:51], v[132:135], v[172:175], v[48:51]
    ds_read_b64 v[198:199], v16 offset:3464
    v_mfma_f32_16x16x32_bf16 v[52:55], v[132:135], v[176:179], v[52:55]
    ds_read_b64 v[200:201], v16 offset:2944
    v_mfma_f32_16x16x32_bf16 v[56:59], v[132:135], v[180:183], v[56:59]
    ds_read_b64 v[202:203], v16 offset:2952
    v_mfma_f32_16x16x32_bf16 v[60:63], v[132:135], v[184:187], v[60:63]
    ds_read_b64 v[204:205], v16 offset:2432
    v_mfma_f32_16x16x32_bf16 v[40:43], v[136:139], v[160:163], v[40:43]
    ds_read_b64 v[206:207], v16 offset:2440
    v_mfma_f32_16x16x32_bf16 v[44:47], v[136:139], v[164:167], v[44:47]
    ds_read_b64 v[208:209], v16 offset:1920
    v_mfma_f32_16x16x32_bf16 v[48:51], v[136:139], v[168:171], v[48:51]
    ds_read_b64 v[210:211], v16 offset:1928
    v_mfma_f32_16x16x32_bf16 v[52:55], v[136:139], v[172:175], v[52:55]
    ds_read_b64 v[212:213], v16 offset:1408
    v_mfma_f32_16x16x32_bf16 v[56:59], v[136:139], v[176:179], v[56:59]
    ds_read_b64 v[214:215], v16 offset:1416
    v_mfma_f32_16x16x32_bf16 v[60:63], v[136:139], v[180:183], v[60:63]
    ds_read_b64 v[216:217], v16 offset:896
    v_mfma_f32_16x16x32_bf16 v[44:47], v[140:143], v[160:163], v[44:47]
    ds_read_b64 v[218:219], v16 offset:904
    v_mfma_f32_16x16x32_bf16 v[48:51], v[140:143], v[164:167], v[48:51]
    ds_read_b64 v[220:221], v16 offset:384
    v_mfma_f32_16x16x32_bf16 v[52:55], v[140:143], v[168:171], v[52:55]
    ds_read_b64 v[222:223], v16 offset:392
    v_mfma_f32_16x16x32_bf16 v[56:59], v[140:143], v[172:175], v[56:59]
    ds_read_b64 v[64:65], v11 offset:512
    v_mfma_f32_16x16x32_bf16 v[60:63], v[140:143], v[176:179], v[60:63]
    ds_read_b64 v[66:67], v11 offset:4608
    v_mfma_f32_16x16x32_bf16 v[48:51], v[144:147], v[160:163], v[48:51]
    ds_read_b64 v[68:69], v11 offset:1024
    v_mfma_f32_16x16x32_bf16 v[52:55], v[144:147], v[164:167], v[52:55]
    ds_read_b64 v[70:71], v11 offset:5120
    v_mfma_f32_16x16x32_bf16 v[56:59], v[144:147], v[168:171], v[56:59]
    ds_read_b64 v[72:73], v11 offset:1536
    v_mfma_f32_16x16x32_bf16 v[60:63], v[144:147], v[172:175], v[60:63]
    ds_read_b64 v[74:75], v11 offset:5632
    v_mfma_f32_16x16x32_bf16 v[52:55], v[148:151], v[160:163], v[52:55]
    ds_read_b64 v[76:77], v11 offset:2048
    v_mfma_f32_16x16x32_bf16 v[56:59], v[148:151], v[164:167], v[56:59]
    ds_read_b64 v[78:79], v11 offset:6144
    v_mfma_f32_16x16x32_bf16 v[60:63], v[148:151], v[168:171], v[60:63]
    v_mfma_f32_16x16x32_bf16 v[56:59], v[152:155], v[160:163], v[56:59]
    v_mfma_f32_16x16x32_bf16 v[60:63], v[152:155], v[164:167], v[60:63]
    v_mfma_f32_16x16x32_bf16 v[60:63], v[156:159], v[160:163], v[60:63]
    s_waitcnt lgkmcnt(0)
    v_mfma_f32_16x16x32_bf16 v[32:35], v[192:195], v[224:227], v[32:35]
    ds_read_b128 v[160:163], v14 offset:352
    v_mfma_f32_16x16x32_bf16 v[36:39], v[192:195], v[228:231], v[36:39]
    ds_read_b128 v[164:167], v14 offset:864
    v_mfma_f32_16x16x32_bf16 v[40:43], v[192:195], v[232:235], v[40:43]
    ds_read_b128 v[168:171], v14 offset:1376
    v_mfma_f32_16x16x32_bf16 v[44:47], v[192:195], v[236:239], v[44:47]
    ds_read_b128 v[172:175], v14 offset:1888
    v_mfma_f32_16x16x32_bf16 v[48:51], v[192:195], v[240:243], v[48:51]
    ds_read_b128 v[176:179], v14 offset:2400
    v_mfma_f32_16x16x32_bf16 v[52:55], v[192:195], v[244:247], v[52:55]
    ds_read_b128 v[180:183], v14 offset:2912
    v_mfma_f32_16x16x32_bf16 v[56:59], v[192:195], v[248:251], v[56:59]
    ds_read_b128 v[184:187], v14 offset:3424
    v_mfma_f32_16x16x32_bf16 v[60:63], v[192:195], v[252:255], v[60:63]
    ds_read_b128 v[188:191], v14 offset:3936
    v_mfma_f32_16x16x32_bf16 v[36:39], v[196:199], v[224:227], v[36:39]
    ds_read_b64 v[128:129], v16 offset:3904
    v_mfma_f32_16x16x32_bf16 v[40:43], v[196:199], v[228:231], v[40:43]
    ds_read_b64 v[130:131], v16 offset:3912
    v_mfma_f32_16x16x32_bf16 v[44:47], v[196:199], v[232:235], v[44:47]
    ds_read_b64 v[132:133], v16 offset:3392
    v_mfma_f32_16x16x32_bf16 v[48:51], v[196:199], v[236:239], v[48:51]
    ds_read_b64 v[134:135], v16 offset:3400
    v_mfma_f32_16x16x32_bf16 v[52:55], v[196:199], v[240:243], v[52:55]
    ds_read_b64 v[136:137], v16 offset:2880
    v_mfma_f32_16x16x32_bf16 v[56:59], v[196:199], v[244:247], v[56:59]
    ds_read_b64 v[138:139], v16 offset:2888
    v_mfma_f32_16x16x32_bf16 v[60:63], v[196:199], v[248:251], v[60:63]
    ds_read_b64 v[140:141], v16 offset:2368
    v_mfma_f32_16x16x32_bf16 v[40:43], v[200:203], v[224:227], v[40:43]
    ds_read_b64 v[142:143], v16 offset:2376
    v_mfma_f32_16x16x32_bf16 v[44:47], v[200:203], v[228:231], v[44:47]
    ds_read_b64 v[144:145], v16 offset:1856
    v_mfma_f32_16x16x32_bf16 v[48:51], v[200:203], v[232:235], v[48:51]
    ds_read_b64 v[146:147], v16 offset:1864
    v_mfma_f32_16x16x32_bf16 v[52:55], v[200:203], v[236:239], v[52:55]
    ds_read_b64 v[148:149], v16 offset:1344
    v_mfma_f32_16x16x32_bf16 v[56:59], v[200:203], v[240:243], v[56:59]
    ds_read_b64 v[150:151], v16 offset:1352
    v_mfma_f32_16x16x32_bf16 v[60:63], v[200:203], v[244:247], v[60:63]
    ds_read_b64 v[152:153], v16 offset:832
    v_mfma_f32_16x16x32_bf16 v[44:47], v[204:207], v[224:227], v[44:47]
    ds_read_b64 v[154:155], v16 offset:840
    v_mfma_f32_16x16x32_bf16 v[48:51], v[204:207], v[228:231], v[48:51]
    ds_read_b64 v[156:157], v16 offset:320
    v_mfma_f32_16x16x32_bf16 v[52:55], v[204:207], v[232:235], v[52:55]
    ds_read_b64 v[158:159], v16 offset:328
    v_mfma_f32_16x16x32_bf16 v[56:59], v[204:207], v[236:239], v[56:59]
    ds_read_b64 v[80:81], v11 offset:2560
    v_mfma_f32_16x16x32_bf16 v[60:63], v[204:207], v[240:243], v[60:63]
    ds_read_b64 v[82:83], v11 offset:6656
    v_mfma_f32_16x16x32_bf16 v[48:51], v[208:211], v[224:227], v[48:51]
    ds_read_b64 v[84:85], v11 offset:3072
    v_mfma_f32_16x16x32_bf16 v[52:55], v[208:211], v[228:231], v[52:55]
    ds_read_b64 v[86:87], v11 offset:7168
    v_mfma_f32_16x16x32_bf16 v[56:59], v[208:211], v[232:235], v[56:59]
    ds_read_b64 v[88:89], v11 offset:3584
    v_mfma_f32_16x16x32_bf16 v[60:63], v[208:211], v[236:239], v[60:63]
    ds_read_b64 v[90:91], v11 offset:7680
    v_mfma_f32_16x16x32_bf16 v[52:55], v[212:215], v[224:227], v[52:55]
    ds_read_b64 v[92:93], v11 offset:4096
    v_mfma_f32_16x16x32_bf16 v[56:59], v[212:215], v[228:231], v[56:59]
    ds_read_b64 v[94:95], v11 offset:8192
    v_mfma_f32_16x16x32_bf16 v[60:63], v[212:215], v[232:235], v[60:63]
    v_mfma_f32_16x16x32_bf16 v[56:59], v[216:219], v[224:227], v[56:59]
    v_mfma_f32_16x16x32_bf16 v[60:63], v[216:219], v[228:231], v[60:63]
    v_mfma_f32_16x16x32_bf16 v[60:63], v[220:223], v[224:227], v[60:63]
    s_waitcnt lgkmcnt(0)
    v_mfma_f32_16x16x32_bf16 v[32:35], v[128:131], v[160:163], v[32:35]
    ds_read_b128 v[224:227], v14 offset:288
    v_lshlrev_b32 v96, 16, v64
    v_mfma_f32_16x16x32_bf16 v[36:39], v[128:131], v[164:167], v[36:39]
    ds_read_b128 v[228:231], v14 offset:800
    v_and_b32 v97, 0xffff0000, v64
    v_mfma_f32_16x16x32_bf16 v[40:43], v[128:131], v[168:171], v[40:43]
    ds_read_b128 v[232:235], v14 offset:1312
    v_lshlrev_b32 v98, 16, v65
    v_mfma_f32_16x16x32_bf16 v[44:47], v[128:131], v[172:175], v[44:47]
    ds_read_b128 v[236:239], v14 offset:1824
    v_and_b32 v99, 0xffff0000, v65
    v_mfma_f32_16x16x32_bf16 v[48:51], v[128:131], v[176:179], v[48:51]
    ds_read_b128 v[240:243], v14 offset:2336
    v_mul_f32 v96, s36, v96
    v_mfma_f32_16x16x32_bf16 v[52:55], v[128:131], v[180:183], v[52:55]
    ds_read_b128 v[244:247], v14 offset:2848
    v_mul_f32 v97, s36, v97
    v_mfma_f32_16x16x32_bf16 v[56:59], v[128:131], v[184:187], v[56:59]
    ds_read_b128 v[248:251], v14 offset:3360
    v_mul_f32 v98, s36, v98
    v_mfma_f32_16x16x32_bf16 v[60:63], v[128:131], v[188:191], v[60:63]
    ds_read_b128 v[252:255], v14 offset:3872
    v_mul_f32 v99, s36, v99
    v_mfma_f32_16x16x32_bf16 v[36:39], v[132:135], v[160:163], v[36:39]
    ds_read_b64 v[192:193], v16 offset:3840
    v_cvt_pk_bf16_f32 v64, v96, v97
    v_mfma_f32_16x16x32_bf16 v[40:43], v[132:135], v[164:167], v[40:43]
    ds_read_b64 v[194:195], v16 offset:3848
    v_cvt_pk_bf16_f32 v65, v98, v99
    v_mfma_f32_16x16x32_bf16 v[44:47], v[132:135], v[168:171], v[44:47]
    ds_read_b64 v[196:197], v16 offset:3328
    v_lshlrev_b32 v96, 16, v64
    v_mfma_f32_16x16x32_bf16 v[48:51], v[132:135], v[172:175], v[48:51]
    ds_read_b64 v[198:199], v16 offset:3336
    v_and_b32 v97, 0xffff0000, v64
    v_mfma_f32_16x16x32_bf16 v[52:55], v[132:135], v[176:179], v[52:55]
    ds_read_b64 v[200:201], v16 offset:2816
    v_lshlrev_b32 v98, 16, v65
    v_mfma_f32_16x16x32_bf16 v[56:59], v[132:135], v[180:183], v[56:59]
    ds_read_b64 v[202:203], v16 offset:2824
    v_and_b32 v99, 0xffff0000, v65
    v_mfma_f32_16x16x32_bf16 v[60:63], v[132:135], v[184:187], v[60:63]
    ds_read_b64 v[204:205], v16 offset:2304
    v_lshlrev_b32 v100, 16, v68
    v_mfma_f32_16x16x32_bf16 v[40:43], v[136:139], v[160:163], v[40:43]
    ds_read_b64 v[206:207], v16 offset:2312
    v_and_b32 v101, 0xffff0000, v68
    v_mfma_f32_16x16x32_bf16 v[44:47], v[136:139], v[164:167], v[44:47]
    ds_read_b64 v[208:209], v16 offset:1792
    v_lshlrev_b32 v102, 16, v69
    v_mfma_f32_16x16x32_bf16 v[48:51], v[136:139], v[168:171], v[48:51]
    ds_read_b64 v[210:211], v16 offset:1800
    v_and_b32 v103, 0xffff0000, v69
    v_mfma_f32_16x16x32_bf16 v[52:55], v[136:139], v[172:175], v[52:55]
    ds_read_b64 v[212:213], v16 offset:1280
    v_mul_f32 v100, s36, v100
    v_mfma_f32_16x16x32_bf16 v[56:59], v[136:139], v[176:179], v[56:59]
    ds_read_b64 v[214:215], v16 offset:1288
    v_mul_f32 v101, s36, v101
    v_mfma_f32_16x16x32_bf16 v[60:63], v[136:139], v[180:183], v[60:63]
    ds_read_b64 v[216:217], v16 offset:768
    v_mul_f32 v102, s36, v102
    v_mfma_f32_16x16x32_bf16 v[44:47], v[140:143], v[160:163], v[44:47]
    ds_read_b64 v[218:219], v16 offset:776
    v_mul_f32 v103, s36, v103
    v_mfma_f32_16x16x32_bf16 v[48:51], v[140:143], v[164:167], v[48:51]
    ds_read_b64 v[220:221], v16 offset:256
    v_cvt_pk_bf16_f32 v68, v100, v101
    v_mfma_f32_16x16x32_bf16 v[52:55], v[140:143], v[168:171], v[52:55]
    ds_read_b64 v[222:223], v16 offset:264
    v_cvt_pk_bf16_f32 v69, v102, v103
    v_mfma_f32_16x16x32_bf16 v[56:59], v[140:143], v[172:175], v[56:59]
    v_lshlrev_b32 v100, 16, v68
    v_and_b32 v101, 0xffff0000, v68
    v_mfma_f32_16x16x32_bf16 v[60:63], v[140:143], v[176:179], v[60:63]
    v_lshlrev_b32 v102, 16, v69
    v_and_b32 v103, 0xffff0000, v69
    v_mfma_f32_16x16x32_bf16 v[48:51], v[144:147], v[160:163], v[48:51]
    v_lshlrev_b32 v104, 16, v72
    v_and_b32 v105, 0xffff0000, v72
    v_mfma_f32_16x16x32_bf16 v[52:55], v[144:147], v[164:167], v[52:55]
    v_lshlrev_b32 v106, 16, v73
    v_and_b32 v107, 0xffff0000, v73
    v_mfma_f32_16x16x32_bf16 v[56:59], v[144:147], v[168:171], v[56:59]
    v_mul_f32 v104, s36, v104
    v_mul_f32 v105, s36, v105
    v_mfma_f32_16x16x32_bf16 v[60:63], v[144:147], v[172:175], v[60:63]
    v_mul_f32 v106, s36, v106
    v_mul_f32 v107, s36, v107
    v_mfma_f32_16x16x32_bf16 v[52:55], v[148:151], v[160:163], v[52:55]
    v_cvt_pk_bf16_f32 v72, v104, v105
    v_cvt_pk_bf16_f32 v73, v106, v107
    v_mfma_f32_16x16x32_bf16 v[56:59], v[148:151], v[164:167], v[56:59]
    v_lshlrev_b32 v104, 16, v72
    v_and_b32 v105, 0xffff0000, v72
    v_mfma_f32_16x16x32_bf16 v[60:63], v[148:151], v[168:171], v[60:63]
    v_lshlrev_b32 v106, 16, v73
    v_and_b32 v107, 0xffff0000, v73
    v_mfma_f32_16x16x32_bf16 v[56:59], v[152:155], v[160:163], v[56:59]
    v_lshlrev_b32 v108, 16, v76
    v_and_b32 v109, 0xffff0000, v76
    v_mfma_f32_16x16x32_bf16 v[60:63], v[152:155], v[164:167], v[60:63]
    v_lshlrev_b32 v110, 16, v77
    v_and_b32 v111, 0xffff0000, v77
    v_mfma_f32_16x16x32_bf16 v[60:63], v[156:159], v[160:163], v[60:63]
    v_mul_f32 v108, s36, v108
    v_mul_f32 v109, s36, v109
    s_waitcnt lgkmcnt(0)
    v_mfma_f32_16x16x32_bf16 v[32:35], v[192:195], v[224:227], v[32:35]
    ds_read_b128 v[160:163], v14 offset:224
    v_mul_f32 v110, s36, v110
    v_mfma_f32_16x16x32_bf16 v[36:39], v[192:195], v[228:231], v[36:39]
    ds_read_b128 v[164:167], v14 offset:736
    v_mul_f32 v111, s36, v111
    v_mfma_f32_16x16x32_bf16 v[40:43], v[192:195], v[232:235], v[40:43]
    ds_read_b128 v[168:171], v14 offset:1248
    v_cvt_pk_bf16_f32 v76, v108, v109
    v_mfma_f32_16x16x32_bf16 v[44:47], v[192:195], v[236:239], v[44:47]
    ds_read_b128 v[172:175], v14 offset:1760
    v_cvt_pk_bf16_f32 v77, v110, v111
    v_mfma_f32_16x16x32_bf16 v[48:51], v[192:195], v[240:243], v[48:51]
    ds_read_b128 v[176:179], v14 offset:2272
    v_lshlrev_b32 v108, 16, v76
    v_mfma_f32_16x16x32_bf16 v[52:55], v[192:195], v[244:247], v[52:55]
    ds_read_b128 v[180:183], v14 offset:2784
    v_and_b32 v109, 0xffff0000, v76
    v_mfma_f32_16x16x32_bf16 v[56:59], v[192:195], v[248:251], v[56:59]
    ds_read_b128 v[184:187], v14 offset:3296
    v_lshlrev_b32 v110, 16, v77
    v_mfma_f32_16x16x32_bf16 v[60:63], v[192:195], v[252:255], v[60:63]
    ds_read_b128 v[188:191], v14 offset:3808
    v_and_b32 v111, 0xffff0000, v77
    v_mfma_f32_16x16x32_bf16 v[36:39], v[196:199], v[224:227], v[36:39]
    ds_read_b64 v[128:129], v16 offset:3776
    v_lshlrev_b32 v112, 16, v80
    v_mfma_f32_16x16x32_bf16 v[40:43], v[196:199], v[228:231], v[40:43]
    ds_read_b64 v[130:131], v16 offset:3784
    v_and_b32 v113, 0xffff0000, v80
    v_mfma_f32_16x16x32_bf16 v[44:47], v[196:199], v[232:235], v[44:47]
    ds_read_b64 v[132:133], v16 offset:3264
    v_lshlrev_b32 v114, 16, v81
    v_mfma_f32_16x16x32_bf16 v[48:51], v[196:199], v[236:239], v[48:51]
    ds_read_b64 v[134:135], v16 offset:3272
    v_and_b32 v115, 0xffff0000, v81
    v_mfma_f32_16x16x32_bf16 v[52:55], v[196:199], v[240:243], v[52:55]
    ds_read_b64 v[136:137], v16 offset:2752
    v_mul_f32 v112, s36, v112
    v_mfma_f32_16x16x32_bf16 v[56:59], v[196:199], v[244:247], v[56:59]
    ds_read_b64 v[138:139], v16 offset:2760
    v_mul_f32 v113, s36, v113
    v_mfma_f32_16x16x32_bf16 v[60:63], v[196:199], v[248:251], v[60:63]
    ds_read_b64 v[140:141], v16 offset:2240
    v_mul_f32 v114, s36, v114
    v_mfma_f32_16x16x32_bf16 v[40:43], v[200:203], v[224:227], v[40:43]
    ds_read_b64 v[142:143], v16 offset:2248
    v_mul_f32 v115, s36, v115
    v_mfma_f32_16x16x32_bf16 v[44:47], v[200:203], v[228:231], v[44:47]
    ds_read_b64 v[144:145], v16 offset:1728
    v_cvt_pk_bf16_f32 v80, v112, v113
    v_mfma_f32_16x16x32_bf16 v[48:51], v[200:203], v[232:235], v[48:51]
    ds_read_b64 v[146:147], v16 offset:1736
    v_cvt_pk_bf16_f32 v81, v114, v115
    v_mfma_f32_16x16x32_bf16 v[52:55], v[200:203], v[236:239], v[52:55]
    ds_read_b64 v[148:149], v16 offset:1216
    v_lshlrev_b32 v112, 16, v80
    v_mfma_f32_16x16x32_bf16 v[56:59], v[200:203], v[240:243], v[56:59]
    ds_read_b64 v[150:151], v16 offset:1224
    v_and_b32 v113, 0xffff0000, v80
    v_mfma_f32_16x16x32_bf16 v[60:63], v[200:203], v[244:247], v[60:63]
    ds_read_b64 v[152:153], v16 offset:704
    v_lshlrev_b32 v114, 16, v81
    v_mfma_f32_16x16x32_bf16 v[44:47], v[204:207], v[224:227], v[44:47]
    ds_read_b64 v[154:155], v16 offset:712
    v_and_b32 v115, 0xffff0000, v81
    v_mfma_f32_16x16x32_bf16 v[48:51], v[204:207], v[228:231], v[48:51]
    ds_read_b64 v[156:157], v16 offset:192
    v_lshlrev_b32 v116, 16, v84
    v_mfma_f32_16x16x32_bf16 v[52:55], v[204:207], v[232:235], v[52:55]
    ds_read_b64 v[158:159], v16 offset:200
    v_and_b32 v117, 0xffff0000, v84
    v_mfma_f32_16x16x32_bf16 v[56:59], v[204:207], v[236:239], v[56:59]
    v_lshlrev_b32 v118, 16, v85
    v_and_b32 v119, 0xffff0000, v85
    v_mfma_f32_16x16x32_bf16 v[60:63], v[204:207], v[240:243], v[60:63]
    v_mul_f32 v116, s36, v116
    v_mul_f32 v117, s36, v117
    v_mfma_f32_16x16x32_bf16 v[48:51], v[208:211], v[224:227], v[48:51]
    v_mul_f32 v118, s36, v118
    v_mul_f32 v119, s36, v119
    v_mfma_f32_16x16x32_bf16 v[52:55], v[208:211], v[228:231], v[52:55]
    v_cvt_pk_bf16_f32 v84, v116, v117
    v_cvt_pk_bf16_f32 v85, v118, v119
    v_mfma_f32_16x16x32_bf16 v[56:59], v[208:211], v[232:235], v[56:59]
    v_lshlrev_b32 v116, 16, v84
    v_and_b32 v117, 0xffff0000, v84
    v_mfma_f32_16x16x32_bf16 v[60:63], v[208:211], v[236:239], v[60:63]
    v_lshlrev_b32 v118, 16, v85
    v_and_b32 v119, 0xffff0000, v85
    v_mfma_f32_16x16x32_bf16 v[52:55], v[212:215], v[224:227], v[52:55]
    v_lshlrev_b32 v120, 16, v88
    v_and_b32 v121, 0xffff0000, v88
    v_mfma_f32_16x16x32_bf16 v[56:59], v[212:215], v[228:231], v[56:59]
    v_lshlrev_b32 v122, 16, v89
    v_and_b32 v123, 0xffff0000, v89
    v_mfma_f32_16x16x32_bf16 v[60:63], v[212:215], v[232:235], v[60:63]
    v_mul_f32 v120, s36, v120
    v_mul_f32 v121, s36, v121
    v_mfma_f32_16x16x32_bf16 v[56:59], v[216:219], v[224:227], v[56:59]
    v_mul_f32 v122, s36, v122
    v_mul_f32 v123, s36, v123
    v_mfma_f32_16x16x32_bf16 v[60:63], v[216:219], v[228:231], v[60:63]
    v_cvt_pk_bf16_f32 v88, v120, v121
    v_cvt_pk_bf16_f32 v89, v122, v123
    v_mfma_f32_16x16x32_bf16 v[60:63], v[220:223], v[224:227], v[60:63]
    v_lshlrev_b32 v120, 16, v88
    v_and_b32 v121, 0xffff0000, v88
    s_waitcnt lgkmcnt(0)
    v_mfma_f32_16x16x32_bf16 v[32:35], v[128:131], v[160:163], v[32:35]
    ds_read_b128 v[224:227], v14 offset:160
    v_lshlrev_b32 v122, 16, v89
    v_mfma_f32_16x16x32_bf16 v[36:39], v[128:131], v[164:167], v[36:39]
    ds_read_b128 v[228:231], v14 offset:672
    v_and_b32 v123, 0xffff0000, v89
    v_mfma_f32_16x16x32_bf16 v[40:43], v[128:131], v[168:171], v[40:43]
    ds_read_b128 v[232:235], v14 offset:1184
    v_lshlrev_b32 v124, 16, v92
    v_mfma_f32_16x16x32_bf16 v[44:47], v[128:131], v[172:175], v[44:47]
    ds_read_b128 v[236:239], v14 offset:1696
    v_and_b32 v125, 0xffff0000, v92
    v_mfma_f32_16x16x32_bf16 v[48:51], v[128:131], v[176:179], v[48:51]
    ds_read_b128 v[240:243], v14 offset:2208
    v_lshlrev_b32 v126, 16, v93
    v_mfma_f32_16x16x32_bf16 v[52:55], v[128:131], v[180:183], v[52:55]
    ds_read_b128 v[244:247], v14 offset:2720
    v_and_b32 v127, 0xffff0000, v93
    v_mfma_f32_16x16x32_bf16 v[56:59], v[128:131], v[184:187], v[56:59]
    ds_read_b128 v[248:251], v14 offset:3232
    v_mul_f32 v124, s36, v124
    v_mfma_f32_16x16x32_bf16 v[60:63], v[128:131], v[188:191], v[60:63]
    ds_read_b128 v[252:255], v14 offset:3744
    v_mul_f32 v125, s36, v125
    v_mfma_f32_16x16x32_bf16 v[36:39], v[132:135], v[160:163], v[36:39]
    ds_read_b64 v[192:193], v16 offset:3712
    v_mul_f32 v126, s36, v126
    v_mfma_f32_16x16x32_bf16 v[40:43], v[132:135], v[164:167], v[40:43]
    ds_read_b64 v[194:195], v16 offset:3720
    v_mul_f32 v127, s36, v127
    v_mfma_f32_16x16x32_bf16 v[44:47], v[132:135], v[168:171], v[44:47]
    ds_read_b64 v[196:197], v16 offset:3200
    v_cvt_pk_bf16_f32 v92, v124, v125
    v_mfma_f32_16x16x32_bf16 v[48:51], v[132:135], v[172:175], v[48:51]
    ds_read_b64 v[198:199], v16 offset:3208
    v_cvt_pk_bf16_f32 v93, v126, v127
    v_mfma_f32_16x16x32_bf16 v[52:55], v[132:135], v[176:179], v[52:55]
    ds_read_b64 v[200:201], v16 offset:2688
    v_lshlrev_b32 v124, 16, v92
    v_mfma_f32_16x16x32_bf16 v[56:59], v[132:135], v[180:183], v[56:59]
    ds_read_b64 v[202:203], v16 offset:2696
    v_and_b32 v125, 0xffff0000, v92
    v_mfma_f32_16x16x32_bf16 v[60:63], v[132:135], v[184:187], v[60:63]
    ds_read_b64 v[204:205], v16 offset:2176
    v_lshlrev_b32 v126, 16, v93
    v_mfma_f32_16x16x32_bf16 v[40:43], v[136:139], v[160:163], v[40:43]
    ds_read_b64 v[206:207], v16 offset:2184
    v_and_b32 v127, 0xffff0000, v93
    v_mfma_f32_16x16x32_bf16 v[44:47], v[136:139], v[164:167], v[44:47]
    ds_read_b64 v[208:209], v16 offset:1664
    v_mfma_f32_16x16x32_bf16 v[48:51], v[136:139], v[168:171], v[48:51]
    ds_read_b64 v[210:211], v16 offset:1672
    v_mfma_f32_16x16x32_bf16 v[52:55], v[136:139], v[172:175], v[52:55]
    ds_read_b64 v[212:213], v16 offset:1152
    v_mfma_f32_16x16x32_bf16 v[56:59], v[136:139], v[176:179], v[56:59]
    ds_read_b64 v[214:215], v16 offset:1160
    v_mfma_f32_16x16x32_bf16 v[60:63], v[136:139], v[180:183], v[60:63]
    ds_read_b64 v[216:217], v16 offset:640
    v_mfma_f32_16x16x32_bf16 v[44:47], v[140:143], v[160:163], v[44:47]
    ds_read_b64 v[218:219], v16 offset:648
    v_mfma_f32_16x16x32_bf16 v[48:51], v[140:143], v[164:167], v[48:51]
    ds_read_b64 v[220:221], v16 offset:128
    v_mfma_f32_16x16x32_bf16 v[52:55], v[140:143], v[168:171], v[52:55]
    ds_read_b64 v[222:223], v16 offset:136
    v_mfma_f32_16x16x32_bf16 v[56:59], v[140:143], v[172:175], v[56:59]
    v_mfma_f32_16x16x32_bf16 v[60:63], v[140:143], v[176:179], v[60:63]
    v_mfma_f32_16x16x32_bf16 v[48:51], v[144:147], v[160:163], v[48:51]
    v_mfma_f32_16x16x32_bf16 v[52:55], v[144:147], v[164:167], v[52:55]
    v_mfma_f32_16x16x32_bf16 v[56:59], v[144:147], v[168:171], v[56:59]
    v_mfma_f32_16x16x32_bf16 v[60:63], v[144:147], v[172:175], v[60:63]
    v_mfma_f32_16x16x32_bf16 v[52:55], v[148:151], v[160:163], v[52:55]
    v_mfma_f32_16x16x32_bf16 v[56:59], v[148:151], v[164:167], v[56:59]
    v_mfma_f32_16x16x32_bf16 v[60:63], v[148:151], v[168:171], v[60:63]
    v_mfma_f32_16x16x32_bf16 v[56:59], v[152:155], v[160:163], v[56:59]
    v_mfma_f32_16x16x32_bf16 v[60:63], v[152:155], v[164:167], v[60:63]
    v_mfma_f32_16x16x32_bf16 v[60:63], v[156:159], v[160:163], v[60:63]
    s_waitcnt lgkmcnt(0)
    v_mfma_f32_16x16x32_bf16 v[32:35], v[192:195], v[224:227], v[32:35]
    ds_read_b128 v[160:163], v14 offset:96
    v_mfma_f32_16x16x32_bf16 v[36:39], v[192:195], v[228:231], v[36:39]
    ds_read_b128 v[164:167], v14 offset:608
    v_mfma_f32_16x16x32_bf16 v[40:43], v[192:195], v[232:235], v[40:43]
    ds_read_b128 v[168:171], v14 offset:1120
    v_mfma_f32_16x16x32_bf16 v[44:47], v[192:195], v[236:239], v[44:47]
    ds_read_b128 v[172:175], v14 offset:1632
    v_mfma_f32_16x16x32_bf16 v[48:51], v[192:195], v[240:243], v[48:51]
    ds_read_b128 v[176:179], v14 offset:2144
    v_mfma_f32_16x16x32_bf16 v[52:55], v[192:195], v[244:247], v[52:55]
    ds_read_b128 v[180:183], v14 offset:2656
    v_mfma_f32_16x16x32_bf16 v[56:59], v[192:195], v[248:251], v[56:59]
    ds_read_b128 v[184:187], v14 offset:3168
    v_mfma_f32_16x16x32_bf16 v[60:63], v[192:195], v[252:255], v[60:63]
    ds_read_b128 v[188:191], v14 offset:3680
    v_mfma_f32_16x16x32_bf16 v[36:39], v[196:199], v[224:227], v[36:39]
    ds_read_b64 v[128:129], v16 offset:3648
    v_mfma_f32_16x16x32_bf16 v[40:43], v[196:199], v[228:231], v[40:43]
    ds_read_b64 v[130:131], v16 offset:3656
    v_mfma_f32_16x16x32_bf16 v[44:47], v[196:199], v[232:235], v[44:47]
    ds_read_b64 v[132:133], v16 offset:3136
    v_mfma_f32_16x16x32_bf16 v[48:51], v[196:199], v[236:239], v[48:51]
    ds_read_b64 v[134:135], v16 offset:3144
    v_mfma_f32_16x16x32_bf16 v[52:55], v[196:199], v[240:243], v[52:55]
    ds_read_b64 v[136:137], v16 offset:2624
    v_mfma_f32_16x16x32_bf16 v[56:59], v[196:199], v[244:247], v[56:59]
    ds_read_b64 v[138:139], v16 offset:2632
    v_mfma_f32_16x16x32_bf16 v[60:63], v[196:199], v[248:251], v[60:63]
    ds_read_b64 v[140:141], v16 offset:2112
    v_mfma_f32_16x16x32_bf16 v[40:43], v[200:203], v[224:227], v[40:43]
    ds_read_b64 v[142:143], v16 offset:2120
    v_mfma_f32_16x16x32_bf16 v[44:47], v[200:203], v[228:231], v[44:47]
    ds_read_b64 v[144:145], v16 offset:1600
    v_mfma_f32_16x16x32_bf16 v[48:51], v[200:203], v[232:235], v[48:51]
    ds_read_b64 v[146:147], v16 offset:1608
    v_mfma_f32_16x16x32_bf16 v[52:55], v[200:203], v[236:239], v[52:55]
    ds_read_b64 v[148:149], v16 offset:1088
    v_mfma_f32_16x16x32_bf16 v[56:59], v[200:203], v[240:243], v[56:59]
    ds_read_b64 v[150:151], v16 offset:1096
    v_mfma_f32_16x16x32_bf16 v[60:63], v[200:203], v[244:247], v[60:63]
    ds_read_b64 v[152:153], v16 offset:576
    v_mfma_f32_16x16x32_bf16 v[44:47], v[204:207], v[224:227], v[44:47]
    ds_read_b64 v[154:155], v16 offset:584
    v_mfma_f32_16x16x32_bf16 v[48:51], v[204:207], v[228:231], v[48:51]
    ds_read_b64 v[156:157], v16 offset:64
    v_mfma_f32_16x16x32_bf16 v[52:55], v[204:207], v[232:235], v[52:55]
    ds_read_b64 v[158:159], v16 offset:72
    v_mfma_f32_16x16x32_bf16 v[56:59], v[204:207], v[236:239], v[56:59]
    v_mfma_f32_16x16x32_bf16 v[60:63], v[204:207], v[240:243], v[60:63]
    v_mfma_f32_16x16x32_bf16 v[48:51], v[208:211], v[224:227], v[48:51]
    v_mfma_f32_16x16x32_bf16 v[52:55], v[208:211], v[228:231], v[52:55]
    v_mfma_f32_16x16x32_bf16 v[56:59], v[208:211], v[232:235], v[56:59]
    v_mfma_f32_16x16x32_bf16 v[60:63], v[208:211], v[236:239], v[60:63]
    v_mfma_f32_16x16x32_bf16 v[52:55], v[212:215], v[224:227], v[52:55]
    v_mfma_f32_16x16x32_bf16 v[56:59], v[212:215], v[228:231], v[56:59]
    v_mfma_f32_16x16x32_bf16 v[60:63], v[212:215], v[232:235], v[60:63]
    v_mfma_f32_16x16x32_bf16 v[56:59], v[216:219], v[224:227], v[56:59]
    v_mfma_f32_16x16x32_bf16 v[60:63], v[216:219], v[228:231], v[60:63]
    v_mfma_f32_16x16x32_bf16 v[60:63], v[220:223], v[224:227], v[60:63]
    s_waitcnt lgkmcnt(0)
    v_mfma_f32_16x16x32_bf16 v[32:35], v[128:131], v[160:163], v[32:35]
    ds_read_b128 v[224:227], v14 offset:32
    v_mfma_f32_16x16x32_bf16 v[36:39], v[128:131], v[164:167], v[36:39]
    ds_read_b128 v[228:231], v14 offset:544
    v_mfma_f32_16x16x32_bf16 v[40:43], v[128:131], v[168:171], v[40:43]
    ds_read_b128 v[232:235], v14 offset:1056
    v_mfma_f32_16x16x32_bf16 v[44:47], v[128:131], v[172:175], v[44:47]
    ds_read_b128 v[236:239], v14 offset:1568
    v_mfma_f32_16x16x32_bf16 v[48:51], v[128:131], v[176:179], v[48:51]
    ds_read_b128 v[240:243], v14 offset:2080
    v_mfma_f32_16x16x32_bf16 v[52:55], v[128:131], v[180:183], v[52:55]
    ds_read_b128 v[244:247], v14 offset:2592
    v_mfma_f32_16x16x32_bf16 v[56:59], v[128:131], v[184:187], v[56:59]
    ds_read_b128 v[248:251], v14 offset:3104
    v_mfma_f32_16x16x32_bf16 v[60:63], v[128:131], v[188:191], v[60:63]
    ds_read_b128 v[252:255], v14 offset:3616
    v_mfma_f32_16x16x32_bf16 v[36:39], v[132:135], v[160:163], v[36:39]
    ds_read_b64 v[192:193], v16 offset:3584
    v_mfma_f32_16x16x32_bf16 v[40:43], v[132:135], v[164:167], v[40:43]
    ds_read_b64 v[194:195], v16 offset:3592
    v_mfma_f32_16x16x32_bf16 v[44:47], v[132:135], v[168:171], v[44:47]
    ds_read_b64 v[196:197], v16 offset:3072
    v_mfma_f32_16x16x32_bf16 v[48:51], v[132:135], v[172:175], v[48:51]
    ds_read_b64 v[198:199], v16 offset:3080
    v_mfma_f32_16x16x32_bf16 v[52:55], v[132:135], v[176:179], v[52:55]
    ds_read_b64 v[200:201], v16 offset:2560
    v_mfma_f32_16x16x32_bf16 v[56:59], v[132:135], v[180:183], v[56:59]
    ds_read_b64 v[202:203], v16 offset:2568
    v_mfma_f32_16x16x32_bf16 v[60:63], v[132:135], v[184:187], v[60:63]
    ds_read_b64 v[204:205], v16 offset:2048
    v_mfma_f32_16x16x32_bf16 v[40:43], v[136:139], v[160:163], v[40:43]
    ds_read_b64 v[206:207], v16 offset:2056
    v_mfma_f32_16x16x32_bf16 v[44:47], v[136:139], v[164:167], v[44:47]
    ds_read_b64 v[208:209], v16 offset:1536
    v_mfma_f32_16x16x32_bf16 v[48:51], v[136:139], v[168:171], v[48:51]
    ds_read_b64 v[210:211], v16 offset:1544
    v_mfma_f32_16x16x32_bf16 v[52:55], v[136:139], v[172:175], v[52:55]
    ds_read_b64 v[212:213], v16 offset:1024
    v_mfma_f32_16x16x32_bf16 v[56:59], v[136:139], v[176:179], v[56:59]
    ds_read_b64 v[214:215], v16 offset:1032
    v_mfma_f32_16x16x32_bf16 v[60:63], v[136:139], v[180:183], v[60:63]
    ds_read_b64 v[216:217], v16 offset:512
    v_mfma_f32_16x16x32_bf16 v[44:47], v[140:143], v[160:163], v[44:47]
    ds_read_b64 v[218:219], v16 offset:520
    v_mfma_f32_16x16x32_bf16 v[48:51], v[140:143], v[164:167], v[48:51]
    ds_read_b64 v[220:221], v16 offset:0
    v_mfma_f32_16x16x32_bf16 v[52:55], v[140:143], v[168:171], v[52:55]
    ds_read_b64 v[222:223], v16 offset:8
    v_mfma_f32_16x16x32_bf16 v[56:59], v[140:143], v[172:175], v[56:59]
    v_mfma_f32_16x16x32_bf16 v[60:63], v[140:143], v[176:179], v[60:63]
    v_mfma_f32_16x16x32_bf16 v[48:51], v[144:147], v[160:163], v[48:51]
    v_mfma_f32_16x16x32_bf16 v[52:55], v[144:147], v[164:167], v[52:55]
    v_mfma_f32_16x16x32_bf16 v[56:59], v[144:147], v[168:171], v[56:59]
    v_mfma_f32_16x16x32_bf16 v[60:63], v[144:147], v[172:175], v[60:63]
    v_mfma_f32_16x16x32_bf16 v[52:55], v[148:151], v[160:163], v[52:55]
    v_mfma_f32_16x16x32_bf16 v[56:59], v[148:151], v[164:167], v[56:59]
    v_mfma_f32_16x16x32_bf16 v[60:63], v[148:151], v[168:171], v[60:63]
    v_mfma_f32_16x16x32_bf16 v[56:59], v[152:155], v[160:163], v[56:59]
    v_mfma_f32_16x16x32_bf16 v[60:63], v[152:155], v[164:167], v[60:63]
    v_mfma_f32_16x16x32_bf16 v[60:63], v[156:159], v[160:163], v[60:63]
    s_waitcnt lgkmcnt(0)
    v_mfma_f32_16x16x32_bf16 v[32:35], v[192:195], v[224:227], v[32:35]
    v_mfma_f32_16x16x32_bf16 v[36:39], v[192:195], v[228:231], v[36:39]
    v_mfma_f32_16x16x32_bf16 v[40:43], v[192:195], v[232:235], v[40:43]
    v_mfma_f32_16x16x32_bf16 v[44:47], v[192:195], v[236:239], v[44:47]
    v_mfma_f32_16x16x32_bf16 v[48:51], v[192:195], v[240:243], v[48:51]
    v_mfma_f32_16x16x32_bf16 v[52:55], v[192:195], v[244:247], v[52:55]
    v_mfma_f32_16x16x32_bf16 v[56:59], v[192:195], v[248:251], v[56:59]
    v_mfma_f32_16x16x32_bf16 v[60:63], v[192:195], v[252:255], v[60:63]
    v_mfma_f32_16x16x32_bf16 v[36:39], v[196:199], v[224:227], v[36:39]
    v_mfma_f32_16x16x32_bf16 v[40:43], v[196:199], v[228:231], v[40:43]
    v_mfma_f32_16x16x32_bf16 v[44:47], v[196:199], v[232:235], v[44:47]
    v_mfma_f32_16x16x32_bf16 v[48:51], v[196:199], v[236:239], v[48:51]
    v_mfma_f32_16x16x32_bf16 v[52:55], v[196:199], v[240:243], v[52:55]
    v_mfma_f32_16x16x32_bf16 v[56:59], v[196:199], v[244:247], v[56:59]
    v_mfma_f32_16x16x32_bf16 v[60:63], v[196:199], v[248:251], v[60:63]
    v_mfma_f32_16x16x32_bf16 v[40:43], v[200:203], v[224:227], v[40:43]
    v_mfma_f32_16x16x32_bf16 v[44:47], v[200:203], v[228:231], v[44:47]
    v_mfma_f32_16x16x32_bf16 v[48:51], v[200:203], v[232:235], v[48:51]
    v_mfma_f32_16x16x32_bf16 v[52:55], v[200:203], v[236:239], v[52:55]
    v_mfma_f32_16x16x32_bf16 v[56:59], v[200:203], v[240:243], v[56:59]
    v_mfma_f32_16x16x32_bf16 v[60:63], v[200:203], v[244:247], v[60:63]
    v_mfma_f32_16x16x32_bf16 v[44:47], v[204:207], v[224:227], v[44:47]
    v_mfma_f32_16x16x32_bf16 v[48:51], v[204:207], v[228:231], v[48:51]
    v_mfma_f32_16x16x32_bf16 v[52:55], v[204:207], v[232:235], v[52:55]
    v_mfma_f32_16x16x32_bf16 v[56:59], v[204:207], v[236:239], v[56:59]
    v_mfma_f32_16x16x32_bf16 v[60:63], v[204:207], v[240:243], v[60:63]
    v_mfma_f32_16x16x32_bf16 v[48:51], v[208:211], v[224:227], v[48:51]
    v_mfma_f32_16x16x32_bf16 v[52:55], v[208:211], v[228:231], v[52:55]
    v_mfma_f32_16x16x32_bf16 v[56:59], v[208:211], v[232:235], v[56:59]
    v_mfma_f32_16x16x32_bf16 v[60:63], v[208:211], v[236:239], v[60:63]
    v_mfma_f32_16x16x32_bf16 v[52:55], v[212:215], v[224:227], v[52:55]
    v_mfma_f32_16x16x32_bf16 v[56:59], v[212:215], v[228:231], v[56:59]
    v_mfma_f32_16x16x32_bf16 v[60:63], v[212:215], v[232:235], v[60:63]
    v_mfma_f32_16x16x32_bf16 v[56:59], v[216:219], v[224:227], v[56:59]
    v_mfma_f32_16x16x32_bf16 v[60:63], v[216:219], v[228:231], v[60:63]
    v_mfma_f32_16x16x32_bf16 v[60:63], v[220:223], v[224:227], v[60:63]
AL_on1:
    v_cvt_pk_bf16_f32 v128, v32, v33
    v_cvt_pk_bf16_f32 v129, v34, v35
    v_lshlrev_b32 v32, 16, v128
    v_and_b32 v33, 0xffff0000, v128
    v_lshlrev_b32 v34, 16, v129
    v_and_b32 v35, 0xffff0000, v129
    v_pk_add_f32 v[32:33], v[32:33], v[96:97]
    v_pk_add_f32 v[34:35], v[34:35], v[98:99]
    v_cvt_pk_bf16_f32 v128, v32, v33
    v_cvt_pk_bf16_f32 v129, v34, v35
    v_lshlrev_b32 v32, 16, v128
    v_and_b32 v33, 0xffff0000, v128
    v_lshlrev_b32 v34, 16, v129
    v_and_b32 v35, 0xffff0000, v129
    v_pk_mul_f32 v[32:33], v[32:33], v[22:23] op_sel_hi:[1,0]
    v_pk_mul_f32 v[34:35], v[34:35], v[22:23] op_sel_hi:[1,0]
    v_cvt_pk_bf16_f32 v128, v32, v33
    v_cvt_pk_bf16_f32 v129, v34, v35
    v_lshlrev_b32 v32, 16, v128
    v_and_b32 v33, 0xffff0000, v128
    v_lshlrev_b32 v34, 16, v129
    v_and_b32 v35, 0xffff0000, v129
    v_lshlrev_b32 v96, 16, v66
    v_and_b32 v97, 0xffff0000, v66
    v_lshlrev_b32 v98, 16, v67
    v_and_b32 v99, 0xffff0000, v67
    v_pk_add_f32 v[32:33], v[32:33], v[96:97]
    v_pk_add_f32 v[34:35], v[34:35], v[98:99]
    v_cvt_pk_bf16_f32 v128, v32, v33
    v_cvt_pk_bf16_f32 v129, v34, v35
    v_cvt_pk_bf16_f32 v130, v36, v37
    v_cvt_pk_bf16_f32 v131, v38, v39
    v_lshlrev_b32 v36, 16, v130
    v_and_b32 v37, 0xffff0000, v130
    v_lshlrev_b32 v38, 16, v131
    v_and_b32 v39, 0xffff0000, v131
    v_pk_add_f32 v[36:37], v[36:37], v[100:101]
    v_pk_add_f32 v[38:39], v[38:39], v[102:103]
    v_cvt_pk_bf16_f32 v130, v36, v37
    v_cvt_pk_bf16_f32 v131, v38, v39
    v_lshlrev_b32 v36, 16, v130
    v_and_b32 v37, 0xffff0000, v130
    v_lshlrev_b32 v38, 16, v131
    v_and_b32 v39, 0xffff0000, v131
    v_pk_mul_f32 v[36:37], v[36:37], v[22:23] op_sel_hi:[1,0]
    v_pk_mul_f32 v[38:39], v[38:39], v[22:23] op_sel_hi:[1,0]
    v_cvt_pk_bf16_f32 v130, v36, v37
    v_cvt_pk_bf16_f32 v131, v38, v39
    v_lshlrev_b32 v36, 16, v130
    v_and_b32 v37, 0xffff0000, v130
    v_lshlrev_b32 v38, 16, v131
    v_and_b32 v39, 0xffff0000, v131
    v_lshlrev_b32 v100, 16, v70
    v_and_b32 v101, 0xffff0000, v70
    v_lshlrev_b32 v102, 16, v71
    v_and_b32 v103, 0xffff0000, v71
    v_pk_add_f32 v[36:37], v[36:37], v[100:101]
    v_pk_add_f32 v[38:39], v[38:39], v[102:103]
    v_cvt_pk_bf16_f32 v130, v36, v37
    v_cvt_pk_bf16_f32 v131, v38, v39
    s_nop 1
    v_permlane16_swap_b32 v128, v130
    v_permlane16_swap_b32 v129, v131
    buffer_store_dwordx4 v[128:131], v20, s[12:15], s29 offen sc1
    s_add_u32 s29, s29, 589824
    v_cvt_pk_bf16_f32 v132, v40, v41
    v_cvt_pk_bf16_f32 v133, v42, v43
    v_lshlrev_b32 v40, 16, v132
    v_and_b32 v41, 0xffff0000, v132
    v_lshlrev_b32 v42, 16, v133
    v_and_b32 v43, 0xffff0000, v133
    v_pk_add_f32 v[40:41], v[40:41], v[104:105]
    v_pk_add_f32 v[42:43], v[42:43], v[106:107]
    v_cvt_pk_bf16_f32 v132, v40, v41
    v_cvt_pk_bf16_f32 v133, v42, v43
    v_lshlrev_b32 v40, 16, v132
    v_and_b32 v41, 0xffff0000, v132
    v_lshlrev_b32 v42, 16, v133
    v_and_b32 v43, 0xffff0000, v133
    v_pk_mul_f32 v[40:41], v[40:41], v[22:23] op_sel_hi:[1,0]
    v_pk_mul_f32 v[42:43], v[42:43], v[22:23] op_sel_hi:[1,0]
    v_cvt_pk_bf16_f32 v132, v40, v41
    v_cvt_pk_bf16_f32 v133, v42, v43
    v_lshlrev_b32 v40, 16, v132
    v_and_b32 v41, 0xffff0000, v132
    v_lshlrev_b32 v42, 16, v133
    v_and_b32 v43, 0xffff0000, v133
    v_lshlrev_b32 v104, 16, v74
    v_and_b32 v105, 0xffff0000, v74
    v_lshlrev_b32 v106, 16, v75
    v_and_b32 v107, 0xffff0000, v75
    v_pk_add_f32 v[40:41], v[40:41], v[104:105]
    v_pk_add_f32 v[42:43], v[42:43], v[106:107]
    v_cvt_pk_bf16_f32 v132, v40, v41
    v_cvt_pk_bf16_f32 v133, v42, v43
    v_cvt_pk_bf16_f32 v134, v44, v45
    v_cvt_pk_bf16_f32 v135, v46, v47
    v_lshlrev_b32 v44, 16, v134
    v_and_b32 v45, 0xffff0000, v134
    v_lshlrev_b32 v46, 16, v135
    v_and_b32 v47, 0xffff0000, v135
    v_pk_add_f32 v[44:45], v[44:45], v[108:109]
    v_pk_add_f32 v[46:47], v[46:47], v[110:111]
    v_cvt_pk_bf16_f32 v134, v44, v45
    v_cvt_pk_bf16_f32 v135, v46, v47
    v_lshlrev_b32 v44, 16, v134
    v_and_b32 v45, 0xffff0000, v134
    v_lshlrev_b32 v46, 16, v135
    v_and_b32 v47, 0xffff0000, v135
    v_pk_mul_f32 v[44:45], v[44:45], v[22:23] op_sel_hi:[1,0]
    v_pk_mul_f32 v[46:47], v[46:47], v[22:23] op_sel_hi:[1,0]
    v_cvt_pk_bf16_f32 v134, v44, v45
    v_cvt_pk_bf16_f32 v135, v46, v47
    v_lshlrev_b32 v44, 16, v134
    v_and_b32 v45, 0xffff0000, v134
    v_lshlrev_b32 v46, 16, v135
    v_and_b32 v47, 0xffff0000, v135
    v_lshlrev_b32 v108, 16, v78
    v_and_b32 v109, 0xffff0000, v78
    v_lshlrev_b32 v110, 16, v79
    v_and_b32 v111, 0xffff0000, v79
    v_pk_add_f32 v[44:45], v[44:45], v[108:109]
    v_pk_add_f32 v[46:47], v[46:47], v[110:111]
    v_cvt_pk_bf16_f32 v134, v44, v45
    v_cvt_pk_bf16_f32 v135, v46, v47
    s_nop 1
    v_permlane16_swap_b32 v132, v134
    v_permlane16_swap_b32 v133, v135
    buffer_store_dwordx4 v[132:135], v20, s[12:15], s29 offen sc1
    s_add_u32 s29, s29, 589824
    v_cvt_pk_bf16_f32 v136, v48, v49
    v_cvt_pk_bf16_f32 v137, v50, v51
    v_lshlrev_b32 v48, 16, v136
    v_and_b32 v49, 0xffff0000, v136
    v_lshlrev_b32 v50, 16, v137
    v_and_b32 v51, 0xffff0000, v137
    v_pk_add_f32 v[48:49], v[48:49], v[112:113]
    v_pk_add_f32 v[50:51], v[50:51], v[114:115]
    v_cvt_pk_bf16_f32 v136, v48, v49
    v_cvt_pk_bf16_f32 v137, v50, v51
    v_lshlrev_b32 v48, 16, v136
    v_and_b32 v49, 0xffff0000, v136
    v_lshlrev_b32 v50, 16, v137
    v_and_b32 v51, 0xffff0000, v137
    v_pk_mul_f32 v[48:49], v[48:49], v[22:23] op_sel_hi:[1,0]
    v_pk_mul_f32 v[50:51], v[50:51], v[22:23] op_sel_hi:[1,0]
    v_cvt_pk_bf16_f32 v136, v48, v49
    v_cvt_pk_bf16_f32 v137, v50, v51
    v_lshlrev_b32 v48, 16, v136
    v_and_b32 v49, 0xffff0000, v136
    v_lshlrev_b32 v50, 16, v137
    v_and_b32 v51, 0xffff0000, v137
    v_lshlrev_b32 v112, 16, v82
    v_and_b32 v113, 0xffff0000, v82
    v_lshlrev_b32 v114, 16, v83
    v_and_b32 v115, 0xffff0000, v83
    v_pk_add_f32 v[48:49], v[48:49], v[112:113]
    v_pk_add_f32 v[50:51], v[50:51], v[114:115]
    v_cvt_pk_bf16_f32 v136, v48, v49
    v_cvt_pk_bf16_f32 v137, v50, v51
    v_cvt_pk_bf16_f32 v138, v52, v53
    v_cvt_pk_bf16_f32 v139, v54, v55
    v_lshlrev_b32 v52, 16, v138
    v_and_b32 v53, 0xffff0000, v138
    v_lshlrev_b32 v54, 16, v139
    v_and_b32 v55, 0xffff0000, v139
    v_pk_add_f32 v[52:53], v[52:53], v[116:117]
    v_pk_add_f32 v[54:55], v[54:55], v[118:119]
    v_cvt_pk_bf16_f32 v138, v52, v53
    v_cvt_pk_bf16_f32 v139, v54, v55
    v_lshlrev_b32 v52, 16, v138
    v_and_b32 v53, 0xffff0000, v138
    v_lshlrev_b32 v54, 16, v139
    v_and_b32 v55, 0xffff0000, v139
    v_pk_mul_f32 v[52:53], v[52:53], v[22:23] op_sel_hi:[1,0]
    v_pk_mul_f32 v[54:55], v[54:55], v[22:23] op_sel_hi:[1,0]
    v_cvt_pk_bf16_f32 v138, v52, v53
    v_cvt_pk_bf16_f32 v139, v54, v55
    v_lshlrev_b32 v52, 16, v138
    v_and_b32 v53, 0xffff0000, v138
    v_lshlrev_b32 v54, 16, v139
    v_and_b32 v55, 0xffff0000, v139
    v_lshlrev_b32 v116, 16, v86
    v_and_b32 v117, 0xffff0000, v86
    v_lshlrev_b32 v118, 16, v87
    v_and_b32 v119, 0xffff0000, v87
    v_pk_add_f32 v[52:53], v[52:53], v[116:117]
    v_pk_add_f32 v[54:55], v[54:55], v[118:119]
    v_cvt_pk_bf16_f32 v138, v52, v53
    v_cvt_pk_bf16_f32 v139, v54, v55
    s_nop 1
    v_permlane16_swap_b32 v136, v138
    v_permlane16_swap_b32 v137, v139
    buffer_store_dwordx4 v[136:139], v20, s[12:15], s29 offen sc1
    s_add_u32 s29, s29, 589824
    v_cvt_pk_bf16_f32 v140, v56, v57
    v_cvt_pk_bf16_f32 v141, v58, v59
    v_lshlrev_b32 v56, 16, v140
    v_and_b32 v57, 0xffff0000, v140
    v_lshlrev_b32 v58, 16, v141
    v_and_b32 v59, 0xffff0000, v141
    v_pk_add_f32 v[56:57], v[56:57], v[120:121]
    v_pk_add_f32 v[58:59], v[58:59], v[122:123]
    v_cvt_pk_bf16_f32 v140, v56, v57
    v_cvt_pk_bf16_f32 v141, v58, v59
    v_lshlrev_b32 v56, 16, v140
    v_and_b32 v57, 0xffff0000, v140
    v_lshlrev_b32 v58, 16, v141
    v_and_b32 v59, 0xffff0000, v141
    v_pk_mul_f32 v[56:57], v[56:57], v[22:23] op_sel_hi:[1,0]
    v_pk_mul_f32 v[58:59], v[58:59], v[22:23] op_sel_hi:[1,0]
    v_cvt_pk_bf16_f32 v140, v56, v57
    v_cvt_pk_bf16_f32 v141, v58, v59
    v_lshlrev_b32 v56, 16, v140
    v_and_b32 v57, 0xffff0000, v140
    v_lshlrev_b32 v58, 16, v141
    v_and_b32 v59, 0xffff0000, v141
    v_lshlrev_b32 v120, 16, v90
    v_and_b32 v121, 0xffff0000, v90
    v_lshlrev_b32 v122, 16, v91
    v_and_b32 v123, 0xffff0000, v91
    v_pk_add_f32 v[56:57], v[56:57], v[120:121]
    v_pk_add_f32 v[58:59], v[58:59], v[122:123]
    v_cvt_pk_bf16_f32 v140, v56, v57
    v_cvt_pk_bf16_f32 v141, v58, v59
    v_cvt_pk_bf16_f32 v142, v60, v61
    v_cvt_pk_bf16_f32 v143, v62, v63
    v_lshlrev_b32 v60, 16, v142
    v_and_b32 v61, 0xffff0000, v142
    v_lshlrev_b32 v62, 16, v143
    v_and_b32 v63, 0xffff0000, v143
    v_pk_add_f32 v[60:61], v[60:61], v[124:125]
    v_pk_add_f32 v[62:63], v[62:63], v[126:127]
    v_cvt_pk_bf16_f32 v142, v60, v61
    v_cvt_pk_bf16_f32 v143, v62, v63
    v_lshlrev_b32 v60, 16, v142
    v_and_b32 v61, 0xffff0000, v142
    v_lshlrev_b32 v62, 16, v143
    v_and_b32 v63, 0xffff0000, v143
    v_pk_mul_f32 v[60:61], v[60:61], v[22:23] op_sel_hi:[1,0]
    v_pk_mul_f32 v[62:63], v[62:63], v[22:23] op_sel_hi:[1,0]
    v_cvt_pk_bf16_f32 v142, v60, v61
    v_cvt_pk_bf16_f32 v143, v62, v63
    v_lshlrev_b32 v60, 16, v142
    v_and_b32 v61, 0xffff0000, v142
    v_lshlrev_b32 v62, 16, v143
    v_and_b32 v63, 0xffff0000, v143
    v_lshlrev_b32 v124, 16, v94
    v_and_b32 v125, 0xffff0000, v94
    v_lshlrev_b32 v126, 16, v95
    v_and_b32 v127, 0xffff0000, v95
    v_pk_add_f32 v[60:61], v[60:61], v[124:125]
    v_pk_add_f32 v[62:63], v[62:63], v[126:127]
    v_cvt_pk_bf16_f32 v142, v60, v61
    v_cvt_pk_bf16_f32 v143, v62, v63
    s_nop 1
    v_permlane16_swap_b32 v140, v142
    v_permlane16_swap_b32 v141, v143
    buffer_store_dwordx4 v[140:143], v20, s[12:15], s29 offen sc1
    s_add_u32 s29, s29, 589824
    s_branch KA_fin
KA_help:
    s_sub_u32 s6, s6, 4
    v_lshrrev_b32 v10, 5, v0
    s_waitcnt lgkmcnt(0)
    s_add_u32 s8, s16, 0
    s_addc_u32 s9, s17, 0
    s_mov_b32 s10, 2359296
    s_mov_b32 s11, 0x20000
    s_sub_u32 s61, s2, 108
    s_lshr_b32 s61, s61, 3
    s_lshl_b32 s62, s6, 1
    s_add_u32 s61, s61, s62
    s_add_u32 s62, s61, 1
    s_and_b32 s61, s61, 7
    s_and_b32 s62, s62, 7
    s_lshl_b32 s63, s48, 3
    s_mul_i32 s19, s61, 294912
    s_mul_i32 s20, s62, 294912
    s_add_u32 s19, s19, s63
    s_add_u32 s20, s20, s63
    v_mul_u32_u24 v195, 4608, v0
    buffer_load_dwordx2 v[96:97], v195, s[8:11], s19 offen offset:0
    buffer_load_dwordx2 v[98:99], v195, s[8:11], s19 offen offset:1152
    buffer_load_dwordx2 v[100:101], v195, s[8:11], s19 offen offset:2304
    buffer_load_dwordx2 v[102:103], v195, s[8:11], s19 offen offset:3456
    buffer_load_dwordx2 v[104:105], v195, s[8:11], s20 offen offset:0
    buffer_load_dwordx2 v[106:107], v195, s[8:11], s20 offen offset:1152
    buffer_load_dwordx2 v[108:109], v195, s[8:11], s20 offen offset:2304
    buffer_load_dwordx2 v[110:111], v195, s[8:11], s20 offen offset:3456
    s_load_dword s7, s[42:43], 0
    s_add_u32 s12, s42, 0
    s_addc_u32 s13, s43, 0
    s_mov_b32 s14, 268435456
    s_mov_b32 s15, 0x20000
    s_add_u32 s44, s40, 0
    s_addc_u32 s45, s41, 0
    s_mov_b32 s46, 256
    s_mov_b32 s47, 0x20000
    s_mov_b32 s38, 0x05040100
    s_mov_b32 s39, 0x07060302
    s_lshl_b32 s53, s61, 9
    s_add_u32 s53, s53, 69632
    v_lshl_add_u32 v12, v0, 3, s53
    s_lshl_b32 s53, s62, 9
    s_add_u32 s53, s53, 69632
    v_lshl_add_u32 v13, v0, 3, s53
    v_lshlrev_b32 v3, 5, v0
    v_and_b32 v4, 7, v0
    v_mul_u32_u24 v4, 27648, v4
    v_bfe_u32 v5, v0, 3, 2
    v_lshl_add_u32 v4, v5, 3, v4
    v_mul_u32_u24 v5, 4608, v10
    v_add_u32 v5, v5, v4
    s_lshl_b32 s61, s61, 11
    s_add_u32 s61, s61, 4096
    s_lshl_b32 s62, s62, 11
    s_add_u32 s62, s62, 4096
    s_lshl_b32 s51, s48, 5
    s_add_u32 s51, s51, 65536
    s_add_u32 s52, s51, 9216
    s_mov_b32 s60, 0
    buffer_load_dwordx2 v[144:145], v5, s[12:15], s51 offen sc1
    buffer_load_dwordx2 v[146:147], v4, s[12:15], s52 offen sc1
    buffer_load_dwordx4 v[128:131], v3, s[12:15], s61 offen offset:0 sc1
    buffer_load_dwordx4 v[132:135], v3, s[12:15], s61 offen offset:16 sc1
    buffer_load_dwordx4 v[136:139], v3, s[12:15], s62 offen offset:0 sc1
    buffer_load_dwordx4 v[140:143], v3, s[12:15], s62 offen offset:16 sc1
    s_waitcnt vmcnt(6)
    v_perm_b32 v80, v98, v96, s38
    v_perm_b32 v81, v102, v100, s38
    ds_write_b64 v12, v[80:81] offset:4608
    v_perm_b32 v82, v98, v96, s39
    v_perm_b32 v83, v102, v100, s39
    ds_write_b64 v12, v[82:83] offset:13312
    v_perm_b32 v84, v99, v97, s38
    v_perm_b32 v85, v103, v101, s38
    ds_write_b64 v12, v[84:85] offset:22016
    v_perm_b32 v86, v99, v97, s39
    v_perm_b32 v87, v103, v101, s39
    ds_write_b64 v12, v[86:87] offset:30720
    v_perm_b32 v88, v106, v104, s38
    v_perm_b32 v89, v110, v108, s38
    ds_write_b64 v13, v[88:89] offset:4608
    v_perm_b32 v90, v106, v104, s39
    v_perm_b32 v91, v110, v108, s39
    ds_write_b64 v13, v[90:91] offset:13312
    v_perm_b32 v92, v107, v105, s38
    v_perm_b32 v93, v111, v109, s38
    ds_write_b64 v13, v[92:93] offset:22016
    v_perm_b32 v94, v107, v105, s39
    v_perm_b32 v95, v111, v109, s39
    ds_write_b64 v13, v[94:95] offset:30720
    s_waitcnt lgkmcnt(0)
    v_lshlrev_b32 v32, 16, v96
    v_and_b32 v33, 0xffff0000, v96
    v_lshlrev_b32 v34, 16, v97
    v_and_b32 v35, 0xffff0000, v97
    v_lshlrev_b32 v36, 16, v98
    v_and_b32 v37, 0xffff0000, v98
    v_lshlrev_b32 v38, 16, v99
    v_and_b32 v39, 0xffff0000, v99
    v_lshlrev_b32 v40, 16, v100
    v_and_b32 v41, 0xffff0000, v100
    v_lshlrev_b32 v42, 16, v101
    v_and_b32 v43, 0xffff0000, v101
    v_lshlrev_b32 v44, 16, v102
    v_and_b32 v45, 0xffff0000, v102
    v_lshlrev_b32 v46, 16, v103
    v_and_b32 v47, 0xffff0000, v103
    v_lshlrev_b32 v48, 16, v104
    v_and_b32 v49, 0xffff0000, v104
    v_lshlrev_b32 v50, 16, v105
    v_and_b32 v51, 0xffff0000, v105
    v_lshlrev_b32 v52, 16, v106
    v_and_b32 v53, 0xffff0000, v106
    v_lshlrev_b32 v54, 16, v107
    v_and_b32 v55, 0xffff0000, v107
    v_lshlrev_b32 v56, 16, v108
    v_and_b32 v57, 0xffff0000, v108
    v_lshlrev_b32 v58, 16, v109
    v_and_b32 v59, 0xffff0000, v109
    v_lshlrev_b32 v60, 16, v110
    v_and_b32 v61, 0xffff0000, v110
    v_lshlrev_b32 v62, 16, v111
    v_and_b32 v63, 0xffff0000, v111
    s_add_u32 s7, s7, 1
    s_branch KC_poll_w
KC_poll:
    buffer_load_dwordx2 v[144:145], v5, s[12:15], s51 offen sc1
    buffer_load_dwordx2 v[146:147], v4, s[12:15], s52 offen sc1
    buffer_load_dwordx4 v[128:131], v3, s[12:15], s61 offen offset:0 sc1
    buffer_load_dwordx4 v[132:135], v3, s[12:15], s61 offen offset:16 sc1
    buffer_load_dwordx4 v[136:139], v3, s[12:15], s62 offen offset:0 sc1
    buffer_load_dwordx4 v[140:143], v3, s[12:15], s62 offen offset:16 sc1
KC_poll_w:
    s_add_u32 s60, s60, 1
    s_waitcnt vmcnt(0)
    v_cmpx_eq_u32 vcc, s7, v129
    v_cmpx_eq_u32 vcc, s7, v131
    v_cmpx_eq_u32 vcc, s7, v133
    v_cmpx_eq_u32 vcc, s7, v135
    v_cmpx_eq_u32 vcc, s7, v137
    v_cmpx_eq_u32 vcc, s7, v139
    v_cmpx_eq_u32 vcc, s7, v141
    v_cmpx_eq_u32 vcc, s7, v143
    v_cmpx_eq_u32 vcc, s7, v145
    v_cmpx_eq_u32 vcc, s7, v147
    s_nop 4
    s_cmp_eq_u64 exec, -1
    s_mov_b64 exec, -1
    s_cbranch_scc1 KC_poll_ok
    s_sleep 1
    s_cmp_lt_u32 s60, 0x8000
    s_cbranch_scc1 KC_poll
KC_poll_ok:
    v_and_b32 v148, 0xffff0000, v128
    v_lshlrev_b32 v156, 16, v128
    v_and_b32 v149, 0xffff0000, v130
    v_lshlrev_b32 v157, 16, v130
    v_and_b32 v150, 0xffff0000, v132
    v_lshlrev_b32 v158, 16, v132
    v_and_b32 v151, 0xffff0000, v134
    v_lshlrev_b32 v159, 16, v134
    v_and_b32 v152, 0xffff0000, v136
    v_lshlrev_b32 v160, 16, v136
    v_and_b32 v153, 0xffff0000, v138
    v_lshlrev_b32 v161, 16, v138
    v_and_b32 v154, 0xffff0000, v140
    v_lshlrev_b32 v162, 16, v140
    v_and_b32 v155, 0xffff0000, v142
    v_lshlrev_b32 v163, 16, v142
    v_add_f32_dpp v144, v144, v144 row_shl:4 row_mask:0xf bank_mask:0xf
    v_add_f32_dpp v146, v146, v146 row_shl:4 row_mask:0xf bank_mask:0xf
    v_rcp_f32 v148, v148
    v_rcp_f32 v149, v149
    v_rcp_f32 v150, v150
    v_add_f32_dpp v144, v144, v144 row_shl:2 row_mask:0xf bank_mask:0xf
    v_add_f32_dpp v146, v146, v146 row_shl:2 row_mask:0xf bank_mask:0xf
    v_rcp_f32 v151, v151
    v_rcp_f32 v152, v152
    v_rcp_f32 v153, v153
    v_add_f32_dpp v144, v144, v144 row_shl:1 row_mask:0xf bank_mask:0xf
    v_add_f32_dpp v146, v146, v146 row_shl:1 row_mask:0xf bank_mask:0xf
    v_rcp_f32 v154, v154
    v_rcp_f32 v155, v155
    v_cvt_pk_bf16_f32 v144, v144, v146
    v_and_b32 v146, 0xffff0000, v144
    v_lshlrev_b32 v144, 16, v144
    v_add_f32 v145, 1.0, v144
    v_cvt_pk_bf16_f32 v145, v145, v145
    v_lshlrev_b32 v145, 16, v145
    v_mul_f32 v156, -v156, v148
    v_mul_f32 v157, -v157, v149
    v_mul_f32 v158, -v158, v150
    v_mul_f32 v159, -v159, v151
    v_mul_f32 v160, -v160, v152
    v_mul_f32 v161, -v161, v153
    v_mul_f32 v162, -v162, v154
    v_mul_f32 v163, -v163, v155
    v_readlane_b32 s16, v145, 32
    v_readlane_b32 s20, v144, 0
    v_readlane_b32 s17, v145, 40
    v_readlane_b32 s21, v144, 8
    v_readlane_b32 s18, v145, 48
    v_readlane_b32 s22, v144, 16
    v_readlane_b32 s19, v145, 56
    v_readlane_b32 s23, v144, 24
    v_lshlrev_b32 v6, 2, v0
    v_add_u32 v6, 104448, v6
    ds_write_b32 v6, v146
    v_mov_b32 v24, s20
    v_mov_b32 v25, s21
    v_mov_b32 v26, s22
    v_mov_b32 v27, s23
    v_pk_fma_f32 v[32:33], v[32:33], v[148:149], v[156:157] op_sel:[0,0,0] op_sel_hi:[1,0,0]
    v_pk_fma_f32 v[34:35], v[34:35], v[148:149], v[156:157] op_sel:[0,0,0] op_sel_hi:[1,0,0]
    v_pk_fma_f32 v[32:33], v[32:33], s[16:17], v[24:25]
    v_pk_fma_f32 v[34:35], v[34:35], s[18:19], v[26:27]
    v_pk_fma_f32 v[36:37], v[36:37], v[148:149], v[156:157] op_sel:[0,1,1] op_sel_hi:[1,1,1]
    v_pk_fma_f32 v[38:39], v[38:39], v[148:149], v[156:157] op_sel:[0,1,1] op_sel_hi:[1,1,1]
    v_pk_fma_f32 v[36:37], v[36:37], s[16:17], v[24:25]
    v_pk_fma_f32 v[38:39], v[38:39], s[18:19], v[26:27]
    v_pk_fma_f32 v[40:41], v[40:41], v[150:151], v[158:159] op_sel:[0,0,0] op_sel_hi:[1,0,0]
    v_pk_fma_f32 v[42:43], v[42:43], v[150:151], v[158:159] op_sel:[0,0,0] op_sel_hi:[1,0,0]
    v_pk_fma_f32 v[40:41], v[40:41], s[16:17], v[24:25]
    v_pk_fma_f32 v[42:43], v[42:43], s[18:19], v[26:27]
    v_pk_fma_f32 v[44:45], v[44:45], v[150:151], v[158:159] op_sel:[0,1,1] op_sel_hi:[1,1,1]
    v_pk_fma_f32 v[46:47], v[46:47], v[150:151], v[158:159] op_sel:[0,1,1] op_sel_hi:[1,1,1]
    v_pk_fma_f32 v[44:45], v[44:45], s[16:17], v[24:25]
    v_pk_fma_f32 v[46:47], v[46:47], s[18:19], v[26:27]
    v_cvt_pk_bf16_f32 v64, v32, v36
    v_cvt_pk_bf16_f32 v65, v40, v44
    ds_write_b64 v12, v[64:65] offset:512
    v_cvt_pk_bf16_f32 v66, v33, v37
    v_cvt_pk_bf16_f32 v67, v41, v45
    ds_write_b64 v12, v[66:67] offset:9216
    v_cvt_pk_bf16_f32 v68, v34, v38
    v_cvt_pk_bf16_f32 v69, v42, v46
    ds_write_b64 v12, v[68:69] offset:17920
    v_cvt_pk_bf16_f32 v70, v35, v39
    v_cvt_pk_bf16_f32 v71, v43, v47
    ds_write_b64 v12, v[70:71] offset:26624
    v_pk_fma_f32 v[48:49], v[48:49], v[152:153], v[160:161] op_sel:[0,0,0] op_sel_hi:[1,0,0]
    v_pk_fma_f32 v[50:51], v[50:51], v[152:153], v[160:161] op_sel:[0,0,0] op_sel_hi:[1,0,0]
    v_pk_fma_f32 v[48:49], v[48:49], s[16:17], v[24:25]
    v_pk_fma_f32 v[50:51], v[50:51], s[18:19], v[26:27]
    v_pk_fma_f32 v[52:53], v[52:53], v[152:153], v[160:161] op_sel:[0,1,1] op_sel_hi:[1,1,1]
    v_pk_fma_f32 v[54:55], v[54:55], v[152:153], v[160:161] op_sel:[0,1,1] op_sel_hi:[1,1,1]
    v_pk_fma_f32 v[52:53], v[52:53], s[16:17], v[24:25]
    v_pk_fma_f32 v[54:55], v[54:55], s[18:19], v[26:27]
    v_pk_fma_f32 v[56:57], v[56:57], v[154:155], v[162:163] op_sel:[0,0,0] op_sel_hi:[1,0,0]
    v_pk_fma_f32 v[58:59], v[58:59], v[154:155], v[162:163] op_sel:[0,0,0] op_sel_hi:[1,0,0]
    v_pk_fma_f32 v[56:57], v[56:57], s[16:17], v[24:25]
    v_pk_fma_f32 v[58:59], v[58:59], s[18:19], v[26:27]
    v_pk_fma_f32 v[60:61], v[60:61], v[154:155], v[162:163] op_sel:[0,1,1] op_sel_hi:[1,1,1]
    v_pk_fma_f32 v[62:63], v[62:63], v[154:155], v[162:163] op_sel:[0,1,1] op_sel_hi:[1,1,1]
    v_pk_fma_f32 v[60:61], v[60:61], s[16:17], v[24:25]
    v_pk_fma_f32 v[62:63], v[62:63], s[18:19], v[26:27]
    v_cvt_pk_bf16_f32 v72, v48, v52
    v_cvt_pk_bf16_f32 v73, v56, v60
    ds_write_b64 v13, v[72:73] offset:512
    v_cvt_pk_bf16_f32 v74, v49, v53
    v_cvt_pk_bf16_f32 v75, v57, v61
    ds_write_b64 v13, v[74:75] offset:9216
    v_cvt_pk_bf16_f32 v76, v50, v54
    v_cvt_pk_bf16_f32 v77, v58, v62
    ds_write_b64 v13, v[76:77] offset:17920
    v_cvt_pk_bf16_f32 v78, v51, v55
    v_cvt_pk_bf16_f32 v79, v59, v63
    ds_write_b64 v13, v[78:79] offset:26624
    s_waitcnt lgkmcnt(0)
    s_barrier
    v_mov_b32 v30, 1879048192
    v_cmp_ne_u32 vcc, 256, v253
    v_mov_b32 v31, 1
    s_nop 0
    v_cndmask_b32 v30, 0, v30, vcc
    buffer_atomic_add v31, v30, s[44:47], 0 offen sc0
    s_cmp_eq_u32 s6, 3
    s_cbranch_scc1 KA_w2e
    s_sub_u32 s50, s2, 108
    s_mul_i32 s50, s50, 3
    s_add_u32 s50, s50, s6
    s_and_b32 s51, s50, 7
    s_lshr_b32 s50, s50, 3
    v_and_b32 v250, 15, v0
    v_lshrrev_b32 v248, 4, v0
    v_mul_u32_u24 v248, 18432, v248
    v_lshl_add_u32 v248, v250, 3, v248
    v_lshlrev_b32 v252, 4, v0
    v_add_u32 v249, 4608, v248
    v_add_u32 v250, 9216, v248
    v_add_u32 v251, 13824, v248
    s_waitcnt lgkmcnt(0)
    s_add_u32 s8, s34, 0
    s_addc_u32 s9, s35, 0
    s_mov_b32 s10, 5308416
    s_mov_b32 s11, 0x20000
    s_mul_i32 s23, s50, 57
    s_lshr_b32 s23, s23, 9
    s_mul_i32 s26, s23, 9
    s_sub_u32 s22, s50, s26
    s_mul_i32 s26, s51, 36
    s_mul_i32 s27, s23, 6
    s_add_u32 s26, s26, s27
    s_lshl_b32 s28, s22, 7
    s_add_u32 s27, s26, 0
    s_lshr_b32 s29, s27, 2
    s_lshl_b32 s29, s29, 6
    s_and_b32 s27, s27, 3
    s_add_u32 s27, s27, s29
    s_mul_i32 s27, s27, 1152
    s_add_u32 s35, s27, s28
    s_add_u32 s27, s26, 2
    s_lshr_b32 s29, s27, 2
    s_lshl_b32 s29, s29, 6
    s_and_b32 s27, s27, 3
    s_add_u32 s27, s27, s29
    s_mul_i32 s27, s27, 1152
    s_add_u32 s36, s27, s28
    s_add_u32 s27, s26, 4
    s_lshr_b32 s29, s27, 2
    s_lshl_b32 s29, s29, 6
    s_and_b32 s27, s27, 3
    s_add_u32 s27, s27, s29
    s_mul_i32 s27, s27, 1152
    s_add_u32 s37, s27, s28
    s_mul_i32 s30, s51, 1332
    s_mul_i32 s31, s22, 18
    s_mul_i32 s27, s23, 3
    s_add_u32 s30, s30, s31
    s_add_u32 s30, s30, s27
    s_add_u32 s30, s30, 171
    s_mov_b32 s24, 1024
    s_lshl_b32 s30, s30, 10
    s_add_u32 s56, s30, 12320768
    s_mul_i32 s30, s51, 1332
    s_mul_i32 s31, s22, 18
    s_mul_i32 s27, s23, 3
    s_add_u32 s30, s30, s31
    s_add_u32 s30, s30, s27
    s_add_u32 s30, s30, 504
    s_mov_b32 s24, 1024
    s_lshl_b32 s30, s30, 10
    s_add_u32 s57, s30, 12320768
    s_mul_i32 s30, s51, 1332
    s_mul_i32 s31, s22, 18
    s_mul_i32 s27, s23, 3
    s_add_u32 s30, s30, s31
    s_add_u32 s30, s30, s27
    s_add_u32 s30, s30, 837
    s_mov_b32 s24, 1024
    s_lshl_b32 s30, s30, 10
    s_add_u32 s58, s30, 12320768
    s_mul_i32 s30, s51, 1332
    s_mul_i32 s31, s22, 18
    s_mul_i32 s27, s23, 3
    s_add_u32 s30, s30, s31
    s_add_u32 s30, s30, s27
    s_add_u32 s30, s30, 1170
    s_mov_b32 s24, 1024
    s_lshl_b32 s30, s30, 10
    s_add_u32 s59, s30, 12320768
    buffer_load_dwordx2 v[200:201], v248, s[8:11], s35 offen offset:0 nt
    buffer_load_dwordx2 v[202:203], v249, s[8:11], s35 offen offset:0 nt
    buffer_load_dwordx2 v[204:205], v250, s[8:11], s35 offen offset:0 nt
    buffer_load_dwordx2 v[206:207], v251, s[8:11], s35 offen offset:0 nt
    buffer_load_dwordx2 v[208:209], v248, s[8:11], s35 offen offset:1152 nt
    buffer_load_dwordx2 v[210:211], v249, s[8:11], s35 offen offset:1152 nt
    buffer_load_dwordx2 v[212:213], v250, s[8:11], s35 offen offset:1152 nt
    buffer_load_dwordx2 v[214:215], v251, s[8:11], s35 offen offset:1152 nt
    buffer_load_dwordx2 v[216:217], v248, s[8:11], s36 offen offset:0 nt
    buffer_load_dwordx2 v[218:219], v249, s[8:11], s36 offen offset:0 nt
    buffer_load_dwordx2 v[220:221], v250, s[8:11], s36 offen offset:0 nt
    buffer_load_dwordx2 v[222:223], v251, s[8:11], s36 offen offset:0 nt
    buffer_load_dwordx2 v[224:225], v248, s[8:11], s36 offen offset:1152 nt
    buffer_load_dwordx2 v[226:227], v249, s[8:11], s36 offen offset:1152 nt
    buffer_load_dwordx2 v[228:229], v250, s[8:11], s36 offen offset:1152 nt
    buffer_load_dwordx2 v[230:231], v251, s[8:11], s36 offen offset:1152 nt
    buffer_load_dwordx2 v[232:233], v248, s[8:11], s37 offen offset:0 nt
    buffer_load_dwordx2 v[234:235], v249, s[8:11], s37 offen offset:0 nt
    buffer_load_dwordx2 v[236:237], v250, s[8:11], s37 offen offset:0 nt
    buffer_load_dwordx2 v[238:239], v251, s[8:11], s37 offen offset:0 nt
    buffer_load_dwordx2 v[240:241], v248, s[8:11], s37 offen offset:1152 nt
    buffer_load_dwordx2 v[242:243], v249, s[8:11], s37 offen offset:1152 nt
    buffer_load_dwordx2 v[244:245], v250, s[8:11], s37 offen offset:1152 nt
    buffer_load_dwordx2 v[246:247], v251, s[8:11], s37 offen offset:1152 nt
    s_waitcnt vmcnt(16)
    v_perm_b32 v128, v202, v200, s38
    v_perm_b32 v129, v206, v204, s38
    v_perm_b32 v130, v210, v208, s38
    v_perm_b32 v131, v214, v212, s38
    buffer_store_dwordx4 v[128:131], v252, s[12:15], s56 offen sc1
    s_add_u32 s56, s56, s24
    v_perm_b32 v132, v202, v200, s39
    v_perm_b32 v133, v206, v204, s39
    v_perm_b32 v134, v210, v208, s39
    v_perm_b32 v135, v214, v212, s39
    buffer_store_dwordx4 v[132:135], v252, s[12:15], s57 offen sc1
    s_add_u32 s57, s57, s24
    v_perm_b32 v136, v203, v201, s38
    v_perm_b32 v137, v207, v205, s38
    v_perm_b32 v138, v211, v209, s38
    v_perm_b32 v139, v215, v213, s38
    buffer_store_dwordx4 v[136:139], v252, s[12:15], s58 offen sc1
    s_add_u32 s58, s58, s24
    v_perm_b32 v140, v203, v201, s39
    v_perm_b32 v141, v207, v205, s39
    v_perm_b32 v142, v211, v209, s39
    v_perm_b32 v143, v215, v213, s39
    buffer_store_dwordx4 v[140:143], v252, s[12:15], s59 offen sc1
    s_add_u32 s59, s59, s24
    s_waitcnt vmcnt(12)
    v_perm_b32 v144, v218, v216, s38
    v_perm_b32 v145, v222, v220, s38
    v_perm_b32 v146, v226, v224, s38
    v_perm_b32 v147, v230, v228, s38
    buffer_store_dwordx4 v[144:147], v252, s[12:15], s56 offen sc1
    s_add_u32 s56, s56, s24
    v_perm_b32 v148, v218, v216, s39
    v_perm_b32 v149, v222, v220, s39
    v_perm_b32 v150, v226, v224, s39
    v_perm_b32 v151, v230, v228, s39
    buffer_store_dwordx4 v[148:151], v252, s[12:15], s57 offen sc1
    s_add_u32 s57, s57, s24
    v_perm_b32 v152, v219, v217, s38
    v_perm_b32 v153, v223, v221, s38
    v_perm_b32 v154, v227, v225, s38
    v_perm_b32 v155, v231, v229, s38
    buffer_store_dwordx4 v[152:155], v252, s[12:15], s58 offen sc1
    s_add_u32 s58, s58, s24
    v_perm_b32 v156, v219, v217, s39
    v_perm_b32 v157, v223, v221, s39
    v_perm_b32 v158, v227, v225, s39
    v_perm_b32 v159, v231, v229, s39
    buffer_store_dwordx4 v[156:159], v252, s[12:15], s59 offen sc1
    s_add_u32 s59, s59, s24
    s_waitcnt vmcnt(8)
    v_perm_b32 v160, v234, v232, s38
    v_perm_b32 v161, v238, v236, s38
    v_perm_b32 v162, v242, v240, s38
    v_perm_b32 v163, v246, v244, s38
    buffer_store_dwordx4 v[160:163], v252, s[12:15], s56 offen sc1
    s_add_u32 s56, s56, s24
    v_perm_b32 v164, v234, v232, s39
    v_perm_b32 v165, v238, v236, s39
    v_perm_b32 v166, v242, v240, s39
    v_perm_b32 v167, v246, v244, s39
    buffer_store_dwordx4 v[164:167], v252, s[12:15], s57 offen sc1
    s_add_u32 s57, s57, s24
    v_perm_b32 v168, v235, v233, s38
    v_perm_b32 v169, v239, v237, s38
    v_perm_b32 v170, v243, v241, s38
    v_perm_b32 v171, v247, v245, s38
    buffer_store_dwordx4 v[168:171], v252, s[12:15], s58 offen sc1
    s_add_u32 s58, s58, s24
    v_perm_b32 v172, v235, v233, s39
    v_perm_b32 v173, v239, v237, s39
    v_perm_b32 v174, v243, v241, s39
    v_perm_b32 v175, v247, v245, s39
    buffer_store_dwordx4 v[172:175], v252, s[12:15], s59 offen sc1
    s_add_u32 s59, s59, s24
KA_w2e:
    s_waitcnt vmcnt(12)
    s_add_u32 s6, s6, 4
    s_branch KA_end
KA_w2:
    s_sub_u32 s6, s6, 4
KA_st2:
    s_mul_i32 s53, s6, 108
    s_add_u32 s53, s53, s2
    v_lshrrev_b32 v1, 3, v0
    v_and_b32 v2, 7, v0
    s_mul_i32 s54, s53, 9216
    s_lshl_b32 s55, s53, 6
    s_add_u32 s55, s55, 4096
    s_cmp_ge_u32 s53, 256
    s_cbranch_scc1 KA_done
    v_mul_u32_u24 v5, 1152, v1
    v_lshl_add_u32 v5, v2, 4, v5
    v_add_u32 v5, s54, v5
    v_lshl_add_u32 v6, v1, 3, s55
    s_waitcnt lgkmcnt(0)
    s_add_u32 s20, s16, 0
    s_addc_u32 s21, s17, 0
    s_mov_b32 s22, 2359296
    s_mov_b32 s23, 0x20000
    s_load_dword s7, s[42:43], 0
    buffer_load_dwordx4 v[96:99], v5, s[20:23], 0 offen offset:0
    buffer_load_dwordx4 v[100:103], v5, s[20:23], 0 offen offset:128
    buffer_load_dwordx4 v[104:107], v5, s[20:23], 0 offen offset:256
    buffer_load_dwordx4 v[108:111], v5, s[20:23], 0 offen offset:384
    buffer_load_dwordx4 v[112:115], v5, s[20:23], 0 offen offset:512
    buffer_load_dwordx4 v[116:119], v5, s[20:23], 0 offen offset:640
    buffer_load_dwordx4 v[120:123], v5, s[20:23], 0 offen offset:768
    buffer_load_dwordx4 v[124:127], v5, s[20:23], 0 offen offset:896
    buffer_load_dwordx4 v[128:131], v5, s[20:23], 0 offen offset:1024
    s_add_u32 s12, s42, 0
    s_addc_u32 s13, s43, 0
    s_mov_b32 s14, 268435456
    s_mov_b32 s15, 0x20000
    s_mov_b32 s30, 0x3f803f80
    s_waitcnt vmcnt(8)
    v_dot2_f32_bf16 v84, v96, s30, 0
    v_dot2_f32_bf16 v86, v96, v96, 0
    v_dot2_f32_bf16 v85, v97, s30, 0
    v_dot2_f32_bf16 v87, v97, v97, 0
    v_dot2_f32_bf16 v84, v98, s30, v84
    v_dot2_f32_bf16 v86, v98, v98, v86
    v_dot2_f32_bf16 v85, v99, s30, v85
    v_dot2_f32_bf16 v87, v99, v99, v87
    s_waitcnt vmcnt(7)
    v_dot2_f32_bf16 v84, v100, s30, v84
    v_dot2_f32_bf16 v86, v100, v100, v86
    v_dot2_f32_bf16 v85, v101, s30, v85
    v_dot2_f32_bf16 v87, v101, v101, v87
    v_dot2_f32_bf16 v84, v102, s30, v84
    v_dot2_f32_bf16 v86, v102, v102, v86
    v_dot2_f32_bf16 v85, v103, s30, v85
    v_dot2_f32_bf16 v87, v103, v103, v87
    s_waitcnt vmcnt(6)
    v_dot2_f32_bf16 v84, v104, s30, v84
    v_dot2_f32_bf16 v86, v104, v104, v86
    v_dot2_f32_bf16 v85, v105, s30, v85
    v_dot2_f32_bf16 v87, v105, v105, v87
    v_dot2_f32_bf16 v84, v106, s30, v84
    v_dot2_f32_bf16 v86, v106, v106, v86
    v_dot2_f32_bf16 v85, v107, s30, v85
    v_dot2_f32_bf16 v87, v107, v107, v87
    s_waitcnt vmcnt(5)
    v_dot2_f32_bf16 v84, v108, s30, v84
    v_dot2_f32_bf16 v86, v108, v108, v86
    v_dot2_f32_bf16 v85, v109, s30, v85
    v_dot2_f32_bf16 v87, v109, v109, v87
    v_dot2_f32_bf16 v84, v110, s30, v84
    v_dot2_f32_bf16 v86, v110, v110, v86
    v_dot2_f32_bf16 v85, v111, s30, v85
    v_dot2_f32_bf16 v87, v111, v111, v87
    s_waitcnt vmcnt(4)
    v_dot2_f32_bf16 v84, v112, s30, v84
    v_dot2_f32_bf16 v86, v112, v112, v86
    v_dot2_f32_bf16 v85, v113, s30, v85
    v_dot2_f32_bf16 v87, v113, v113, v87
    v_dot2_f32_bf16 v84, v114, s30, v84
    v_dot2_f32_bf16 v86, v114, v114, v86
    v_dot2_f32_bf16 v85, v115, s30, v85
    v_dot2_f32_bf16 v87, v115, v115, v87
    s_waitcnt vmcnt(3)
    v_dot2_f32_bf16 v84, v116, s30, v84
    v_dot2_f32_bf16 v86, v116, v116, v86
    v_dot2_f32_bf16 v85, v117, s30, v85
    v_dot2_f32_bf16 v87, v117, v117, v87
    v_dot2_f32_bf16 v84, v118, s30, v84
    v_dot2_f32_bf16 v86, v118, v118, v86
    v_dot2_f32_bf16 v85, v119, s30, v85
    v_dot2_f32_bf16 v87, v119, v119, v87
    s_waitcnt vmcnt(2)
    v_dot2_f32_bf16 v84, v120, s30, v84
    v_dot2_f32_bf16 v86, v120, v120, v86
    v_dot2_f32_bf16 v85, v121, s30, v85
    v_dot2_f32_bf16 v87, v121, v121, v87
    v_dot2_f32_bf16 v84, v122, s30, v84
    v_dot2_f32_bf16 v86, v122, v122, v86
    v_dot2_f32_bf16 v85, v123, s30, v85
    v_dot2_f32_bf16 v87, v123, v123, v87
    s_waitcnt vmcnt(1)
    v_dot2_f32_bf16 v84, v124, s30, v84
    v_dot2_f32_bf16 v86, v124, v124, v86
    v_dot2_f32_bf16 v85, v125, s30, v85
    v_dot2_f32_bf16 v87, v125, v125, v87
    v_dot2_f32_bf16 v84, v126, s30, v84
    v_dot2_f32_bf16 v86, v126, v126, v86
    v_dot2_f32_bf16 v85, v127, s30, v85
    v_dot2_f32_bf16 v87, v127, v127, v87
    s_waitcnt vmcnt(0)
    v_dot2_f32_bf16 v84, v128, s30, v84
    v_dot2_f32_bf16 v86, v128, v128, v86
    v_dot2_f32_bf16 v85, v129, s30, v85
    v_dot2_f32_bf16 v87, v129, v129, v87
    v_dot2_f32_bf16 v84, v130, s30, v84
    v_dot2_f32_bf16 v86, v130, v130, v86
    v_dot2_f32_bf16 v85, v131, s30, v85
    v_dot2_f32_bf16 v87, v131, v131, v87
    s_mov_b32 s30, 0x3ae38e39
    s_nop 1
    v_add_f32 v84, v84, v85
    v_add_f32 v86, v86, v87
    s_nop 0
    v_add_f32_dpp v84, v84, v84 quad_perm:[1,0,3,2] row_mask:0xf bank_mask:0xf
    v_add_f32_dpp v86, v86, v86 quad_perm:[1,0,3,2] row_mask:0xf bank_mask:0xf
    s_nop 0
    v_add_f32_dpp v84, v84, v84 quad_perm:[2,3,0,1] row_mask:0xf bank_mask:0xf
    v_add_f32_dpp v86, v86, v86 quad_perm:[2,3,0,1] row_mask:0xf bank_mask:0xf
    s_nop 0
    v_add_f32_dpp v84, v84, v84 row_half_mirror row_mask:0xf bank_mask:0xf
    v_add_f32_dpp v86, v86, v86 row_half_mirror row_mask:0xf bank_mask:0xf
    v_mul_f32 v84, s30, v84
    v_mul_f32 v86, s30, v86
    v_fma_f32 v86, -v84, v84, v86
    v_max_f32 v86, 0, v86
    v_cvt_pk_bf16_f32 v86, v86, v86
    v_lshlrev_b32 v86, 16, v86
    v_add_f32 v86, 0x3727c5ac, v86
    v_cvt_pk_bf16_f32 v86, v86, v86
    v_lshlrev_b32 v86, 16, v86
    v_sqrt_f32 v86, v86
    s_waitcnt lgkmcnt(0)
    v_add_u32_e64 v89, s7, 1
    v_cvt_pk_bf16_f32 v88, v84, v86
    buffer_store_dwordx2 v[88:89], v6, s[12:15], 0 offen sc1
    s_add_u32 s6, s6, 4
    s_branch KA_fin
KA_svc:
    s_xor_b32 s6, s6, 4
    v_xor_b32 v253, 256, v253
    s_cmp_ge_u32 s6, 4
    s_cbranch_scc1 KA_w2
    s_lshr_b32 s48, s6, 1
    s_mul_i32 s48, s48, 214
    s_add_u32 s48, s48, s6
    s_lshl_b32 s49, s2, 1
    s_add_u32 s48, s48, s49
    s_and_b32 s49, s48, 7
    s_lshr_b32 s50, s48, 3
    v_lshrrev_b32 v1, 3, v0
    v_and_b32 v2, 7, v0
    v_mul_u32_u24 v3, 6912, v1
    v_lshl_add_u32 v3, v2, 4, v3
    s_mul_i32 s51, s49, 497664
    s_lshl_b32 s52, s50, 7
    s_add_u32 s51, s51, s52
    s_mul_i32 s52, s49, 144
    v_lshl_add_u32 v4, v1, 1, s52
    s_waitcnt lgkmcnt(0)
    s_add_u32 s8, s38, 0
    s_addc_u32 s9, s39, 0
    s_mov_b32 s10, 3981312
    s_mov_b32 s11, 0x20000
    s_load_dword s7, s[42:43], 0
    global_load_ushort v10, v4, s[36:37] offset:0
    global_load_ushort v11, v4, s[36:37] offset:16
    global_load_ushort v12, v4, s[36:37] offset:32
    global_load_ushort v13, v4, s[36:37] offset:48
    global_load_ushort v14, v4, s[36:37] offset:64
    global_load_ushort v15, v4, s[36:37] offset:80
    global_load_ushort v16, v4, s[36:37] offset:96
    global_load_ushort v17, v4, s[36:37] offset:112
    global_load_ushort v18, v4, s[36:37] offset:128
    buffer_load_dwordx4 v[32:35], v3, s[8:11], s51 offen nt
    s_add_u32 s51, s51, 55296
    buffer_load_dwordx4 v[36:39], v3, s[8:11], s51 offen nt
    s_add_u32 s51, s51, 55296
    buffer_load_dwordx4 v[40:43], v3, s[8:11], s51 offen nt
    s_add_u32 s51, s51, 55296
    buffer_load_dwordx4 v[44:47], v3, s[8:11], s51 offen nt
    s_add_u32 s51, s51, 55296
    buffer_load_dwordx4 v[48:51], v3, s[8:11], s51 offen nt
    s_add_u32 s51, s51, 55296
    buffer_load_dwordx4 v[52:55], v3, s[8:11], s51 offen nt
    s_add_u32 s51, s51, 55296
    buffer_load_dwordx4 v[56:59], v3, s[8:11], s51 offen nt
    s_add_u32 s51, s51, 55296
    buffer_load_dwordx4 v[60:63], v3, s[8:11], s51 offen nt
    s_add_u32 s51, s51, 55296
    buffer_load_dwordx4 v[64:67], v3, s[8:11], s51 offen nt
    s_add_u32 s51, s51, 55296
    v_and_b32 v240, 15, v0
    v_lshrrev_b32 v241, 4, v0
    s_add_u32 s12, s42, 0
    s_addc_u32 s13, s43, 0
    s_mov_b32 s14, 268435456
    s_mov_b32 s15, 0x20000
    s_add_u32 s44, s40, 0
    s_addc_u32 s45, s41, 0
    s_mov_b32 s46, 256
    s_mov_b32 s47, 0x20000
    s_mov_b32 s25, 1069066811
    s_waitcnt vmcnt(9)
    v_lshlrev_b32 v10, 16, v10
    v_lshlrev_b32 v11, 16, v11
    v_lshlrev_b32 v12, 16, v12
    v_lshlrev_b32 v13, 16, v13
    v_lshlrev_b32 v14, 16, v14
    v_lshlrev_b32 v15, 16, v15
    v_lshlrev_b32 v16, 16, v16
    v_lshlrev_b32 v17, 16, v17
    v_lshlrev_b32 v18, 16, v18
    v_mul_f32 v20, s25, v10
    v_mul_f32 v21, s25, v11
    v_mul_f32 v22, s25, v12
    v_mul_f32 v23, s25, v13
    v_mul_f32 v24, s25, v14
    v_mul_f32 v25, s25, v15
    v_mul_f32 v26, s25, v16
    v_mul_f32 v27, s25, v17
    v_mul_f32 v28, s25, v18
    v_exp_f32 v20, -v20
    v_exp_f32 v21, -v21
    v_exp_f32 v22, -v22
    v_exp_f32 v23, -v23
    v_exp_f32 v24, -v24
    v_exp_f32 v25, -v25
    v_exp_f32 v26, -v26
    v_exp_f32 v27, -v27
    v_exp_f32 v28, -v28
    v_add_f32 v20, 1.0, v20
    v_add_f32 v21, 1.0, v21
    v_add_f32 v22, 1.0, v22
    v_add_f32 v23, 1.0, v23
    v_add_f32 v24, 1.0, v24
    v_add_f32 v25, 1.0, v25
    v_add_f32 v26, 1.0, v26
    v_add_f32 v27, 1.0, v27
    v_add_f32 v28, 1.0, v28
    v_rcp_f32 v20, v20
    v_rcp_f32 v21, v21
    v_rcp_f32 v22, v22
    v_rcp_f32 v23, v23
    v_rcp_f32 v24, v24
    v_rcp_f32 v25, v25
    v_rcp_f32 v26, v26
    v_rcp_f32 v27, v27
    v_rcp_f32 v28, v28
    v_mul_f32 v10, v10, v20
    v_mul_f32 v11, v11, v21
    v_mul_f32 v12, v12, v22
    v_mul_f32 v13, v13, v23
    v_mul_f32 v14, v14, v24
    v_mul_f32 v15, v15, v25
    v_mul_f32 v16, v16, v26
    v_mul_f32 v17, v17, v27
    v_mul_f32 v18, v18, v28
    v_cvt_pk_bf16_f32 v10, v10, v10
    v_cvt_pk_bf16_f32 v11, v11, v11
    v_cvt_pk_bf16_f32 v12, v12, v12
    v_cvt_pk_bf16_f32 v13, v13, v13
    v_cvt_pk_bf16_f32 v14, v14, v14
    v_cvt_pk_bf16_f32 v15, v15, v15
    v_cvt_pk_bf16_f32 v16, v16, v16
    v_cvt_pk_bf16_f32 v17, v17, v17
    v_cvt_pk_bf16_f32 v18, v18, v18
    v_and_b32 v20, 0xffff0000, v10
    v_and_b32 v10, 0xffff, v10
    v_and_b32 v21, 0xffff0000, v11
    v_and_b32 v11, 0xffff, v11
    v_and_b32 v22, 0xffff0000, v12
    v_and_b32 v12, 0xffff, v12
    v_and_b32 v23, 0xffff0000, v13
    v_and_b32 v13, 0xffff, v13
    v_and_b32 v24, 0xffff0000, v14
    v_and_b32 v14, 0xffff, v14
    v_and_b32 v25, 0xffff0000, v15
    v_and_b32 v15, 0xffff, v15
    v_and_b32 v26, 0xffff0000, v16
    v_and_b32 v16, 0xffff, v16
    v_and_b32 v27, 0xffff0000, v17
    v_and_b32 v17, 0xffff, v17
    v_and_b32 v28, 0xffff0000, v18
    v_and_b32 v18, 0xffff, v18
    s_waitcnt vmcnt(8)
    v_dot2_f32_bf16 v80, v32, v10, 0
    v_dot2_f32_bf16 v81, v32, v20, 0
    v_dot2_f32_bf16 v82, v33, v10, 0
    v_dot2_f32_bf16 v83, v33, v20, 0
    v_dot2_f32_bf16 v84, v34, v10, 0
    v_dot2_f32_bf16 v85, v34, v20, 0
    v_dot2_f32_bf16 v86, v35, v10, 0
    v_dot2_f32_bf16 v87, v35, v20, 0
    s_waitcnt vmcnt(7)
    v_dot2_f32_bf16 v80, v36, v11, v80
    v_dot2_f32_bf16 v81, v36, v21, v81
    v_dot2_f32_bf16 v82, v37, v11, v82
    v_dot2_f32_bf16 v83, v37, v21, v83
    v_dot2_f32_bf16 v84, v38, v11, v84
    v_dot2_f32_bf16 v85, v38, v21, v85
    v_dot2_f32_bf16 v86, v39, v11, v86
    v_dot2_f32_bf16 v87, v39, v21, v87
    s_waitcnt vmcnt(6)
    v_dot2_f32_bf16 v80, v40, v12, v80
    v_dot2_f32_bf16 v81, v40, v22, v81
    v_dot2_f32_bf16 v82, v41, v12, v82
    v_dot2_f32_bf16 v83, v41, v22, v83
    v_dot2_f32_bf16 v84, v42, v12, v84
    v_dot2_f32_bf16 v85, v42, v22, v85
    v_dot2_f32_bf16 v86, v43, v12, v86
    v_dot2_f32_bf16 v87, v43, v22, v87
    s_waitcnt vmcnt(5)
    v_dot2_f32_bf16 v80, v44, v13, v80
    v_dot2_f32_bf16 v81, v44, v23, v81
    v_dot2_f32_bf16 v82, v45, v13, v82
    v_dot2_f32_bf16 v83, v45, v23, v83
    v_dot2_f32_bf16 v84, v46, v13, v84
    v_dot2_f32_bf16 v85, v46, v23, v85
    v_dot2_f32_bf16 v86, v47, v13, v86
    v_dot2_f32_bf16 v87, v47, v23, v87
    s_waitcnt vmcnt(4)
    v_dot2_f32_bf16 v80, v48, v14, v80
    v_dot2_f32_bf16 v81, v48, v24, v81
    v_dot2_f32_bf16 v82, v49, v14, v82
    v_dot2_f32_bf16 v83, v49, v24, v83
    v_dot2_f32_bf16 v84, v50, v14, v84
    v_dot2_f32_bf16 v85, v50, v24, v85
    v_dot2_f32_bf16 v86, v51, v14, v86
    v_dot2_f32_bf16 v87, v51, v24, v87
    s_waitcnt vmcnt(3)
    v_dot2_f32_bf16 v80, v52, v15, v80
    v_dot2_f32_bf16 v81, v52, v25, v81
    v_dot2_f32_bf16 v82, v53, v15, v82
    v_dot2_f32_bf16 v83, v53, v25, v83
    v_dot2_f32_bf16 v84, v54, v15, v84
    v_dot2_f32_bf16 v85, v54, v25, v85
    v_dot2_f32_bf16 v86, v55, v15, v86
    v_dot2_f32_bf16 v87, v55, v25, v87
    s_waitcnt vmcnt(2)
    v_dot2_f32_bf16 v80, v56, v16, v80
    v_dot2_f32_bf16 v81, v56, v26, v81
    v_dot2_f32_bf16 v82, v57, v16, v82
    v_dot2_f32_bf16 v83, v57, v26, v83
    v_dot2_f32_bf16 v84, v58, v16, v84
    v_dot2_f32_bf16 v85, v58, v26, v85
    v_dot2_f32_bf16 v86, v59, v16, v86
    v_dot2_f32_bf16 v87, v59, v26, v87
    s_waitcnt vmcnt(1)
    v_dot2_f32_bf16 v80, v60, v17, v80
    v_dot2_f32_bf16 v81, v60, v27, v81
    v_dot2_f32_bf16 v82, v61, v17, v82
    v_dot2_f32_bf16 v83, v61, v27, v83
    v_dot2_f32_bf16 v84, v62, v17, v84
    v_dot2_f32_bf16 v85, v62, v27, v85
    v_dot2_f32_bf16 v86, v63, v17, v86
    v_dot2_f32_bf16 v87, v63, v27, v87
    s_waitcnt vmcnt(0)
    v_dot2_f32_bf16 v80, v64, v18, v80
    v_dot2_f32_bf16 v81, v64, v28, v81
    v_dot2_f32_bf16 v82, v65, v18, v82
    v_dot2_f32_bf16 v83, v65, v28, v83
    v_dot2_f32_bf16 v84, v66, v18, v84
    v_dot2_f32_bf16 v85, v66, v28, v85
    v_dot2_f32_bf16 v86, v67, v18, v86
    v_dot2_f32_bf16 v87, v67, v28, v87
    s_nop 2
    v_permlane32_swap_b32 v80, v84
    v_permlane32_swap_b32 v81, v85
    v_permlane32_swap_b32 v82, v86
    v_permlane32_swap_b32 v83, v87
    v_add_f32 v80, v80, v84
    v_add_f32 v81, v81, v85
    v_add_f32 v82, v82, v86
    v_add_f32 v83, v83, v87
    s_nop 1
    v_permlane16_swap_b32 v80, v82
    v_permlane16_swap_b32 v81, v83
    v_add_f32 v80, v80, v82
    v_add_f32 v82, v81, v83
    v_lshlrev_b32 v7, 4, v241
    v_lshl_add_u32 v7, v2, 6, v7
    s_waitcnt lgkmcnt(0)
    s_add_u32 s7, s7, 1
    v_mov_b32 v81, s7
    v_mov_b32 v83, s7
    v_add_f32_dpp v80, v80, v80 row_ror:8 row_mask:0xf bank_mask:0xf
    v_add_f32_dpp v82, v82, v82 row_ror:8 row_mask:0xf bank_mask:0xf
    s_mul_i32 s51, s49, 27648
    s_lshl_b32 s52, s50, 9
    s_add_u32 s51, s51, s52
    s_add_u32 s51, s51, 65536
    buffer_store_dwordx4 v[80:83], v7, s[12:15], s51 offen sc1
    s_mul_i32 s21, s2, 43
    s_lshr_b32 s21, s21, 8
    s_mul_i32 s22, s21, 6
    s_sub_u32 s20, s2, s22
    s_lshl_b32 s22, s21, 2
    s_add_u32 s22, s22, s6
    v_mul_u32_u24 v3, 73728, v241
    v_lshl_add_u32 v3, v240, 3, v3
    s_mul_i32 s23, s20, 884736
    s_lshl_b32 s26, s22, 7
    s_add_u32 s23, s23, s26
    s_add_u32 s8, s32, 0
    s_addc_u32 s9, s33, 0
    s_mov_b32 s10, 5308416
    s_mov_b32 s11, 0x20000
    buffer_load_dwordx2 v[32:33], v3, s[8:11], s23 offen nt
    s_add_u32 s23, s23, 9216
    buffer_load_dwordx2 v[34:35], v3, s[8:11], s23 offen nt
    s_add_u32 s23, s23, 9216
    buffer_load_dwordx2 v[36:37], v3, s[8:11], s23 offen nt
    s_add_u32 s23, s23, 9216
    buffer_load_dwordx2 v[38:39], v3, s[8:11], s23 offen nt
    s_add_u32 s23, s23, 9216
    buffer_load_dwordx2 v[40:41], v3, s[8:11], s23 offen nt
    s_add_u32 s23, s23, 9216
    buffer_load_dwordx2 v[42:43], v3, s[8:11], s23 offen nt
    s_add_u32 s23, s23, 9216
    buffer_load_dwordx2 v[44:45], v3, s[8:11], s23 offen nt
    s_add_u32 s23, s23, 9216
    buffer_load_dwordx2 v[46:47], v3, s[8:11], s23 offen nt
    s_add_u32 s23, s23, 230400
    buffer_load_dwordx2 v[48:49], v3, s[8:11], s23 offen nt
    s_add_u32 s23, s23, 9216
    buffer_load_dwordx2 v[50:51], v3, s[8:11], s23 offen nt
    s_add_u32 s23, s23, 9216
    buffer_load_dwordx2 v[52:53], v3, s[8:11], s23 offen nt
    s_add_u32 s23, s23, 9216
    buffer_load_dwordx2 v[54:55], v3, s[8:11], s23 offen nt
    s_add_u32 s23, s23, 9216
    buffer_load_dwordx2 v[56:57], v3, s[8:11], s23 offen nt
    s_add_u32 s23, s23, 9216
    buffer_load_dwordx2 v[58:59], v3, s[8:11], s23 offen nt
    s_add_u32 s23, s23, 9216
    buffer_load_dwordx2 v[60:61], v3, s[8:11], s23 offen nt
    s_add_u32 s23, s23, 9216
    buffer_load_dwordx2 v[62:63], v3, s[8:11], s23 offen nt
    s_add_u32 s23, s23, 230400
    buffer_load_dwordx2 v[64:65], v3, s[8:11], s23 offen nt
    s_add_u32 s23, s23, 9216
    buffer_load_dwordx2 v[66:67], v3, s[8:11], s23 offen nt
    s_add_u32 s23, s23, 9216
    buffer_load_dwordx2 v[68:69], v3, s[8:11], s23 offen nt
    s_add_u32 s23, s23, 9216
    buffer_load_dwordx2 v[70:71], v3, s[8:11], s23 offen nt
    s_add_u32 s23, s23, 9216
    buffer_load_dwordx2 v[72:73], v3, s[8:11], s23 offen nt
    s_add_u32 s23, s23, 9216
    buffer_load_dwordx2 v[74:75], v3, s[8:11], s23 offen nt
    s_add_u32 s23, s23, 9216
    buffer_load_dwordx2 v[76:77], v3, s[8:11], s23 offen nt
    s_add_u32 s23, s23, 9216
    buffer_load_dwordx2 v[78:79], v3, s[8:11], s23 offen nt
    s_add_u32 s23, s23, 230400
    v_lshlrev_b32 v7, 4, v0
    v_cmp_le_u32 vcc, 96, v253
    v_mov_b32 v5, 3840
    v_lshlrev_b32 v4, 3, v253
    v_cndmask_b32 v5, 0, v5, vcc
    v_add_u32 v4, v4, v5
    s_mul_i32 s27, s20, 768
    s_add_u32 s28, s27, 79360
    s_min_u32 s27, s2, 8
    s_lshl_b32 s27, s27, 9
    s_add_u32 s29, s27, 83200
    s_cmp_eq_u32 s6, 3
    s_cselect_b32 s28, s29, s28
    v_add_u32 v245, 55296, v4
    v_add_u32 v246, 110592, v4
    v_add_u32 v247, 165888, v4
    s_add_u32 s29, s28, 27648
    s_lshl_b32 s27, s22, 2
    s_add_u32 s27, s27, 0
    s_mul_i32 s30, s27, 7282
    s_lshr_b32 s30, s30, 16
    s_mul_i32 s31, s30, 9
    s_sub_u32 s27, s27, s31
    s_mul_i32 s30, s30, 333
    s_lshl_b32 s31, s27, 2
    s_add_u32 s31, s31, 135
    s_mul_i32 s24, s20, 27
    s_add_u32 s24, s24, s27
    s_cmp_eq_u32 s20, 5
    s_cselect_b32 s24, s31, s24
    s_add_u32 s31, s31, s30
    s_add_u32 s31, s31, 3
    s_add_u32 s30, s30, s24
    s_cmp_eq_u32 s20, 5
    s_cselect_b32 s24, 1, 9
    s_lshl_b32 s24, s24, 10
    s_lshl_b32 s30, s30, 10
    s_add_u32 s56, s30, 12320768
    s_lshl_b32 s31, s31, 10
    s_add_u32 s52, s31, 12320768
    s_lshl_b32 s27, s22, 2
    s_add_u32 s27, s27, 1
    s_mul_i32 s30, s27, 7282
    s_lshr_b32 s30, s30, 16
    s_mul_i32 s31, s30, 9
    s_sub_u32 s27, s27, s31
    s_mul_i32 s30, s30, 333
    s_lshl_b32 s31, s27, 2
    s_add_u32 s31, s31, 135
    s_mul_i32 s24, s20, 27
    s_add_u32 s24, s24, s27
    s_cmp_eq_u32 s20, 5
    s_cselect_b32 s24, s31, s24
    s_add_u32 s31, s31, s30
    s_add_u32 s31, s31, 3
    s_add_u32 s30, s30, s24
    s_cmp_eq_u32 s20, 5
    s_cselect_b32 s24, 1, 9
    s_lshl_b32 s24, s24, 10
    s_lshl_b32 s30, s30, 10
    s_add_u32 s57, s30, 12320768
    s_lshl_b32 s31, s31, 10
    s_add_u32 s53, s31, 12320768
    s_lshl_b32 s27, s22, 2
    s_add_u32 s27, s27, 2
    s_mul_i32 s30, s27, 7282
    s_lshr_b32 s30, s30, 16
    s_mul_i32 s31, s30, 9
    s_sub_u32 s27, s27, s31
    s_mul_i32 s30, s30, 333
    s_lshl_b32 s31, s27, 2
    s_add_u32 s31, s31, 135
    s_mul_i32 s24, s20, 27
    s_add_u32 s24, s24, s27
    s_cmp_eq_u32 s20, 5
    s_cselect_b32 s24, s31, s24
    s_add_u32 s31, s31, s30
    s_add_u32 s31, s31, 3
    s_add_u32 s30, s30, s24
    s_cmp_eq_u32 s20, 5
    s_cselect_b32 s24, 1, 9
    s_lshl_b32 s24, s24, 10
    s_lshl_b32 s30, s30, 10
    s_add_u32 s58, s30, 12320768
    s_lshl_b32 s31, s31, 10
    s_add_u32 s54, s31, 12320768
    s_lshl_b32 s27, s22, 2
    s_add_u32 s27, s27, 3
    s_mul_i32 s30, s27, 7282
    s_lshr_b32 s30, s30, 16
    s_mul_i32 s31, s30, 9
    s_sub_u32 s27, s27, s31
    s_mul_i32 s30, s30, 333
    s_lshl_b32 s31, s27, 2
    s_add_u32 s31, s31, 135
    s_mul_i32 s24, s20, 27
    s_add_u32 s24, s24, s27
    s_cmp_eq_u32 s20, 5
    s_cselect_b32 s24, s31, s24
    s_add_u32 s31, s31, s30
    s_add_u32 s31, s31, 3
    s_add_u32 s30, s30, s24
    s_cmp_eq_u32 s20, 5
    s_cselect_b32 s24, 1, 9
    s_lshl_b32 s24, s24, 10
    s_lshl_b32 s30, s30, 10
    s_add_u32 s59, s30, 12320768
    s_lshl_b32 s31, s31, 10
    s_add_u32 s55, s31, 12320768
    v_lshlrev_b32 v6, 3, v253
    v_mov_b32 v5, 0xfffffd00
    v_cndmask_b32 v5, 4, v5, vcc
    v_add_u32 v6, v6, v5
    v_lshlrev_b32 v28, 6, v241
    v_mov_b32 v248, 0x3f803f80
    v_mov_b32 v249, v248
    v_mov_b32 v250, v248
    v_mov_b32 v251, v248
    s_mov_b64 s[38:39], vcc
    s_mov_b32 s60, 0
KS_poll:
    buffer_load_dwordx2 v[8:9], v4, s[12:15], s28 offen sc1
    buffer_load_dwordx2 v[10:11], v4, s[12:15], s29 offen sc1
    buffer_load_dwordx2 v[12:13], v245, s[12:15], s28 offen sc1
    buffer_load_dwordx2 v[14:15], v245, s[12:15], s29 offen sc1
    buffer_load_dwordx2 v[16:17], v246, s[12:15], s28 offen sc1
    buffer_load_dwordx2 v[18:19], v246, s[12:15], s29 offen sc1
    buffer_load_dwordx2 v[20:21], v247, s[12:15], s28 offen sc1
    buffer_load_dwordx2 v[22:23], v247, s[12:15], s29 offen sc1
KS_poll_w:
    s_add_u32 s60, s60, 1
    s_waitcnt vmcnt(0)
    v_cmpx_eq_u32 vcc, s7, v9
    v_cmpx_eq_u32 vcc, s7, v11
    v_cmpx_eq_u32 vcc, s7, v13
    v_cmpx_eq_u32 vcc, s7, v15
    v_cmpx_eq_u32 vcc, s7, v17
    v_cmpx_eq_u32 vcc, s7, v19
    v_cmpx_eq_u32 vcc, s7, v21
    v_cmpx_eq_u32 vcc, s7, v23
    s_nop 4
    s_cmp_eq_u64 exec, -1
    s_mov_b64 exec, -1
    s_cbranch_scc1 KS_poll_ok
    s_sleep 1
    s_cmp_lt_u32 s60, 0x8000
    s_cbranch_scc1 KS_poll
KS_poll_ok:
    v_add_f32 v8, v8, v10
    v_add_f32 v12, v12, v14
    v_add_f32 v16, v16, v18
    v_add_f32 v20, v20, v22
    v_add_f32 v8, v8, v12
    v_add_f32 v16, v16, v20
    v_add_f32 v8, v8, v16
    v_cvt_pk_bf16_f32 v8, v8, v8
    v_lshlrev_b32 v8, 16, v8
    v_add_f32 v9, 1.0, v8
    v_cvt_pk_bf16_f32 v9, v9, v9
    v_lshlrev_b32 v9, 16, v9
    v_cndmask_b32 v9, v8, v9, s[38:39]
    ds_write_b32 v6, v9
    s_min_u32 s27, s2, 8
    s_lshl_b32 s27, s27, 8
    s_add_u32 s27, s27, 7340032
    s_cmp_eq_u32 s6, 3
    s_cselect_b32 s27, s27, 1879048192
    s_cmp_lt_u32 s2, 9
    s_cselect_b32 s27, s27, 1879048192
    v_lshl_add_u32 v10, v0, 2, s27
    buffer_store_dword v8, v10, s[12:15], 0 offen
    s_waitcnt lgkmcnt(0)
    s_barrier
    v_mov_b32 v30, 1879048192
    v_cmp_ne_u32 vcc, 0, v253
    v_mov_b32 v31, 1
    s_nop 0
    v_cndmask_b32 v30, 0, v30, vcc
    buffer_atomic_add v31, v30, s[44:47], 0 offen sc0
    ds_read_b128 v[80:83], v28 offset:0
    ds_read_b128 v[84:87], v28 offset:16
    ds_read_b128 v[88:91], v28 offset:32
    ds_read_b128 v[92:95], v28 offset:48
    ds_read_b128 v[96:99], v28 offset:256
    ds_read_b128 v[100:103], v28 offset:272
    ds_read_b128 v[104:107], v28 offset:288
    ds_read_b128 v[108:111], v28 offset:304
    ds_read_b128 v[112:115], v28 offset:512
    ds_read_b128 v[116:119], v28 offset:528
    ds_read_b128 v[120:123], v28 offset:544
    ds_read_b128 v[124:127], v28 offset:560
    s_waitcnt lgkmcnt(8)
    v_lshlrev_b32 v128, 16, v32
    v_and_b32 v129, 0xffff0000, v32
    v_lshlrev_b32 v130, 16, v33
    v_and_b32 v131, 0xffff0000, v33
    v_pk_mul_f32 v[24:25], v[128:129], v[80:81] op_sel:[0,1] op_sel_hi:[1,1]
    v_pk_mul_f32 v[26:27], v[130:131], v[80:81] op_sel:[0,1] op_sel_hi:[1,1]
    v_pk_mul_f32 v[128:129], v[128:129], v[80:81] op_sel:[0,0] op_sel_hi:[1,0]
    v_pk_mul_f32 v[130:131], v[130:131], v[80:81] op_sel:[0,0] op_sel_hi:[1,0]
    v_lshlrev_b32 v132, 16, v34
    v_and_b32 v133, 0xffff0000, v34
    v_lshlrev_b32 v134, 16, v35
    v_and_b32 v135, 0xffff0000, v35
    v_pk_fma_f32 v[24:25], v[132:133], v[82:83], v[24:25] op_sel:[0,1,0] op_sel_hi:[1,1,1]
    v_pk_fma_f32 v[26:27], v[134:135], v[82:83], v[26:27] op_sel:[0,1,0] op_sel_hi:[1,1,1]
    v_pk_mul_f32 v[132:133], v[132:133], v[82:83] op_sel:[0,0] op_sel_hi:[1,0]
    v_pk_mul_f32 v[134:135], v[134:135], v[82:83] op_sel:[0,0] op_sel_hi:[1,0]
    v_lshlrev_b32 v136, 16, v36
    v_and_b32 v137, 0xffff0000, v36
    v_lshlrev_b32 v138, 16, v37
    v_and_b32 v139, 0xffff0000, v37
    v_pk_fma_f32 v[24:25], v[136:137], v[84:85], v[24:25] op_sel:[0,1,0] op_sel_hi:[1,1,1]
    v_pk_fma_f32 v[26:27], v[138:139], v[84:85], v[26:27] op_sel:[0,1,0] op_sel_hi:[1,1,1]
    v_pk_mul_f32 v[136:137], v[136:137], v[84:85] op_sel:[0,0] op_sel_hi:[1,0]
    v_pk_mul_f32 v[138:139], v[138:139], v[84:85] op_sel:[0,0] op_sel_hi:[1,0]
    v_lshlrev_b32 v140, 16, v38
    v_and_b32 v141, 0xffff0000, v38
    v_lshlrev_b32 v142, 16, v39
    v_and_b32 v143, 0xffff0000, v39
    v_pk_fma_f32 v[24:25], v[140:141], v[86:87], v[24:25] op_sel:[0,1,0] op_sel_hi:[1,1,1]
    v_pk_fma_f32 v[26:27], v[142:143], v[86:87], v[26:27] op_sel:[0,1,0] op_sel_hi:[1,1,1]
    v_pk_mul_f32 v[140:141], v[140:141], v[86:87] op_sel:[0,0] op_sel_hi:[1,0]
    v_pk_mul_f32 v[142:143], v[142:143], v[86:87] op_sel:[0,0] op_sel_hi:[1,0]
    v_lshlrev_b32 v144, 16, v40
    v_and_b32 v145, 0xffff0000, v40
    v_lshlrev_b32 v146, 16, v41
    v_and_b32 v147, 0xffff0000, v41
    v_pk_fma_f32 v[24:25], v[144:145], v[88:89], v[24:25] op_sel:[0,1,0] op_sel_hi:[1,1,1]
    v_pk_fma_f32 v[26:27], v[146:147], v[88:89], v[26:27] op_sel:[0,1,0] op_sel_hi:[1,1,1]
    v_pk_mul_f32 v[144:145], v[144:145], v[88:89] op_sel:[0,0] op_sel_hi:[1,0]
    v_pk_mul_f32 v[146:147], v[146:147], v[88:89] op_sel:[0,0] op_sel_hi:[1,0]
    v_lshlrev_b32 v148, 16, v42
    v_and_b32 v149, 0xffff0000, v42
    v_lshlrev_b32 v150, 16, v43
    v_and_b32 v151, 0xffff0000, v43
    v_pk_fma_f32 v[24:25], v[148:149], v[90:91], v[24:25] op_sel:[0,1,0] op_sel_hi:[1,1,1]
    v_pk_fma_f32 v[26:27], v[150:151], v[90:91], v[26:27] op_sel:[0,1,0] op_sel_hi:[1,1,1]
    v_pk_mul_f32 v[148:149], v[148:149], v[90:91] op_sel:[0,0] op_sel_hi:[1,0]
    v_pk_mul_f32 v[150:151], v[150:151], v[90:91] op_sel:[0,0] op_sel_hi:[1,0]
    v_lshlrev_b32 v152, 16, v44
    v_and_b32 v153, 0xffff0000, v44
    v_lshlrev_b32 v154, 16, v45
    v_and_b32 v155, 0xffff0000, v45
    v_pk_fma_f32 v[24:25], v[152:153], v[92:93], v[24:25] op_sel:[0,1,0] op_sel_hi:[1,1,1]
    v_pk_fma_f32 v[26:27], v[154:155], v[92:93], v[26:27] op_sel:[0,1,0] op_sel_hi:[1,1,1]
    v_pk_mul_f32 v[152:153], v[152:153], v[92:93] op_sel:[0,0] op_sel_hi:[1,0]
    v_pk_mul_f32 v[154:155], v[154:155], v[92:93] op_sel:[0,0] op_sel_hi:[1,0]
    v_lshlrev_b32 v156, 16, v46
    v_and_b32 v157, 0xffff0000, v46
    v_lshlrev_b32 v158, 16, v47
    v_and_b32 v159, 0xffff0000, v47
    v_pk_fma_f32 v[24:25], v[156:157], v[94:95], v[24:25] op_sel:[0,1,0] op_sel_hi:[1,1,1]
    v_pk_fma_f32 v[26:27], v[158:159], v[94:95], v[26:27] op_sel:[0,1,0] op_sel_hi:[1,1,1]
    v_pk_mul_f32 v[156:157], v[156:157], v[94:95] op_sel:[0,0] op_sel_hi:[1,0]
    v_pk_mul_f32 v[158:159], v[158:159], v[94:95] op_sel:[0,0] op_sel_hi:[1,0]
    v_cvt_pk_bf16_f32 v176, v128, v132
    v_cvt_pk_bf16_f32 v177, v136, v140
    v_cvt_pk_bf16_f32 v178, v144, v148
    v_cvt_pk_bf16_f32 v179, v152, v156
    buffer_store_dwordx4 v[176:179], v7, s[12:15], s56 offen sc1
    s_add_u32 s56, s56, s24
    v_mfma_f32_16x16x32_bf16 v[160:163], v[248:251], v[176:179], 0
    v_cvt_pk_bf16_f32 v180, v129, v133
    v_cvt_pk_bf16_f32 v181, v137, v141
    v_cvt_pk_bf16_f32 v182, v145, v149
    v_cvt_pk_bf16_f32 v183, v153, v157
    buffer_store_dwordx4 v[180:183], v7, s[12:15], s57 offen sc1
    s_add_u32 s57, s57, s24
    v_mfma_f32_16x16x32_bf16 v[164:167], v[248:251], v[180:183], 0
    v_cvt_pk_bf16_f32 v184, v130, v134
    v_cvt_pk_bf16_f32 v185, v138, v142
    v_cvt_pk_bf16_f32 v186, v146, v150
    v_cvt_pk_bf16_f32 v187, v154, v158
    buffer_store_dwordx4 v[184:187], v7, s[12:15], s58 offen sc1
    s_add_u32 s58, s58, s24
    v_mfma_f32_16x16x32_bf16 v[168:171], v[248:251], v[184:187], 0
    v_cvt_pk_bf16_f32 v188, v131, v135
    v_cvt_pk_bf16_f32 v189, v139, v143
    v_cvt_pk_bf16_f32 v190, v147, v151
    v_cvt_pk_bf16_f32 v191, v155, v159
    buffer_store_dwordx4 v[188:191], v7, s[12:15], s59 offen sc1
    s_add_u32 s59, s59, s24
    v_mfma_f32_16x16x32_bf16 v[172:175], v[248:251], v[188:191], 0
    s_waitcnt lgkmcnt(4)
    v_lshlrev_b32 v128, 16, v48
    v_and_b32 v129, 0xffff0000, v48
    v_lshlrev_b32 v130, 16, v49
    v_and_b32 v131, 0xffff0000, v49
    v_pk_fma_f32 v[24:25], v[128:129], v[96:97], v[24:25] op_sel:[0,1,0] op_sel_hi:[1,1,1]
    v_pk_fma_f32 v[26:27], v[130:131], v[96:97], v[26:27] op_sel:[0,1,0] op_sel_hi:[1,1,1]
    v_pk_mul_f32 v[128:129], v[128:129], v[96:97] op_sel:[0,0] op_sel_hi:[1,0]
    v_pk_mul_f32 v[130:131], v[130:131], v[96:97] op_sel:[0,0] op_sel_hi:[1,0]
    v_lshlrev_b32 v132, 16, v50
    v_and_b32 v133, 0xffff0000, v50
    v_lshlrev_b32 v134, 16, v51
    v_and_b32 v135, 0xffff0000, v51
    v_pk_fma_f32 v[24:25], v[132:133], v[98:99], v[24:25] op_sel:[0,1,0] op_sel_hi:[1,1,1]
    v_pk_fma_f32 v[26:27], v[134:135], v[98:99], v[26:27] op_sel:[0,1,0] op_sel_hi:[1,1,1]
    v_pk_mul_f32 v[132:133], v[132:133], v[98:99] op_sel:[0,0] op_sel_hi:[1,0]
    v_pk_mul_f32 v[134:135], v[134:135], v[98:99] op_sel:[0,0] op_sel_hi:[1,0]
    v_lshlrev_b32 v136, 16, v52
    v_and_b32 v137, 0xffff0000, v52
    v_lshlrev_b32 v138, 16, v53
    v_and_b32 v139, 0xffff0000, v53
    v_pk_fma_f32 v[24:25], v[136:137], v[100:101], v[24:25] op_sel:[0,1,0] op_sel_hi:[1,1,1]
    v_pk_fma_f32 v[26:27], v[138:139], v[100:101], v[26:27] op_sel:[0,1,0] op_sel_hi:[1,1,1]
    v_pk_mul_f32 v[136:137], v[136:137], v[100:101] op_sel:[0,0] op_sel_hi:[1,0]
    v_pk_mul_f32 v[138:139], v[138:139], v[100:101] op_sel:[0,0] op_sel_hi:[1,0]
    v_lshlrev_b32 v140, 16, v54
    v_and_b32 v141, 0xffff0000, v54
    v_lshlrev_b32 v142, 16, v55
    v_and_b32 v143, 0xffff0000, v55
    v_pk_fma_f32 v[24:25], v[140:141], v[102:103], v[24:25] op_sel:[0,1,0] op_sel_hi:[1,1,1]
    v_pk_fma_f32 v[26:27], v[142:143], v[102:103], v[26:27] op_sel:[0,1,0] op_sel_hi:[1,1,1]
    v_pk_mul_f32 v[140:141], v[140:141], v[102:103] op_sel:[0,0] op_sel_hi:[1,0]
    v_pk_mul_f32 v[142:143], v[142:143], v[102:103] op_sel:[0,0] op_sel_hi:[1,0]
    v_lshlrev_b32 v144, 16, v56
    v_and_b32 v145, 0xffff0000, v56
    v_lshlrev_b32 v146, 16, v57
    v_and_b32 v147, 0xffff0000, v57
    v_pk_fma_f32 v[24:25], v[144:145], v[104:105], v[24:25] op_sel:[0,1,0] op_sel_hi:[1,1,1]
    v_pk_fma_f32 v[26:27], v[146:147], v[104:105], v[26:27] op_sel:[0,1,0] op_sel_hi:[1,1,1]
    v_pk_mul_f32 v[144:145], v[144:145], v[104:105] op_sel:[0,0] op_sel_hi:[1,0]
    v_pk_mul_f32 v[146:147], v[146:147], v[104:105] op_sel:[0,0] op_sel_hi:[1,0]
    v_lshlrev_b32 v148, 16, v58
    v_and_b32 v149, 0xffff0000, v58
    v_lshlrev_b32 v150, 16, v59
    v_and_b32 v151, 0xffff0000, v59
    v_pk_fma_f32 v[24:25], v[148:149], v[106:107], v[24:25] op_sel:[0,1,0] op_sel_hi:[1,1,1]
    v_pk_fma_f32 v[26:27], v[150:151], v[106:107], v[26:27] op_sel:[0,1,0] op_sel_hi:[1,1,1]
    v_pk_mul_f32 v[148:149], v[148:149], v[106:107] op_sel:[0,0] op_sel_hi:[1,0]
    v_pk_mul_f32 v[150:151], v[150:151], v[106:107] op_sel:[0,0] op_sel_hi:[1,0]
    v_lshlrev_b32 v152, 16, v60
    v_and_b32 v153, 0xffff0000, v60
    v_lshlrev_b32 v154, 16, v61
    v_and_b32 v155, 0xffff0000, v61
    v_pk_fma_f32 v[24:25], v[152:153], v[108:109], v[24:25] op_sel:[0,1,0] op_sel_hi:[1,1,1]
    v_pk_fma_f32 v[26:27], v[154:155], v[108:109], v[26:27] op_sel:[0,1,0] op_sel_hi:[1,1,1]
    v_pk_mul_f32 v[152:153], v[152:153], v[108:109] op_sel:[0,0] op_sel_hi:[1,0]
    v_pk_mul_f32 v[154:155], v[154:155], v[108:109] op_sel:[0,0] op_sel_hi:[1,0]
    v_lshlrev_b32 v156, 16, v62
    v_and_b32 v157, 0xffff0000, v62
    v_lshlrev_b32 v158, 16, v63
    v_and_b32 v159, 0xffff0000, v63
    v_pk_fma_f32 v[24:25], v[156:157], v[110:111], v[24:25] op_sel:[0,1,0] op_sel_hi:[1,1,1]
    v_pk_fma_f32 v[26:27], v[158:159], v[110:111], v[26:27] op_sel:[0,1,0] op_sel_hi:[1,1,1]
    v_pk_mul_f32 v[156:157], v[156:157], v[110:111] op_sel:[0,0] op_sel_hi:[1,0]
    v_pk_mul_f32 v[158:159], v[158:159], v[110:111] op_sel:[0,0] op_sel_hi:[1,0]
    v_cvt_pk_bf16_f32 v192, v128, v132
    v_cvt_pk_bf16_f32 v193, v136, v140
    v_cvt_pk_bf16_f32 v194, v144, v148
    v_cvt_pk_bf16_f32 v195, v152, v156
    buffer_store_dwordx4 v[192:195], v7, s[12:15], s56 offen sc1
    s_add_u32 s56, s56, s24
    v_mfma_f32_16x16x32_bf16 v[160:163], v[248:251], v[192:195], v[160:163]
    v_cvt_pk_bf16_f32 v196, v129, v133
    v_cvt_pk_bf16_f32 v197, v137, v141
    v_cvt_pk_bf16_f32 v198, v145, v149
    v_cvt_pk_bf16_f32 v199, v153, v157
    buffer_store_dwordx4 v[196:199], v7, s[12:15], s57 offen sc1
    s_add_u32 s57, s57, s24
    v_mfma_f32_16x16x32_bf16 v[164:167], v[248:251], v[196:199], v[164:167]
    v_cvt_pk_bf16_f32 v200, v130, v134
    v_cvt_pk_bf16_f32 v201, v138, v142
    v_cvt_pk_bf16_f32 v202, v146, v150
    v_cvt_pk_bf16_f32 v203, v154, v158
    buffer_store_dwordx4 v[200:203], v7, s[12:15], s58 offen sc1
    s_add_u32 s58, s58, s24
    v_mfma_f32_16x16x32_bf16 v[168:171], v[248:251], v[200:203], v[168:171]
    v_cvt_pk_bf16_f32 v204, v131, v135
    v_cvt_pk_bf16_f32 v205, v139, v143
    v_cvt_pk_bf16_f32 v206, v147, v151
    v_cvt_pk_bf16_f32 v207, v155, v159
    buffer_store_dwordx4 v[204:207], v7, s[12:15], s59 offen sc1
    s_add_u32 s59, s59, s24
    v_mfma_f32_16x16x32_bf16 v[172:175], v[248:251], v[204:207], v[172:175]
    s_waitcnt lgkmcnt(0)
    v_lshlrev_b32 v128, 16, v64
    v_and_b32 v129, 0xffff0000, v64
    v_lshlrev_b32 v130, 16, v65
    v_and_b32 v131, 0xffff0000, v65
    v_pk_fma_f32 v[24:25], v[128:129], v[112:113], v[24:25] op_sel:[0,1,0] op_sel_hi:[1,1,1]
    v_pk_fma_f32 v[26:27], v[130:131], v[112:113], v[26:27] op_sel:[0,1,0] op_sel_hi:[1,1,1]
    v_pk_mul_f32 v[128:129], v[128:129], v[112:113] op_sel:[0,0] op_sel_hi:[1,0]
    v_pk_mul_f32 v[130:131], v[130:131], v[112:113] op_sel:[0,0] op_sel_hi:[1,0]
    v_lshlrev_b32 v132, 16, v66
    v_and_b32 v133, 0xffff0000, v66
    v_lshlrev_b32 v134, 16, v67
    v_and_b32 v135, 0xffff0000, v67
    v_pk_fma_f32 v[24:25], v[132:133], v[114:115], v[24:25] op_sel:[0,1,0] op_sel_hi:[1,1,1]
    v_pk_fma_f32 v[26:27], v[134:135], v[114:115], v[26:27] op_sel:[0,1,0] op_sel_hi:[1,1,1]
    v_pk_mul_f32 v[132:133], v[132:133], v[114:115] op_sel:[0,0] op_sel_hi:[1,0]
    v_pk_mul_f32 v[134:135], v[134:135], v[114:115] op_sel:[0,0] op_sel_hi:[1,0]
    v_lshlrev_b32 v136, 16, v68
    v_and_b32 v137, 0xffff0000, v68
    v_lshlrev_b32 v138, 16, v69
    v_and_b32 v139, 0xffff0000, v69
    v_pk_fma_f32 v[24:25], v[136:137], v[116:117], v[24:25] op_sel:[0,1,0] op_sel_hi:[1,1,1]
    v_pk_fma_f32 v[26:27], v[138:139], v[116:117], v[26:27] op_sel:[0,1,0] op_sel_hi:[1,1,1]
    v_pk_mul_f32 v[136:137], v[136:137], v[116:117] op_sel:[0,0] op_sel_hi:[1,0]
    v_pk_mul_f32 v[138:139], v[138:139], v[116:117] op_sel:[0,0] op_sel_hi:[1,0]
    v_lshlrev_b32 v140, 16, v70
    v_and_b32 v141, 0xffff0000, v70
    v_lshlrev_b32 v142, 16, v71
    v_and_b32 v143, 0xffff0000, v71
    v_pk_fma_f32 v[24:25], v[140:141], v[118:119], v[24:25] op_sel:[0,1,0] op_sel_hi:[1,1,1]
    v_pk_fma_f32 v[26:27], v[142:143], v[118:119], v[26:27] op_sel:[0,1,0] op_sel_hi:[1,1,1]
    v_pk_mul_f32 v[140:141], v[140:141], v[118:119] op_sel:[0,0] op_sel_hi:[1,0]
    v_pk_mul_f32 v[142:143], v[142:143], v[118:119] op_sel:[0,0] op_sel_hi:[1,0]
    v_lshlrev_b32 v144, 16, v72
    v_and_b32 v145, 0xffff0000, v72
    v_lshlrev_b32 v146, 16, v73
    v_and_b32 v147, 0xffff0000, v73
    v_pk_fma_f32 v[24:25], v[144:145], v[120:121], v[24:25] op_sel:[0,1,0] op_sel_hi:[1,1,1]
    v_pk_fma_f32 v[26:27], v[146:147], v[120:121], v[26:27] op_sel:[0,1,0] op_sel_hi:[1,1,1]
    v_pk_mul_f32 v[144:145], v[144:145], v[120:121] op_sel:[0,0] op_sel_hi:[1,0]
    v_pk_mul_f32 v[146:147], v[146:147], v[120:121] op_sel:[0,0] op_sel_hi:[1,0]
    v_lshlrev_b32 v148, 16, v74
    v_and_b32 v149, 0xffff0000, v74
    v_lshlrev_b32 v150, 16, v75
    v_and_b32 v151, 0xffff0000, v75
    v_pk_fma_f32 v[24:25], v[148:149], v[122:123], v[24:25] op_sel:[0,1,0] op_sel_hi:[1,1,1]
    v_pk_fma_f32 v[26:27], v[150:151], v[122:123], v[26:27] op_sel:[0,1,0] op_sel_hi:[1,1,1]
    v_pk_mul_f32 v[148:149], v[148:149], v[122:123] op_sel:[0,0] op_sel_hi:[1,0]
    v_pk_mul_f32 v[150:151], v[150:151], v[122:123] op_sel:[0,0] op_sel_hi:[1,0]
    v_lshlrev_b32 v152, 16, v76
    v_and_b32 v153, 0xffff0000, v76
    v_lshlrev_b32 v154, 16, v77
    v_and_b32 v155, 0xffff0000, v77
    v_pk_fma_f32 v[24:25], v[152:153], v[124:125], v[24:25] op_sel:[0,1,0] op_sel_hi:[1,1,1]
    v_pk_fma_f32 v[26:27], v[154:155], v[124:125], v[26:27] op_sel:[0,1,0] op_sel_hi:[1,1,1]
    v_pk_mul_f32 v[152:153], v[152:153], v[124:125] op_sel:[0,0] op_sel_hi:[1,0]
    v_pk_mul_f32 v[154:155], v[154:155], v[124:125] op_sel:[0,0] op_sel_hi:[1,0]
    v_lshlrev_b32 v156, 16, v78
    v_and_b32 v157, 0xffff0000, v78
    v_lshlrev_b32 v158, 16, v79
    v_and_b32 v159, 0xffff0000, v79
    v_pk_fma_f32 v[24:25], v[156:157], v[126:127], v[24:25] op_sel:[0,1,0] op_sel_hi:[1,1,1]
    v_pk_fma_f32 v[26:27], v[158:159], v[126:127], v[26:27] op_sel:[0,1,0] op_sel_hi:[1,1,1]
    v_pk_mul_f32 v[156:157], v[156:157], v[126:127] op_sel:[0,0] op_sel_hi:[1,0]
    v_pk_mul_f32 v[158:159], v[158:159], v[126:127] op_sel:[0,0] op_sel_hi:[1,0]
    v_cvt_pk_bf16_f32 v208, v128, v132
    v_cvt_pk_bf16_f32 v209, v136, v140
    v_cvt_pk_bf16_f32 v210, v144, v148
    v_cvt_pk_bf16_f32 v211, v152, v156
    buffer_store_dwordx4 v[208:211], v7, s[12:15], s56 offen sc1
    s_add_u32 s56, s56, s24
    v_mfma_f32_16x16x32_bf16 v[160:163], v[248:251], v[208:211], v[160:163]
    v_cvt_pk_bf16_f32 v212, v129, v133
    v_cvt_pk_bf16_f32 v213, v137, v141
    v_cvt_pk_bf16_f32 v214, v145, v149
    v_cvt_pk_bf16_f32 v215, v153, v157
    buffer_store_dwordx4 v[212:215], v7, s[12:15], s57 offen sc1
    s_add_u32 s57, s57, s24
    v_mfma_f32_16x16x32_bf16 v[164:167], v[248:251], v[212:215], v[164:167]
    v_cvt_pk_bf16_f32 v216, v130, v134
    v_cvt_pk_bf16_f32 v217, v138, v142
    v_cvt_pk_bf16_f32 v218, v146, v150
    v_cvt_pk_bf16_f32 v219, v154, v158
    buffer_store_dwordx4 v[216:219], v7, s[12:15], s58 offen sc1
    s_add_u32 s58, s58, s24
    v_mfma_f32_16x16x32_bf16 v[168:171], v[248:251], v[216:219], v[168:171]
    v_cvt_pk_bf16_f32 v220, v131, v135
    v_cvt_pk_bf16_f32 v221, v139, v143
    v_cvt_pk_bf16_f32 v222, v147, v151
    v_cvt_pk_bf16_f32 v223, v155, v159
    buffer_store_dwordx4 v[220:223], v7, s[12:15], s59 offen sc1
    s_add_u32 s59, s59, s24
    v_mfma_f32_16x16x32_bf16 v[172:175], v[248:251], v[220:223], v[172:175]
    v_mov_b32 v8, v24
    v_mov_b32 v9, v25
    v_mov_b32 v10, v26
    v_mov_b32 v11, v27
    s_nop 1
    v_permlane32_swap_b32 v24, v8
    v_permlane32_swap_b32 v25, v9
    v_permlane32_swap_b32 v26, v10
    v_permlane32_swap_b32 v27, v11
    v_add_f32 v24, v24, v8
    v_add_f32 v25, v25, v9
    v_add_f32 v26, v26, v10
    v_add_f32 v27, v27, v11
    v_mov_b32 v8, v24
    v_mov_b32 v9, v25
    v_mov_b32 v10, v26
    v_mov_b32 v11, v27
    s_nop 1
    v_permlane16_swap_b32 v24, v8
    v_permlane16_swap_b32 v25, v9
    v_permlane16_swap_b32 v26, v10
    v_permlane16_swap_b32 v27, v11
    v_add_f32 v24, v24, v8
    v_add_f32 v25, v25, v9
    v_add_f32 v26, v26, v10
    v_add_f32 v27, v27, v11
    s_lshr_b32 s29, s20, 1
    s_lshl_b32 s29, s29, 8
    s_and_b32 s30, s20, 1
    s_lshl_b32 s30, s30, 3
    s_add_u32 s29, s29, s30
    s_add_u32 s30, s30, 768
    s_cmp_lt_u32 s20, 2
    s_cselect_b32 s30, s30, 1879048192
    v_cmp_eq_u32 vcc, 0, v241
    v_cmp_eq_u32 s[32:33], 1, v241
    v_mov_b32 v12, 1879048192
    v_mov_b32 v13, s29
    v_mov_b32 v14, s30
    v_cndmask_b32 v12, v12, v13, vcc
    v_cndmask_b32 v12, v12, v14, s[32:33]
    v_lshl_add_u32 v12, v240, 4, v12
    v_cvt_pk_bf16_f32 v8, v24, v160
    v_lshlrev_b32 v9, 16, v8
    v_and_b32 v10, 0xffff0000, v8
    v_sub_f32 v15, v24, v9
    v_sub_f32 v11, v160, v10
    v_cvt_pk_bf16_f32 v32, v9, v15
    v_cvt_pk_bf16_f32 v33, v10, v11
    v_cndmask_b32 v32, 0, v32, vcc
    v_cndmask_b32 v33, 0, v33, vcc
    buffer_store_dwordx2 v[32:33], v12, s[12:15], s52 offen
    v_cvt_pk_bf16_f32 v8, v25, v164
    v_lshlrev_b32 v9, 16, v8
    v_and_b32 v10, 0xffff0000, v8
    v_sub_f32 v15, v25, v9
    v_sub_f32 v11, v164, v10
    v_cvt_pk_bf16_f32 v34, v9, v15
    v_cvt_pk_bf16_f32 v35, v10, v11
    v_cndmask_b32 v34, 0, v34, vcc
    v_cndmask_b32 v35, 0, v35, vcc
    buffer_store_dwordx2 v[34:35], v12, s[12:15], s53 offen
    v_cvt_pk_bf16_f32 v8, v26, v168
    v_lshlrev_b32 v9, 16, v8
    v_and_b32 v10, 0xffff0000, v8
    v_sub_f32 v15, v26, v9
    v_sub_f32 v11, v168, v10
    v_cvt_pk_bf16_f32 v36, v9, v15
    v_cvt_pk_bf16_f32 v37, v10, v11
    v_cndmask_b32 v36, 0, v36, vcc
    v_cndmask_b32 v37, 0, v37, vcc
    buffer_store_dwordx2 v[36:37], v12, s[12:15], s54 offen
    v_cvt_pk_bf16_f32 v8, v27, v172
    v_lshlrev_b32 v9, 16, v8
    v_and_b32 v10, 0xffff0000, v8
    v_sub_f32 v15, v27, v9
    v_sub_f32 v11, v172, v10
    v_cvt_pk_bf16_f32 v38, v9, v15
    v_cvt_pk_bf16_f32 v39, v10, v11
    v_cndmask_b32 v38, 0, v38, vcc
    v_cndmask_b32 v39, 0, v39, vcc
    buffer_store_dwordx2 v[38:39], v12, s[12:15], s55 offen
    s_waitcnt vmcnt(16)
    s_mul_i32 s61, s6, 108
    s_add_u32 s61, s61, s2
    v_lshlrev_b32 v40, 4, v0
    v_mov_b32 v44, -1
    v_mov_b32 v45, -1
    v_mov_b32 v46, -1
    v_mov_b32 v47, -1
KA_sn:
    s_lshr_b32 s57, s61, 2
    s_and_b32 s56, s57, 31
    s_mul_i32 s58, s56, 57
    s_lshr_b32 s58, s58, 9
    s_mul_i32 s58, s58, 9
    s_sub_u32 s56, s56, s58
    s_lshl_b32 s56, s56, 1
    s_and_b32 s58, s61, 3
    s_add_u32 s56, s56, s58
    s_add_u32 s56, s56, 14
    s_cmp_ge_u32 s56, 18
    s_cselect_b32 s58, 18, 0
    s_sub_u32 s56, s56, s58
    s_mul_i32 s57, s57, 18
    s_add_u32 s56, s56, s57
    s_lshl_b32 s56, s56, 12
    s_add_u32 s56, s56, 23330816
    buffer_store_dwordx4 v[44:47], v40, s[12:15], s56 offen offset:0 sc1
    buffer_store_dwordx4 v[44:47], v40, s[12:15], s56 offen offset:1024 sc1
    buffer_store_dwordx4 v[44:47], v40, s[12:15], s56 offen offset:2048 sc1
    buffer_store_dwordx4 v[44:47], v40, s[12:15], s56 offen offset:3072 sc1
    s_add_u32 s61, s61, 432
    s_cmp_lt_u32 s61, 1024
    s_cbranch_scc1 KA_sn
KA_end:
    v_cmp_eq_u32 vcc, 251, v31
    v_mov_b32 v29, 1879048192
    v_mov_b32 v28, s7
    v_cndmask_b32 v30, v29, v30, vcc
    buffer_store_dword v28, v30, s[12:15], 0 offen offset:0
KA_fin:
KA_done:
    s_endpgm
.section .rodata,"a"
.p2align 6
.amdhsa_kernel ka_kernel
  .amdhsa_next_free_vgpr 256
  .amdhsa_next_free_sgpr 102
  .amdhsa_accum_offset 256
  .amdhsa_group_segment_fixed_size 0
  .amdhsa_kernarg_size 120
  .amdhsa_user_sgpr_count 2
  .amdhsa_user_sgpr_kernarg_segment_ptr 1
  .amdhsa_system_sgpr_workgroup_id_x 1
  .amdhsa_float_denorm_mode_32 3
.end_amdhsa_kernel
.text
.globl kb_kernel
.p2align 8
.type kb_kernel,@function
kb_kernel:
    s_cmp_ge_u32 s2, 256
    s_cbranch_scc1 KB_done
    s_load_dwordx2 s[4:5], s[0:1], 112
    s_load_dwordx2 s[46:47], s[0:1], 96
    v_lshrrev_b32 v1, 6, v0
    v_and_b32 v0, 63, v0
    v_lshlrev_b32 v2, 4, v0
    v_readfirstlane_b32 s6, v1
    s_and_b32 s19, s2, 3
    s_lshl_b32 s19, s19, 1
    s_bfe_u32 s3, s2, 0x10003
    s_add_u32 s19, s19, s3
    s_bfe_u32 s3, s2, 0x10002
    s_lshl_b32 s3, s3, 4
    s_lshr_b32 s20, s2, 4
    s_add_u32 s3, s3, s20
    s_mul_i32 s43, s3, 57
    s_lshr_b32 s43, s43, 9
    s_mul_i32 s43, s43, 9
    s_sub_u32 s43, s3, s43
    s_mul_i32 s40, s43, 18432
    s_add_u32 s40, s40, 175104
    s_mov_b32 s16, 0
    s_mov_b32 s18, 7
    v_add_u32 v3, 4096, v2
    v_add_u32 v4, 8192, v2
    s_lshl_b32 s20, s19, 2
    s_add_u32 s20, s20, s6
    s_mul_i32 s20, s20, 340992
    s_add_u32 s20, s20, 12320768
    s_mul_i32 s21, s3, 73728
    s_lshl_b32 s22, s6, 10
    s_add_u32 s21, s21, s22
    s_add_u32 s21, s21, 7602176
    s_mov_b32 m0, s22
    s_waitcnt lgkmcnt(0)
    s_add_u32 s12, s4, 0
    s_addc_u32 s13, s5, 0
    s_mov_b32 s14, 268435456
    s_mov_b32 s15, 0x20000
    s_add_u32 s8, s4, s20
    s_addc_u32 s9, s5, 0
    s_mov_b32 s10, 340992
    s_mov_b32 s11, 0x20000
    buffer_load_dwordx4 v2, s[12:15], s21 offen lds
    s_add_u32 m0, m0, 4096
    s_add_u32 s21, s21, 4096
    buffer_load_dwordx4 v2, s[12:15], s21 offen lds
    s_add_u32 m0, m0, 4096
    s_add_u32 s21, s21, 4096
    buffer_load_dwordx4 v2, s[12:15], s21 offen lds
    s_add_u32 m0, m0, 4096
    s_add_u32 s21, s21, 4096
    buffer_load_dwordx4 v2, s[12:15], s21 offen lds
    s_add_u32 m0, m0, 4096
    s_add_u32 s21, s21, 4096
    buffer_load_dwordx4 a[0:3], v2, s[8:11], s16 offen offset:0
    buffer_load_dwordx4 a[4:7], v2, s[8:11], s16 offen offset:1024
    buffer_load_dwordx4 a[8:11], v2, s[8:11], s16 offen offset:2048
    buffer_load_dwordx4 a[12:15], v2, s[8:11], s16 offen offset:3072
    buffer_load_dwordx4 a[16:19], v3, s[8:11], s16 offen offset:0
    s_load_dword s7, s[4:5], 0
    v_lshrrev_b32 v10, 4, v0
    v_bfe_u32 v11, v0, 2, 2
    v_and_b32 v12, 3, v0
    v_lshl_add_u32 v13, v10, 3, v11
    v_lshlrev_b32 v13, 7, v13
    v_lshl_add_u32 v13, v12, 3, v13
    v_lshrrev_b32 v14, 1, v11
    v_and_b32 v15, 1, v10
    v_lshl_or_b32 v14, v15, 1, v14
    s_add_u32 s32, s6, 0
    s_and_b32 s32, s32, 3
    v_xor_b32 v15, s32, v14
    v_lshl_add_u32 v16, v15, 5, v13
    s_add_u32 s33, s6, 1
    s_and_b32 s33, s33, 3
    buffer_load_dwordx4 a[20:23], v3, s[8:11], s16 offen offset:1024
    v_xor_b32 v15, s33, v14
    v_lshl_add_u32 v17, v15, 5, v13
    s_add_u32 s34, s6, 2
    s_and_b32 s34, s34, 3
    v_xor_b32 v15, s34, v14
    v_lshl_add_u32 v18, v15, 5, v13
    s_add_u32 s35, s6, 3
    s_and_b32 s35, s35, 3
    v_xor_b32 v15, s35, v14
    v_lshl_add_u32 v19, v15, 5, v13
    v_mov_b32 v24, 0
    v_mov_b32 v25, 0
    v_mov_b32 v26, 0
    v_mov_b32 v27, 0
    v_mov_b32 v28, 0
    v_mov_b32 v29, 0
    buffer_load_dwordx4 v2, s[12:15], s21 offen lds
    s_add_u32 m0, m0, 4096
    s_add_u32 s21, s21, 4096
    v_mov_b32 v30, 0
    v_mov_b32 v31, 0
    v_mov_b32 v32, 0
    v_mov_b32 v33, 0
    v_mov_b32 v34, 0
    v_mov_b32 v35, 0
    v_mov_b32 v36, 0
    v_mov_b32 v37, 0
    v_mov_b32 v38, 0
    v_mov_b32 v39, 0
    v_mov_b32 v40, 0
    v_mov_b32 v41, 0
    v_mov_b32 v42, 0
    v_mov_b32 v43, 0
    v_mov_b32 v44, 0
    v_mov_b32 v45, 0
    buffer_load_dwordx4 a[24:27], v3, s[8:11], s16 offen offset:2048
    v_mov_b32 v46, 0
    v_mov_b32 v47, 0
    v_mov_b32 v48, 0
    v_mov_b32 v49, 0
    v_mov_b32 v50, 0
    v_mov_b32 v51, 0
    v_mov_b32 v52, 0
    v_mov_b32 v53, 0
    v_mov_b32 v54, 0
    v_mov_b32 v55, 0
    v_mov_b32 v56, 0
    v_mov_b32 v57, 0
    v_mov_b32 v58, 0
    v_mov_b32 v59, 0
    v_mov_b32 v60, 0
    v_mov_b32 v61, 0
    buffer_load_dwordx4 a[28:31], v3, s[8:11], s16 offen offset:3072
    v_mov_b32 v62, 0
    v_mov_b32 v63, 0
    v_mov_b32 v64, 0
    v_mov_b32 v65, 0
    v_mov_b32 v66, 0
    v_mov_b32 v67, 0
    v_mov_b32 v68, 0
    v_mov_b32 v69, 0
    v_mov_b32 v70, 0
    v_mov_b32 v71, 0
    v_mov_b32 v72, 0
    v_mov_b32 v73, 0
    v_mov_b32 v74, 0
    v_mov_b32 v75, 0
    v_mov_b32 v76, 0
    v_mov_b32 v77, 0
    buffer_load_dwordx4 a[32:35], v4, s[8:11], s16 offen offset:0
    s_add_u32 s16, s16, 9216
    v_mov_b32 v78, 0
    v_mov_b32 v79, 0
    v_mov_b32 v80, 0
    v_mov_b32 v81, 0
    v_mov_b32 v82, 0
    v_mov_b32 v83, 0
    v_mov_b32 v84, 0
    v_mov_b32 v85, 0
    v_mov_b32 v86, 0
    v_mov_b32 v87, 0
    v_mov_b32 v88, 0
    v_mov_b32 v89, 0
    v_mov_b32 v90, 0
    v_mov_b32 v91, 0
    v_mov_b32 v92, 0
    v_mov_b32 v93, 0
    buffer_load_dwordx4 a[36:39], v2, s[8:11], s16 offen offset:0
    v_mov_b32 v94, 0
    v_mov_b32 v95, 0
    v_mov_b32 v96, 0
    v_mov_b32 v97, 0
    v_mov_b32 v98, 0
    v_mov_b32 v99, 0
    v_mov_b32 v100, 0
    v_mov_b32 v101, 0
    v_mov_b32 v102, 0
    v_mov_b32 v103, 0
    v_mov_b32 v104, 0
    v_mov_b32 v105, 0
    v_mov_b32 v106, 0
    v_mov_b32 v107, 0
    v_mov_b32 v108, 0
    v_mov_b32 v109, 0
    buffer_load_dwordx4 a[40:43], v2, s[8:11], s16 offen offset:1024
    v_mov_b32 v110, 0
    v_mov_b32 v111, 0
    v_mov_b32 v112, 0
    v_mov_b32 v113, 0
    v_mov_b32 v114, 0
    v_mov_b32 v115, 0
    v_mov_b32 v116, 0
    v_mov_b32 v117, 0
    v_mov_b32 v118, 0
    v_mov_b32 v119, 0
    v_mov_b32 v120, 0
    v_mov_b32 v121, 0
    v_mov_b32 v122, 0
    v_mov_b32 v123, 0
    v_mov_b32 v124, 0
    v_mov_b32 v125, 0
    buffer_load_dwordx4 a[44:47], v2, s[8:11], s16 offen offset:2048
    v_mov_b32 v126, 0
    v_mov_b32 v127, 0
    v_mov_b32 v128, 0
    v_mov_b32 v129, 0
    v_mov_b32 v130, 0
    v_mov_b32 v131, 0
    v_mov_b32 v132, 0
    v_mov_b32 v133, 0
    v_mov_b32 v134, 0
    v_mov_b32 v135, 0
    v_mov_b32 v136, 0
    v_mov_b32 v137, 0
    v_mov_b32 v138, 0
    v_mov_b32 v139, 0
    v_mov_b32 v140, 0
    v_mov_b32 v141, 0
    buffer_load_dwordx4 v2, s[12:15], s21 offen lds
    s_add_u32 m0, m0, 4096
    s_add_u32 s21, s21, 4096
    v_mov_b32 v142, 0
    v_mov_b32 v143, 0
    v_mov_b32 v144, 0
    v_mov_b32 v145, 0
    v_mov_b32 v146, 0
    v_mov_b32 v147, 0
    v_mov_b32 v148, 0
    v_mov_b32 v149, 0
    v_mov_b32 v150, 0
    v_mov_b32 v151, 0
    v_mov_b32 v152, 0
    v_mov_b32 v153, 0
    v_mov_b32 v154, 0
    v_mov_b32 v155, 0
    v_mov_b32 v156, 0
    v_mov_b32 v157, 0
    buffer_load_dwordx4 a[48:51], v2, s[8:11], s16 offen offset:3072
    v_mov_b32 v158, 0
    v_mov_b32 v159, 0
    v_mov_b32 v160, 0
    v_mov_b32 v161, 0
    v_mov_b32 v162, 0
    v_mov_b32 v163, 0
    v_mov_b32 v164, 0
    v_mov_b32 v165, 0
    v_mov_b32 v166, 0
    v_mov_b32 v167, 0
    v_mov_b32 v168, 0
    v_mov_b32 v169, 0
    v_mov_b32 v170, 0
    v_mov_b32 v171, 0
    v_mov_b32 v172, 0
    v_mov_b32 v173, 0
    buffer_load_dwordx4 a[52:55], v3, s[8:11], s16 offen offset:0
    v_mov_b32 v174, 0
    v_mov_b32 v175, 0
    v_mov_b32 v15, 0x3f803f80
    v_accvgpr_write_b32 a156, v15
    v_accvgpr_write_b32 a157, v15
    v_accvgpr_write_b32 a158, v15
    v_accvgpr_write_b32 a159, v15
    s_mul_i32 s24, s6, 9
    s_add_u32 s25, s24, 0
    s_lshr_b32 s26, s25, 1
    s_lshl_b32 s26, s26, 12
    s_and_b32 s25, s25, 1
    s_lshl_b32 s25, s25, 3
    s_add_u32 s25, s25, s26
    s_add_u32 s25, s25, 73728
    s_lshl_b32 s26, s32, 10
    buffer_load_dwordx4 a[56:59], v3, s[8:11], s16 offen offset:1024
    s_add_u32 s26, s26, s25
    v_add_u32 v248, s26, v2
    s_lshl_b32 s26, s33, 10
    s_add_u32 s26, s26, s25
    v_add_u32 v249, s26, v2
    s_lshl_b32 s26, s34, 10
    s_add_u32 s26, s26, s25
    v_add_u32 v250, s26, v2
    s_lshl_b32 s26, s35, 10
    s_add_u32 s26, s26, s25
    v_add_u32 v251, s26, v2
    s_add_u32 s25, s24, 1
    s_lshr_b32 s26, s25, 1
    s_lshl_b32 s26, s26, 12
    s_and_b32 s25, s25, 1
    s_lshl_b32 s25, s25, 3
    buffer_load_dwordx4 a[60:63], v3, s[8:11], s16 offen offset:2048
    s_add_u32 s25, s25, s26
    s_add_u32 s25, s25, 73728
    s_lshl_b32 s26, s32, 10
    s_add_u32 s26, s26, s25
    v_add_u32 v252, s26, v2
    s_lshl_b32 s26, s33, 10
    s_add_u32 s26, s26, s25
    v_add_u32 v253, s26, v2
    s_lshl_b32 s26, s34, 10
    s_add_u32 s26, s26, s25
    v_add_u32 v254, s26, v2
    s_lshl_b32 s26, s35, 10
    s_add_u32 s26, s26, s25
    v_add_u32 v255, s26, v2
    v_add_u32 v21, 110592, v2
    v_add_u32 v22, 73728, v2
    buffer_load_dwordx4 a[64:67], v3, s[8:11], s16 offen offset:3072
    v_and_b32 v8, 15, v0
    v_lshlrev_b32 v8, 4, v8
    v_add_u32 v8, 147456, v8
    s_lshl_b32 s25, s6, 8
    v_add_u32 v9, s25, v8
    v_add_u32 v15, 148480, v2
    v_cmp_eq_u32 s[36:37], v10, v11
    v_cmp_eq_u32 s[38:39], 1, v12
    v_cmp_eq_u32 s[26:27], 2, v12
    v_cmp_eq_u32 s[28:29], 3, v12
    s_mov_b32 s30, 0x3ae38e39
    v_cndmask_b32 v9, v15, v9, s[36:37]
    s_lshl_b32 s25, s32, 8
    v_add_u32 v244, s25, v8
    s_lshl_b32 s25, s33, 8
    v_add_u32 v245, s25, v8
    buffer_load_dwordx4 v2, s[12:15], s21 offen lds
    s_add_u32 m0, m0, 4096
    s_add_u32 s21, s21, 4096
    s_lshl_b32 s25, s34, 8
    v_add_u32 v246, s25, v8
    s_lshl_b32 s25, s35, 8
    v_add_u32 v247, s25, v8
    v_lshlrev_b32 v20, 8, v11
    v_lshl_add_u32 v20, v10, 6, v20
    v_lshl_add_u32 v20, v12, 4, v20
    s_lshl_b32 s31, s19, 5
    s_add_u32 s31, s31, s3
    s_mul_i32 s31, s31, 73728
    s_add_u32 s31, s31, 23330816
    s_lshl_b32 s25, s6, 11
    s_add_u32 s41, s31, s25
    s_add_u32 s42, s41, 73728
    s_lshl_b32 s25, s43, 13
    s_add_u32 s31, s41, s25
    s_waitcnt vmcnt(20)
    s_barrier
    ds_read_b64_tr_b16 a[108:109], v16 offset:0
    ds_read_b64_tr_b16 a[110:111], v16 offset:512
    ds_read_b64_tr_b16 a[112:113], v17 offset:0
    ds_read_b64_tr_b16 a[114:115], v17 offset:512
    ds_read_b64_tr_b16 a[116:117], v18 offset:0
    ds_read_b64_tr_b16 a[118:119], v18 offset:512
    ds_read_b64_tr_b16 a[120:121], v19 offset:0
    ds_read_b64_tr_b16 a[122:123], v19 offset:512
    s_mov_b32 s17, 0
    s_waitcnt lgkmcnt(0)
    .p2align 3
KB_g1:
    v_mfma_f32_16x16x32_bf16 v[24:27], a[156:159], a[108:111], v[24:27]
    v_mfma_f32_16x16x32_bf16 v[28:31], a[108:111], a[108:111], v[28:31]
    s_waitcnt vmcnt(16)
    v_mfma_f32_16x16x32_bf16 v[32:35], a[0:3], a[108:111], v[32:35]
    buffer_load_dwordx4 a[68:71], v4, s[8:11], s16 offen offset:0
    s_add_u32 s16, s16, 9216
    v_mfma_f32_16x16x32_bf16 v[36:39], a[0:3], a[112:115], v[36:39]
    ds_read_b64_tr_b16 a[124:125], v16 offset:4096
    v_mfma_f32_16x16x32_bf16 v[40:43], a[0:3], a[116:119], v[40:43]
    ds_read_b64_tr_b16 a[126:127], v16 offset:4608
    v_mfma_f32_16x16x32_bf16 v[44:47], a[0:3], a[120:123], v[44:47]
    ds_read_b64_tr_b16 a[128:129], v17 offset:4096
    s_cmp_lt_u32 s18, 18
    s_cbranch_scc0 KB_nx1
    buffer_load_dwordx4 v2, s[12:15], s21 offen lds
    s_add_u32 m0, m0, 4096
    s_add_u32 s21, s21, 4096
    s_add_u32 s18, s18, 1
KB_nx1:
    s_waitcnt vmcnt(16)
    v_mfma_f32_16x16x32_bf16 v[48:51], a[4:7], a[108:111], v[48:51]
    buffer_load_dwordx4 a[72:75], v2, s[8:11], s16 offen offset:0
    v_mfma_f32_16x16x32_bf16 v[52:55], a[4:7], a[112:115], v[52:55]
    ds_read_b64_tr_b16 a[130:131], v17 offset:4608
    v_mfma_f32_16x16x32_bf16 v[56:59], a[4:7], a[116:119], v[56:59]
    ds_read_b64_tr_b16 a[132:133], v18 offset:4096
    v_mfma_f32_16x16x32_bf16 v[60:63], a[4:7], a[120:123], v[60:63]
    ds_read_b64_tr_b16 a[134:135], v18 offset:4608
    s_waitcnt vmcnt(16)
    v_mfma_f32_16x16x32_bf16 v[64:67], a[8:11], a[108:111], v[64:67]
    buffer_load_dwordx4 a[76:79], v2, s[8:11], s16 offen offset:1024
    v_mfma_f32_16x16x32_bf16 v[68:71], a[8:11], a[112:115], v[68:71]
    ds_read_b64_tr_b16 a[136:137], v19 offset:4096
    v_mfma_f32_16x16x32_bf16 v[72:75], a[8:11], a[116:119], v[72:75]
    ds_read_b64_tr_b16 a[138:139], v19 offset:4608
    v_mfma_f32_16x16x32_bf16 v[76:79], a[8:11], a[120:123], v[76:79]
    s_waitcnt vmcnt(16)
    v_mfma_f32_16x16x32_bf16 v[80:83], a[12:15], a[108:111], v[80:83]
    buffer_load_dwordx4 a[80:83], v2, s[8:11], s16 offen offset:2048
    v_mfma_f32_16x16x32_bf16 v[84:87], a[12:15], a[112:115], v[84:87]
    v_mfma_f32_16x16x32_bf16 v[88:91], a[12:15], a[116:119], v[88:91]
    v_mfma_f32_16x16x32_bf16 v[92:95], a[12:15], a[120:123], v[92:95]
    s_waitcnt vmcnt(16)
    v_mfma_f32_16x16x32_bf16 v[96:99], a[16:19], a[108:111], v[96:99]
    buffer_load_dwordx4 a[84:87], v2, s[8:11], s16 offen offset:3072
    v_mfma_f32_16x16x32_bf16 v[100:103], a[16:19], a[112:115], v[100:103]
    v_mfma_f32_16x16x32_bf16 v[104:107], a[16:19], a[116:119], v[104:107]
    v_mfma_f32_16x16x32_bf16 v[108:111], a[16:19], a[120:123], v[108:111]
    s_waitcnt vmcnt(16)
    v_mfma_f32_16x16x32_bf16 v[112:115], a[20:23], a[108:111], v[112:115]
    buffer_load_dwordx4 a[88:91], v3, s[8:11], s16 offen offset:0
    v_mfma_f32_16x16x32_bf16 v[116:119], a[20:23], a[112:115], v[116:119]
    v_mfma_f32_16x16x32_bf16 v[120:123], a[20:23], a[116:119], v[120:123]
    v_mfma_f32_16x16x32_bf16 v[124:127], a[20:23], a[120:123], v[124:127]
    s_waitcnt vmcnt(16)
    v_mfma_f32_16x16x32_bf16 v[128:131], a[24:27], a[108:111], v[128:131]
    buffer_load_dwordx4 a[92:95], v3, s[8:11], s16 offen offset:1024
    v_mfma_f32_16x16x32_bf16 v[132:135], a[24:27], a[112:115], v[132:135]
    v_mfma_f32_16x16x32_bf16 v[136:139], a[24:27], a[116:119], v[136:139]
    v_mfma_f32_16x16x32_bf16 v[140:143], a[24:27], a[120:123], v[140:143]
    s_waitcnt vmcnt(16)
    v_mfma_f32_16x16x32_bf16 v[144:147], a[28:31], a[108:111], v[144:147]
    buffer_load_dwordx4 a[96:99], v3, s[8:11], s16 offen offset:2048
    v_mfma_f32_16x16x32_bf16 v[148:151], a[28:31], a[112:115], v[148:151]
    v_mfma_f32_16x16x32_bf16 v[152:155], a[28:31], a[116:119], v[152:155]
    v_mfma_f32_16x16x32_bf16 v[156:159], a[28:31], a[120:123], v[156:159]
    s_waitcnt vmcnt(16)
    v_mfma_f32_16x16x32_bf16 v[160:163], a[32:35], a[108:111], v[160:163]
    buffer_load_dwordx4 a[100:103], v3, s[8:11], s16 offen offset:3072
    v_mfma_f32_16x16x32_bf16 v[164:167], a[32:35], a[112:115], v[164:167]
    v_mfma_f32_16x16x32_bf16 v[168:171], a[32:35], a[116:119], v[168:171]
    v_mfma_f32_16x16x32_bf16 v[172:175], a[32:35], a[120:123], v[172:175]
    s_waitcnt lgkmcnt(0)
    v_mfma_f32_16x16x32_bf16 v[24:27], a[156:159], a[124:127], v[24:27]
    v_mfma_f32_16x16x32_bf16 v[28:31], a[124:127], a[124:127], v[28:31]
    s_waitcnt vmcnt(16)
    v_mfma_f32_16x16x32_bf16 v[32:35], a[36:39], a[124:127], v[32:35]
    buffer_load_dwordx4 a[104:107], v4, s[8:11], s16 offen offset:0
    s_add_u32 s16, s16, 9216
    v_mfma_f32_16x16x32_bf16 v[36:39], a[36:39], a[128:131], v[36:39]
    ds_read_b64_tr_b16 a[140:141], v16 offset:8192
    v_mfma_f32_16x16x32_bf16 v[40:43], a[36:39], a[132:135], v[40:43]
    ds_read_b64_tr_b16 a[142:143], v16 offset:8704
    v_mfma_f32_16x16x32_bf16 v[44:47], a[36:39], a[136:139], v[44:47]
    ds_read_b64_tr_b16 a[144:145], v17 offset:8192
    s_cmp_lt_u32 s18, 18
    s_cbranch_scc0 KB_nx2
    buffer_load_dwordx4 v2, s[12:15], s21 offen lds
    s_add_u32 m0, m0, 4096
    s_add_u32 s21, s21, 4096
    s_add_u32 s18, s18, 1
KB_nx2:
    s_waitcnt vmcnt(16)
    v_mfma_f32_16x16x32_bf16 v[48:51], a[40:43], a[124:127], v[48:51]
    buffer_load_dwordx4 a[0:3], v2, s[8:11], s16 offen offset:0
    v_mfma_f32_16x16x32_bf16 v[52:55], a[40:43], a[128:131], v[52:55]
    ds_read_b64_tr_b16 a[146:147], v17 offset:8704
    v_mfma_f32_16x16x32_bf16 v[56:59], a[40:43], a[132:135], v[56:59]
    ds_read_b64_tr_b16 a[148:149], v18 offset:8192
    v_mfma_f32_16x16x32_bf16 v[60:63], a[40:43], a[136:139], v[60:63]
    ds_read_b64_tr_b16 a[150:151], v18 offset:8704
    s_waitcnt vmcnt(16)
    v_mfma_f32_16x16x32_bf16 v[64:67], a[44:47], a[124:127], v[64:67]
    buffer_load_dwordx4 a[4:7], v2, s[8:11], s16 offen offset:1024
    v_mfma_f32_16x16x32_bf16 v[68:71], a[44:47], a[128:131], v[68:71]
    ds_read_b64_tr_b16 a[152:153], v19 offset:8192
    v_mfma_f32_16x16x32_bf16 v[72:75], a[44:47], a[132:135], v[72:75]
    ds_read_b64_tr_b16 a[154:155], v19 offset:8704
    v_mfma_f32_16x16x32_bf16 v[76:79], a[44:47], a[136:139], v[76:79]
    s_waitcnt vmcnt(16)
    v_mfma_f32_16x16x32_bf16 v[80:83], a[48:51], a[124:127], v[80:83]
    buffer_load_dwordx4 a[8:11], v2, s[8:11], s16 offen offset:2048
    v_mfma_f32_16x16x32_bf16 v[84:87], a[48:51], a[128:131], v[84:87]
    v_mfma_f32_16x16x32_bf16 v[88:91], a[48:51], a[132:135], v[88:91]
    v_mfma_f32_16x16x32_bf16 v[92:95], a[48:51], a[136:139], v[92:95]
    s_waitcnt vmcnt(16)
    v_mfma_f32_16x16x32_bf16 v[96:99], a[52:55], a[124:127], v[96:99]
    buffer_load_dwordx4 a[12:15], v2, s[8:11], s16 offen offset:3072
    v_mfma_f32_16x16x32_bf16 v[100:103], a[52:55], a[128:131], v[100:103]
    v_mfma_f32_16x16x32_bf16 v[104:107], a[52:55], a[132:135], v[104:107]
    v_mfma_f32_16x16x32_bf16 v[108:111], a[52:55], a[136:139], v[108:111]
    s_waitcnt vmcnt(16)
    v_mfma_f32_16x16x32_bf16 v[112:115], a[56:59], a[124:127], v[112:115]
    buffer_load_dwordx4 a[16:19], v3, s[8:11], s16 offen offset:0
    v_mfma_f32_16x16x32_bf16 v[116:119], a[56:59], a[128:131], v[116:119]
    v_mfma_f32_16x16x32_bf16 v[120:123], a[56:59], a[132:135], v[120:123]
    v_mfma_f32_16x16x32_bf16 v[124:127], a[56:59], a[136:139], v[124:127]
    s_cmp_lt_u32 s18, 18
    s_cbranch_scc0 KB_nx3
    buffer_load_dwordx4 v2, s[12:15], s21 offen lds
    s_add_u32 m0, m0, 4096
    s_add_u32 s21, s21, 4096
    s_add_u32 s18, s18, 1
KB_nx3:
    s_waitcnt vmcnt(16)
    v_mfma_f32_16x16x32_bf16 v[128:131], a[60:63], a[124:127], v[128:131]
    buffer_load_dwordx4 a[20:23], v3, s[8:11], s16 offen offset:1024
    v_mfma_f32_16x16x32_bf16 v[132:135], a[60:63], a[128:131], v[132:135]
    v_mfma_f32_16x16x32_bf16 v[136:139], a[60:63], a[132:135], v[136:139]
    v_mfma_f32_16x16x32_bf16 v[140:143], a[60:63], a[136:139], v[140:143]
    s_waitcnt vmcnt(16)
    v_mfma_f32_16x16x32_bf16 v[144:147], a[64:67], a[124:127], v[144:147]
    buffer_load_dwordx4 a[24:27], v3, s[8:11], s16 offen offset:2048
    v_mfma_f32_16x16x32_bf16 v[148:151], a[64:67], a[128:131], v[148:151]
    v_mfma_f32_16x16x32_bf16 v[152:155], a[64:67], a[132:135], v[152:155]
    v_mfma_f32_16x16x32_bf16 v[156:159], a[64:67], a[136:139], v[156:159]
    s_waitcnt vmcnt(16)
    v_mfma_f32_16x16x32_bf16 v[160:163], a[68:71], a[124:127], v[160:163]
    buffer_load_dwordx4 a[28:31], v3, s[8:11], s16 offen offset:3072
    v_mfma_f32_16x16x32_bf16 v[164:167], a[68:71], a[128:131], v[164:167]
    v_mfma_f32_16x16x32_bf16 v[168:171], a[68:71], a[132:135], v[168:171]
    v_mfma_f32_16x16x32_bf16 v[172:175], a[68:71], a[136:139], v[172:175]
    s_waitcnt lgkmcnt(0)
    v_mfma_f32_16x16x32_bf16 v[24:27], a[156:159], a[140:143], v[24:27]
    v_mfma_f32_16x16x32_bf16 v[28:31], a[140:143], a[140:143], v[28:31]
    s_waitcnt vmcnt(16)
    v_mfma_f32_16x16x32_bf16 v[32:35], a[72:75], a[140:143], v[32:35]
    buffer_load_dwordx4 a[32:35], v4, s[8:11], s16 offen offset:0
    s_add_u32 s16, s16, 9216
    v_mfma_f32_16x16x32_bf16 v[36:39], a[72:75], a[144:147], v[36:39]
    ds_read_b64_tr_b16 a[108:109], v16 offset:12288
    v_mfma_f32_16x16x32_bf16 v[40:43], a[72:75], a[148:151], v[40:43]
    ds_read_b64_tr_b16 a[110:111], v16 offset:12800
    v_mfma_f32_16x16x32_bf16 v[44:47], a[72:75], a[152:155], v[44:47]
    ds_read_b64_tr_b16 a[112:113], v17 offset:12288
    s_cmp_lt_u32 s18, 18
    s_cbranch_scc0 KB_nx4
    buffer_load_dwordx4 v2, s[12:15], s21 offen lds
    s_add_u32 m0, m0, 4096
    s_add_u32 s21, s21, 4096
    s_add_u32 s18, s18, 1
KB_nx4:
    s_waitcnt vmcnt(16)
    v_mfma_f32_16x16x32_bf16 v[48:51], a[76:79], a[140:143], v[48:51]
    buffer_load_dwordx4 a[36:39], v2, s[8:11], s16 offen offset:0
    v_mfma_f32_16x16x32_bf16 v[52:55], a[76:79], a[144:147], v[52:55]
    ds_read_b64_tr_b16 a[114:115], v17 offset:12800
    v_mfma_f32_16x16x32_bf16 v[56:59], a[76:79], a[148:151], v[56:59]
    ds_read_b64_tr_b16 a[116:117], v18 offset:12288
    v_mfma_f32_16x16x32_bf16 v[60:63], a[76:79], a[152:155], v[60:63]
    ds_read_b64_tr_b16 a[118:119], v18 offset:12800
    s_waitcnt vmcnt(16)
    v_mfma_f32_16x16x32_bf16 v[64:67], a[80:83], a[140:143], v[64:67]
    buffer_load_dwordx4 a[40:43], v2, s[8:11], s16 offen offset:1024
    v_mfma_f32_16x16x32_bf16 v[68:71], a[80:83], a[144:147], v[68:71]
    ds_read_b64_tr_b16 a[120:121], v19 offset:12288
    v_mfma_f32_16x16x32_bf16 v[72:75], a[80:83], a[148:151], v[72:75]
    ds_read_b64_tr_b16 a[122:123], v19 offset:12800
    v_mfma_f32_16x16x32_bf16 v[76:79], a[80:83], a[152:155], v[76:79]
    v_add_u32 v16, 12288, v16
    s_waitcnt vmcnt(16)
    v_mfma_f32_16x16x32_bf16 v[80:83], a[84:87], a[140:143], v[80:83]
    buffer_load_dwordx4 a[44:47], v2, s[8:11], s16 offen offset:2048
    v_mfma_f32_16x16x32_bf16 v[84:87], a[84:87], a[144:147], v[84:87]
    v_add_u32 v17, 12288, v17
    v_mfma_f32_16x16x32_bf16 v[88:91], a[84:87], a[148:151], v[88:91]
    v_add_u32 v18, 12288, v18
    v_mfma_f32_16x16x32_bf16 v[92:95], a[84:87], a[152:155], v[92:95]
    v_add_u32 v19, 12288, v19
    s_waitcnt vmcnt(16)
    v_mfma_f32_16x16x32_bf16 v[96:99], a[88:91], a[140:143], v[96:99]
    buffer_load_dwordx4 a[48:51], v2, s[8:11], s16 offen offset:3072
    v_mfma_f32_16x16x32_bf16 v[100:103], a[88:91], a[144:147], v[100:103]
    v_mfma_f32_16x16x32_bf16 v[104:107], a[88:91], a[148:151], v[104:107]
    v_mfma_f32_16x16x32_bf16 v[108:111], a[88:91], a[152:155], v[108:111]
    s_waitcnt vmcnt(16)
    v_mfma_f32_16x16x32_bf16 v[112:115], a[92:95], a[140:143], v[112:115]
    buffer_load_dwordx4 a[52:55], v3, s[8:11], s16 offen offset:0
    v_mfma_f32_16x16x32_bf16 v[116:119], a[92:95], a[144:147], v[116:119]
    v_mfma_f32_16x16x32_bf16 v[120:123], a[92:95], a[148:151], v[120:123]
    v_mfma_f32_16x16x32_bf16 v[124:127], a[92:95], a[152:155], v[124:127]
    s_waitcnt vmcnt(16)
    v_mfma_f32_16x16x32_bf16 v[128:131], a[96:99], a[140:143], v[128:131]
    buffer_load_dwordx4 a[56:59], v3, s[8:11], s16 offen offset:1024
    v_mfma_f32_16x16x32_bf16 v[132:135], a[96:99], a[144:147], v[132:135]
    v_mfma_f32_16x16x32_bf16 v[136:139], a[96:99], a[148:151], v[136:139]
    v_mfma_f32_16x16x32_bf16 v[140:143], a[96:99], a[152:155], v[140:143]
    s_waitcnt vmcnt(16)
    v_mfma_f32_16x16x32_bf16 v[144:147], a[100:103], a[140:143], v[144:147]
    buffer_load_dwordx4 a[60:63], v3, s[8:11], s16 offen offset:2048
    v_mfma_f32_16x16x32_bf16 v[148:151], a[100:103], a[144:147], v[148:151]
    v_mfma_f32_16x16x32_bf16 v[152:155], a[100:103], a[148:151], v[152:155]
    v_mfma_f32_16x16x32_bf16 v[156:159], a[100:103], a[152:155], v[156:159]
    s_waitcnt vmcnt(16)
    v_mfma_f32_16x16x32_bf16 v[160:163], a[104:107], a[140:143], v[160:163]
    buffer_load_dwordx4 a[64:67], v3, s[8:11], s16 offen offset:3072
    v_mfma_f32_16x16x32_bf16 v[164:167], a[104:107], a[144:147], v[164:167]
    v_mfma_f32_16x16x32_bf16 v[168:171], a[104:107], a[148:151], v[168:171]
    v_mfma_f32_16x16x32_bf16 v[172:175], a[104:107], a[152:155], v[172:175]
    s_add_u32 s17, s17, 1
    s_cmp_lt_u32 s17, 4
    s_waitcnt lgkmcnt(0)
    s_barrier
    s_cbranch_scc1 KB_g1
    v_mfma_f32_16x16x32_bf16 v[24:27], a[156:159], a[108:111], v[24:27]
    v_mfma_f32_16x16x32_bf16 v[28:31], a[108:111], a[108:111], v[28:31]
    s_waitcnt vmcnt(16)
    v_mfma_f32_16x16x32_bf16 v[32:35], a[0:3], a[108:111], v[32:35]
    buffer_load_dwordx4 a[68:71], v4, s[8:11], s16 offen offset:0
    s_add_u32 s16, s16, 9216
    v_mfma_f32_16x16x32_bf16 v[36:39], a[0:3], a[112:115], v[36:39]
    ds_read_b64_tr_b16 a[124:125], v16 offset:4096
    v_mfma_f32_16x16x32_bf16 v[40:43], a[0:3], a[116:119], v[40:43]
    ds_read_b64_tr_b16 a[126:127], v16 offset:4608
    ds_read_b64_tr_b16 a[128:129], v17 offset:4096
    v_mfma_f32_16x16x32_bf16 v[44:47], a[0:3], a[120:123], v[44:47]
    ds_read_b64_tr_b16 a[130:131], v17 offset:4608
    s_waitcnt vmcnt(16)
    v_mfma_f32_16x16x32_bf16 v[48:51], a[4:7], a[108:111], v[48:51]
    buffer_load_dwordx4 a[72:75], v2, s[8:11], s16 offen offset:0
    v_mfma_f32_16x16x32_bf16 v[52:55], a[4:7], a[112:115], v[52:55]
    ds_read_b64_tr_b16 a[132:133], v18 offset:4096
    v_mfma_f32_16x16x32_bf16 v[56:59], a[4:7], a[116:119], v[56:59]
    ds_read_b64_tr_b16 a[134:135], v18 offset:4608
    ds_read_b64_tr_b16 a[136:137], v19 offset:4096
    v_mfma_f32_16x16x32_bf16 v[60:63], a[4:7], a[120:123], v[60:63]
    ds_read_b64_tr_b16 a[138:139], v19 offset:4608
    s_waitcnt vmcnt(16)
    v_mfma_f32_16x16x32_bf16 v[64:67], a[8:11], a[108:111], v[64:67]
    buffer_load_dwordx4 a[76:79], v2, s[8:11], s16 offen offset:1024
    v_mfma_f32_16x16x32_bf16 v[68:71], a[8:11], a[112:115], v[68:71]
    ds_read_b64_tr_b16 v[176:177], v16 offset:12288
    v_mfma_f32_16x16x32_bf16 v[72:75], a[8:11], a[116:119], v[72:75]
    ds_read_b64_tr_b16 v[178:179], v16 offset:12800
    ds_read_b64_tr_b16 v[180:181], v17 offset:12288
    v_mfma_f32_16x16x32_bf16 v[76:79], a[8:11], a[120:123], v[76:79]
    ds_read_b64_tr_b16 v[182:183], v17 offset:12800
    s_waitcnt vmcnt(16)
    v_mfma_f32_16x16x32_bf16 v[80:83], a[12:15], a[108:111], v[80:83]
    buffer_load_dwordx4 a[80:83], v2, s[8:11], s16 offen offset:2048
    v_mfma_f32_16x16x32_bf16 v[84:87], a[12:15], a[112:115], v[84:87]
    ds_read_b64_tr_b16 v[184:185], v18 offset:12288
    v_mfma_f32_16x16x32_bf16 v[88:91], a[12:15], a[116:119], v[88:91]
    ds_read_b64_tr_b16 v[186:187], v18 offset:12800
    ds_read_b64_tr_b16 v[188:189], v19 offset:12288
    v_mfma_f32_16x16x32_bf16 v[92:95], a[12:15], a[120:123], v[92:95]
    ds_read_b64_tr_b16 v[190:191], v19 offset:12800
    s_waitcnt vmcnt(16)
    v_mfma_f32_16x16x32_bf16 v[96:99], a[16:19], a[108:111], v[96:99]
    buffer_load_dwordx4 a[84:87], v2, s[8:11], s16 offen offset:3072
    v_mfma_f32_16x16x32_bf16 v[100:103], a[16:19], a[112:115], v[100:103]
    ds_read_b64_tr_b16 v[192:193], v16 offset:16384
    v_mfma_f32_16x16x32_bf16 v[104:107], a[16:19], a[116:119], v[104:107]
    ds_read_b64_tr_b16 v[194:195], v16 offset:16896
    ds_read_b64_tr_b16 v[196:197], v17 offset:16384
    v_mfma_f32_16x16x32_bf16 v[108:111], a[16:19], a[120:123], v[108:111]
    ds_read_b64_tr_b16 v[198:199], v17 offset:16896
    s_waitcnt vmcnt(16)
    v_mfma_f32_16x16x32_bf16 v[112:115], a[20:23], a[108:111], v[112:115]
    buffer_load_dwordx4 a[88:91], v3, s[8:11], s16 offen offset:0
    v_mfma_f32_16x16x32_bf16 v[116:119], a[20:23], a[112:115], v[116:119]
    ds_read_b64_tr_b16 v[200:201], v18 offset:16384
    v_mfma_f32_16x16x32_bf16 v[120:123], a[20:23], a[116:119], v[120:123]
    ds_read_b64_tr_b16 v[202:203], v18 offset:16896
    ds_read_b64_tr_b16 v[204:205], v19 offset:16384
    v_mfma_f32_16x16x32_bf16 v[124:127], a[20:23], a[120:123], v[124:127]
    ds_read_b64_tr_b16 v[206:207], v19 offset:16896
    s_waitcnt vmcnt(16)
    v_mfma_f32_16x16x32_bf16 v[128:131], a[24:27], a[108:111], v[128:131]
    buffer_load_dwordx4 a[92:95], v3, s[8:11], s16 offen offset:1024
    v_mfma_f32_16x16x32_bf16 v[132:135], a[24:27], a[112:115], v[132:135]
    ds_read_b64_tr_b16 v[208:209], v16 offset:20480
    v_mfma_f32_16x16x32_bf16 v[136:139], a[24:27], a[116:119], v[136:139]
    ds_read_b64_tr_b16 v[210:211], v16 offset:20992
    ds_read_b64_tr_b16 v[212:213], v17 offset:20480
    v_mfma_f32_16x16x32_bf16 v[140:143], a[24:27], a[120:123], v[140:143]
    ds_read_b64_tr_b16 v[214:215], v17 offset:20992
    s_waitcnt vmcnt(16)
    v_mfma_f32_16x16x32_bf16 v[144:147], a[28:31], a[108:111], v[144:147]
    buffer_load_dwordx4 a[96:99], v3, s[8:11], s16 offen offset:2048
    v_mfma_f32_16x16x32_bf16 v[148:151], a[28:31], a[112:115], v[148:151]
    ds_read_b64_tr_b16 v[216:217], v18 offset:20480
    v_mfma_f32_16x16x32_bf16 v[152:155], a[28:31], a[116:119], v[152:155]
    ds_read_b64_tr_b16 v[218:219], v18 offset:20992
    ds_read_b64_tr_b16 v[220:221], v19 offset:20480
    v_mfma_f32_16x16x32_bf16 v[156:159], a[28:31], a[120:123], v[156:159]
    ds_read_b64_tr_b16 v[222:223], v19 offset:20992
    s_waitcnt vmcnt(16)
    v_mfma_f32_16x16x32_bf16 v[160:163], a[32:35], a[108:111], v[160:163]
    buffer_load_dwordx4 a[100:103], v3, s[8:11], s16 offen offset:3072
    v_mfma_f32_16x16x32_bf16 v[164:167], a[32:35], a[112:115], v[164:167]
    v_mfma_f32_16x16x32_bf16 v[168:171], a[32:35], a[116:119], v[168:171]
    v_mfma_f32_16x16x32_bf16 v[172:175], a[32:35], a[120:123], v[172:175]
    s_waitcnt lgkmcnt(0)
    v_mfma_f32_16x16x32_bf16 v[24:27], a[156:159], a[124:127], v[24:27]
    v_mfma_f32_16x16x32_bf16 v[28:31], a[124:127], a[124:127], v[28:31]
    v_mfma_f32_16x16x32_bf16 v[24:27], a[156:159], v[176:179], v[24:27]
    v_mfma_f32_16x16x32_bf16 v[28:31], v[176:179], v[176:179], v[28:31]
    v_mfma_f32_16x16x32_bf16 v[24:27], a[156:159], v[192:195], v[24:27]
    v_mfma_f32_16x16x32_bf16 v[28:31], v[192:195], v[192:195], v[28:31]
    v_mfma_f32_16x16x32_bf16 v[24:27], a[156:159], v[208:211], v[24:27]
    v_mfma_f32_16x16x32_bf16 v[28:31], v[208:211], v[208:211], v[28:31]
    s_waitcnt vmcnt(16)
    v_mfma_f32_16x16x32_bf16 v[32:35], a[36:39], a[124:127], v[32:35]
    buffer_load_dwordx4 a[104:107], v4, s[8:11], s16 offen offset:0
    s_add_u32 s16, s16, 9216
    v_mfma_f32_16x16x32_bf16 v[36:39], a[36:39], a[128:131], v[36:39]
    ds_read_b64_tr_b16 a[140:141], v16 offset:8192
    v_mfma_f32_16x16x32_bf16 v[40:43], a[36:39], a[132:135], v[40:43]
    ds_read_b64_tr_b16 a[142:143], v16 offset:8704
    v_mfma_f32_16x16x32_bf16 v[44:47], a[36:39], a[136:139], v[44:47]
    ds_read_b64_tr_b16 a[144:145], v17 offset:8192
    s_waitcnt vmcnt(16)
    v_mfma_f32_16x16x32_bf16 v[48:51], a[40:43], a[124:127], v[48:51]
    buffer_load_dwordx4 a[0:3], v2, s[8:11], s16 offen offset:0
    v_mfma_f32_16x16x32_bf16 v[52:55], a[40:43], a[128:131], v[52:55]
    ds_read_b64_tr_b16 a[146:147], v17 offset:8704
    v_mfma_f32_16x16x32_bf16 v[56:59], a[40:43], a[132:135], v[56:59]
    ds_read_b64_tr_b16 a[148:149], v18 offset:8192
    v_mfma_f32_16x16x32_bf16 v[60:63], a[40:43], a[136:139], v[60:63]
    ds_read_b64_tr_b16 a[150:151], v18 offset:8704
    s_waitcnt vmcnt(16)
    v_mfma_f32_16x16x32_bf16 v[64:67], a[44:47], a[124:127], v[64:67]
    buffer_load_dwordx4 a[4:7], v2, s[8:11], s16 offen offset:1024
    v_mfma_f32_16x16x32_bf16 v[68:71], a[44:47], a[128:131], v[68:71]
    ds_read_b64_tr_b16 a[152:153], v19 offset:8192
    v_mfma_f32_16x16x32_bf16 v[72:75], a[44:47], a[132:135], v[72:75]
    ds_read_b64_tr_b16 a[154:155], v19 offset:8704
    v_mfma_f32_16x16x32_bf16 v[76:79], a[44:47], a[136:139], v[76:79]
    s_waitcnt vmcnt(16)
    v_mfma_f32_16x16x32_bf16 v[80:83], a[48:51], a[124:127], v[80:83]
    buffer_load_dwordx4 a[8:11], v2, s[8:11], s16 offen offset:2048
    v_mfma_f32_16x16x32_bf16 v[84:87], a[48:51], a[128:131], v[84:87]
    v_mfma_f32_16x16x32_bf16 v[88:91], a[48:51], a[132:135], v[88:91]
    v_mfma_f32_16x16x32_bf16 v[92:95], a[48:51], a[136:139], v[92:95]
    s_waitcnt vmcnt(16)
    v_mfma_f32_16x16x32_bf16 v[96:99], a[52:55], a[124:127], v[96:99]
    buffer_load_dwordx4 a[12:15], v2, s[8:11], s16 offen offset:3072
    v_mfma_f32_16x16x32_bf16 v[100:103], a[52:55], a[128:131], v[100:103]
    v_mfma_f32_16x16x32_bf16 v[104:107], a[52:55], a[132:135], v[104:107]
    v_mfma_f32_16x16x32_bf16 v[108:111], a[52:55], a[136:139], v[108:111]
    s_waitcnt vmcnt(16)
    v_mfma_f32_16x16x32_bf16 v[112:115], a[56:59], a[124:127], v[112:115]
    buffer_load_dwordx4 a[16:19], v3, s[8:11], s16 offen offset:0
    v_mfma_f32_16x16x32_bf16 v[116:119], a[56:59], a[128:131], v[116:119]
    v_mfma_f32_16x16x32_bf16 v[120:123], a[56:59], a[132:135], v[120:123]
    v_mfma_f32_16x16x32_bf16 v[124:127], a[56:59], a[136:139], v[124:127]
    s_waitcnt vmcnt(16)
    v_mfma_f32_16x16x32_bf16 v[128:131], a[60:63], a[124:127], v[128:131]
    buffer_load_dwordx4 a[20:23], v3, s[8:11], s16 offen offset:1024
    v_mfma_f32_16x16x32_bf16 v[132:135], a[60:63], a[128:131], v[132:135]
    v_mfma_f32_16x16x32_bf16 v[136:139], a[60:63], a[132:135], v[136:139]
    v_mfma_f32_16x16x32_bf16 v[140:143], a[60:63], a[136:139], v[140:143]
    s_waitcnt vmcnt(16)
    v_mfma_f32_16x16x32_bf16 v[144:147], a[64:67], a[124:127], v[144:147]
    buffer_load_dwordx4 a[24:27], v3, s[8:11], s16 offen offset:2048
    v_mfma_f32_16x16x32_bf16 v[148:151], a[64:67], a[128:131], v[148:151]
    v_mfma_f32_16x16x32_bf16 v[152:155], a[64:67], a[132:135], v[152:155]
    v_mfma_f32_16x16x32_bf16 v[156:159], a[64:67], a[136:139], v[156:159]
    s_waitcnt vmcnt(16)
    v_mfma_f32_16x16x32_bf16 v[160:163], a[68:71], a[124:127], v[160:163]
    buffer_load_dwordx4 a[28:31], v3, s[8:11], s16 offen offset:3072
    v_mfma_f32_16x16x32_bf16 v[164:167], a[68:71], a[128:131], v[164:167]
    v_mfma_f32_16x16x32_bf16 v[168:171], a[68:71], a[132:135], v[168:171]
    v_mfma_f32_16x16x32_bf16 v[172:175], a[68:71], a[136:139], v[172:175]
    s_waitcnt lgkmcnt(0)
    v_mfma_f32_16x16x32_bf16 v[24:27], a[156:159], a[140:143], v[24:27]
    v_mfma_f32_16x16x32_bf16 v[28:31], a[140:143], a[140:143], v[28:31]
    s_waitcnt vmcnt(16)
    v_mfma_f32_16x16x32_bf16 v[32:35], a[72:75], a[140:143], v[32:35]
    buffer_load_dwordx4 a[32:35], v4, s[8:11], s16 offen offset:0
    s_add_u32 s16, s16, 9216
    v_mfma_f32_16x16x32_bf16 v[36:39], a[72:75], a[144:147], v[36:39]
    v_mfma_f32_16x16x32_bf16 v[40:43], a[72:75], a[148:151], v[40:43]
    v_mfma_f32_16x16x32_bf16 v[44:47], a[72:75], a[152:155], v[44:47]
    s_waitcnt vmcnt(16)
    v_mfma_f32_16x16x32_bf16 v[48:51], a[76:79], a[140:143], v[48:51]
    buffer_load_dwordx4 a[36:39], v2, s[8:11], s16 offen offset:0
    v_mfma_f32_16x16x32_bf16 v[52:55], a[76:79], a[144:147], v[52:55]
    v_cndmask_b32 v6, v28, v29, s[38:39]
    v_mfma_f32_16x16x32_bf16 v[56:59], a[76:79], a[148:151], v[56:59]
    v_mul_f32 v7, s30, v24
    v_mfma_f32_16x16x32_bf16 v[60:63], a[76:79], a[152:155], v[60:63]
    v_cndmask_b32 v6, v6, v30, s[26:27]
    s_waitcnt vmcnt(16)
    v_mfma_f32_16x16x32_bf16 v[64:67], a[80:83], a[140:143], v[64:67]
    buffer_load_dwordx4 a[40:43], v2, s[8:11], s16 offen offset:1024
    v_mfma_f32_16x16x32_bf16 v[68:71], a[80:83], a[144:147], v[68:71]
    v_cndmask_b32 v6, v6, v31, s[28:29]
    v_mfma_f32_16x16x32_bf16 v[72:75], a[80:83], a[148:151], v[72:75]
    v_mul_f32 v6, s30, v6
    v_mfma_f32_16x16x32_bf16 v[76:79], a[80:83], a[152:155], v[76:79]
    v_fma_f32 v6, -v7, v7, v6
    s_waitcnt vmcnt(16)
    v_mfma_f32_16x16x32_bf16 v[80:83], a[84:87], a[140:143], v[80:83]
    buffer_load_dwordx4 a[44:47], v2, s[8:11], s16 offen offset:2048
    v_mfma_f32_16x16x32_bf16 v[84:87], a[84:87], a[144:147], v[84:87]
    v_max_f32 v6, 0, v6
    v_mfma_f32_16x16x32_bf16 v[88:91], a[84:87], a[148:151], v[88:91]
    v_cvt_pk_bf16_f32 v6, v6, v6
    v_mfma_f32_16x16x32_bf16 v[92:95], a[84:87], a[152:155], v[92:95]
    v_lshlrev_b32 v6, 16, v6
    s_waitcnt vmcnt(16)
    v_mfma_f32_16x16x32_bf16 v[96:99], a[88:91], a[140:143], v[96:99]
    buffer_load_dwordx4 a[48:51], v2, s[8:11], s16 offen offset:3072
    v_mfma_f32_16x16x32_bf16 v[100:103], a[88:91], a[144:147], v[100:103]
    v_add_f32 v6, 0x3727c5ac, v6
    v_mfma_f32_16x16x32_bf16 v[104:107], a[88:91], a[148:151], v[104:107]
    v_cvt_pk_bf16_f32 v6, v6, v6
    v_mfma_f32_16x16x32_bf16 v[108:111], a[88:91], a[152:155], v[108:111]
    v_lshlrev_b32 v6, 16, v6
    s_waitcnt vmcnt(16)
    v_mfma_f32_16x16x32_bf16 v[112:115], a[92:95], a[140:143], v[112:115]
    buffer_load_dwordx4 a[52:55], v3, s[8:11], s16 offen offset:0
    v_mfma_f32_16x16x32_bf16 v[116:119], a[92:95], a[144:147], v[116:119]
    v_sqrt_f32 v6, v6
    v_mfma_f32_16x16x32_bf16 v[120:123], a[92:95], a[148:151], v[120:123]
    v_cvt_pk_bf16_f32 v13, -v7, -v7
    v_mfma_f32_16x16x32_bf16 v[124:127], a[92:95], a[152:155], v[124:127]
    v_cvt_pk_bf16_f32 v12, v6, v6
    s_waitcnt vmcnt(16)
    v_mfma_f32_16x16x32_bf16 v[128:131], a[96:99], a[140:143], v[128:131]
    buffer_load_dwordx4 a[56:59], v3, s[8:11], s16 offen offset:1024
    v_mfma_f32_16x16x32_bf16 v[132:135], a[96:99], a[144:147], v[132:135]
    v_mov_b32 v15, v13
    v_mfma_f32_16x16x32_bf16 v[136:139], a[96:99], a[148:151], v[136:139]
    v_mov_b32 v14, v12
    v_mfma_f32_16x16x32_bf16 v[140:143], a[96:99], a[152:155], v[140:143]
    ds_write_b128 v9, v[12:15]
    s_waitcnt vmcnt(16)
    v_mfma_f32_16x16x32_bf16 v[144:147], a[100:103], a[140:143], v[144:147]
    buffer_load_dwordx4 a[60:63], v3, s[8:11], s16 offen offset:2048
    v_mfma_f32_16x16x32_bf16 v[148:151], a[100:103], a[144:147], v[148:151]
    v_mfma_f32_16x16x32_bf16 v[152:155], a[100:103], a[148:151], v[152:155]
    v_mfma_f32_16x16x32_bf16 v[156:159], a[100:103], a[152:155], v[156:159]
    s_waitcnt vmcnt(16)
    v_mfma_f32_16x16x32_bf16 v[160:163], a[104:107], a[140:143], v[160:163]
    buffer_load_dwordx4 a[64:67], v3, s[8:11], s16 offen offset:3072
    v_mfma_f32_16x16x32_bf16 v[164:167], a[104:107], a[144:147], v[164:167]
    v_mfma_f32_16x16x32_bf16 v[168:171], a[104:107], a[148:151], v[168:171]
    v_mfma_f32_16x16x32_bf16 v[172:175], a[104:107], a[152:155], v[172:175]
    s_waitcnt lgkmcnt(0)
    s_barrier
    s_waitcnt vmcnt(16)
    v_mfma_f32_16x16x32_bf16 v[32:35], a[0:3], v[176:179], v[32:35]
    buffer_load_dwordx4 a[68:71], v4, s[8:11], s16 offen offset:0
    s_add_u32 s16, s16, 9216
    v_mfma_f32_16x16x32_bf16 v[36:39], a[0:3], v[180:183], v[36:39]
    ds_read_b128 v[224:227], v244
    v_mfma_f32_16x16x32_bf16 v[40:43], a[0:3], v[184:187], v[40:43]
    ds_read_b128 v[228:231], v245
    ds_read_b128 v[232:235], v246
    v_mfma_f32_16x16x32_bf16 v[44:47], a[0:3], v[188:191], v[44:47]
    ds_read_b128 v[236:239], v247
    s_waitcnt vmcnt(16)
    v_mfma_f32_16x16x32_bf16 v[32:35], a[4:7], v[192:195], v[32:35]
    buffer_load_dwordx4 a[72:75], v2, s[8:11], s16 offen offset:0
    v_mfma_f32_16x16x32_bf16 v[36:39], a[4:7], v[196:199], v[36:39]
    v_mfma_f32_16x16x32_bf16 v[40:43], a[4:7], v[200:203], v[40:43]
    v_mfma_f32_16x16x32_bf16 v[44:47], a[4:7], v[204:207], v[44:47]
    s_waitcnt vmcnt(16)
    v_mfma_f32_16x16x32_bf16 v[32:35], a[8:11], v[208:211], v[32:35]
    buffer_load_dwordx4 a[76:79], v2, s[8:11], s16 offen offset:1024
    v_mfma_f32_16x16x32_bf16 v[36:39], a[8:11], v[212:215], v[36:39]
    v_mfma_f32_16x16x32_bf16 v[40:43], a[8:11], v[216:219], v[40:43]
    v_mfma_f32_16x16x32_bf16 v[44:47], a[8:11], v[220:223], v[44:47]
    s_waitcnt lgkmcnt(0)
    s_waitcnt vmcnt(16)
    v_mfma_f32_16x16x32_bf16 v[32:35], a[12:15], v[224:227], v[32:35]
    buffer_load_dwordx4 a[80:83], v2, s[8:11], s16 offen offset:2048
    v_mfma_f32_16x16x32_bf16 v[36:39], a[12:15], v[228:231], v[36:39]
    v_mfma_f32_16x16x32_bf16 v[40:43], a[12:15], v[232:235], v[40:43]
    v_mfma_f32_16x16x32_bf16 v[44:47], a[12:15], v[236:239], v[44:47]
    s_waitcnt vmcnt(16)
    v_mfma_f32_16x16x32_bf16 v[48:51], a[16:19], v[176:179], v[48:51]
    buffer_load_dwordx4 a[84:87], v2, s[8:11], s16 offen offset:3072
    v_mfma_f32_16x16x32_bf16 v[52:55], a[16:19], v[180:183], v[52:55]
    v_cvt_pk_bf16_f32 v32, v32, v33
    v_mfma_f32_16x16x32_bf16 v[56:59], a[16:19], v[184:187], v[56:59]
    v_cvt_pk_bf16_f32 v33, v34, v35
    v_pk_max_i16 v32, v32, 0
    v_mfma_f32_16x16x32_bf16 v[60:63], a[16:19], v[188:191], v[60:63]
    v_pk_max_i16 v33, v33, 0
    ds_write_b64 v248, v[32:33] offset:0
    s_waitcnt vmcnt(16)
    v_mfma_f32_16x16x32_bf16 v[48:51], a[20:23], v[192:195], v[48:51]
    buffer_load_dwordx4 a[88:91], v3, s[8:11], s16 offen offset:0
    v_cvt_pk_bf16_f32 v36, v36, v37
    v_mfma_f32_16x16x32_bf16 v[52:55], a[20:23], v[196:199], v[52:55]
    v_cvt_pk_bf16_f32 v37, v38, v39
    v_mfma_f32_16x16x32_bf16 v[56:59], a[20:23], v[200:203], v[56:59]
    v_pk_max_i16 v36, v36, 0
    v_pk_max_i16 v37, v37, 0
    v_mfma_f32_16x16x32_bf16 v[60:63], a[20:23], v[204:207], v[60:63]
    ds_write_b64 v249, v[36:37] offset:0
    s_waitcnt vmcnt(16)
    v_mfma_f32_16x16x32_bf16 v[48:51], a[24:27], v[208:211], v[48:51]
    buffer_load_dwordx4 a[92:95], v3, s[8:11], s16 offen offset:1024
    v_cvt_pk_bf16_f32 v40, v40, v41
    v_mfma_f32_16x16x32_bf16 v[52:55], a[24:27], v[212:215], v[52:55]
    v_cvt_pk_bf16_f32 v41, v42, v43
    v_mfma_f32_16x16x32_bf16 v[56:59], a[24:27], v[216:219], v[56:59]
    v_pk_max_i16 v40, v40, 0
    v_pk_max_i16 v41, v41, 0
    v_mfma_f32_16x16x32_bf16 v[60:63], a[24:27], v[220:223], v[60:63]
    ds_write_b64 v250, v[40:41] offset:0
    s_waitcnt vmcnt(16)
    v_mfma_f32_16x16x32_bf16 v[48:51], a[28:31], v[224:227], v[48:51]
    buffer_load_dwordx4 a[96:99], v3, s[8:11], s16 offen offset:2048
    v_cvt_pk_bf16_f32 v44, v44, v45
    v_mfma_f32_16x16x32_bf16 v[52:55], a[28:31], v[228:231], v[52:55]
    v_cvt_pk_bf16_f32 v45, v46, v47
    v_mfma_f32_16x16x32_bf16 v[56:59], a[28:31], v[232:235], v[56:59]
    v_pk_max_i16 v44, v44, 0
    v_pk_max_i16 v45, v45, 0
    v_mfma_f32_16x16x32_bf16 v[60:63], a[28:31], v[236:239], v[60:63]
    ds_write_b64 v251, v[44:45] offset:0
    s_waitcnt vmcnt(16)
    v_mfma_f32_16x16x32_bf16 v[64:67], a[32:35], v[176:179], v[64:67]
    buffer_load_dwordx4 a[100:103], v3, s[8:11], s16 offen offset:3072
    v_mfma_f32_16x16x32_bf16 v[68:71], a[32:35], v[180:183], v[68:71]
    v_cvt_pk_bf16_f32 v48, v48, v49
    v_mfma_f32_16x16x32_bf16 v[72:75], a[32:35], v[184:187], v[72:75]
    v_cvt_pk_bf16_f32 v49, v50, v51
    v_pk_max_i16 v48, v48, 0
    v_mfma_f32_16x16x32_bf16 v[76:79], a[32:35], v[188:191], v[76:79]
    v_pk_max_i16 v49, v49, 0
    ds_write_b64 v252, v[48:49] offset:0
    s_waitcnt vmcnt(16)
    v_mfma_f32_16x16x32_bf16 v[64:67], a[36:39], v[192:195], v[64:67]
    buffer_load_dwordx4 a[104:107], v4, s[8:11], s16 offen offset:0
    s_add_u32 s16, s16, 9216
    v_cvt_pk_bf16_f32 v52, v52, v53
    v_mfma_f32_16x16x32_bf16 v[68:71], a[36:39], v[196:199], v[68:71]
    v_cvt_pk_bf16_f32 v53, v54, v55
    v_mfma_f32_16x16x32_bf16 v[72:75], a[36:39], v[200:203], v[72:75]
    v_pk_max_i16 v52, v52, 0
    v_pk_max_i16 v53, v53, 0
    v_mfma_f32_16x16x32_bf16 v[76:79], a[36:39], v[204:207], v[76:79]
    ds_write_b64 v253, v[52:53] offset:0
    s_waitcnt vmcnt(16)
    v_mfma_f32_16x16x32_bf16 v[64:67], a[40:43], v[208:211], v[64:67]
    buffer_load_dwordx4 a[0:3], v2, s[8:11], s16 offen offset:0
    v_cvt_pk_bf16_f32 v56, v56, v57
    v_mfma_f32_16x16x32_bf16 v[68:71], a[40:43], v[212:215], v[68:71]
    v_cvt_pk_bf16_f32 v57, v58, v59
    v_mfma_f32_16x16x32_bf16 v[72:75], a[40:43], v[216:219], v[72:75]
    v_pk_max_i16 v56, v56, 0
    v_pk_max_i16 v57, v57, 0
    v_mfma_f32_16x16x32_bf16 v[76:79], a[40:43], v[220:223], v[76:79]
    ds_write_b64 v254, v[56:57] offset:0
    s_waitcnt vmcnt(16)
    v_mfma_f32_16x16x32_bf16 v[64:67], a[44:47], v[224:227], v[64:67]
    buffer_load_dwordx4 a[4:7], v2, s[8:11], s16 offen offset:1024
    v_cvt_pk_bf16_f32 v60, v60, v61
    v_mfma_f32_16x16x32_bf16 v[68:71], a[44:47], v[228:231], v[68:71]
    v_cvt_pk_bf16_f32 v61, v62, v63
    v_mfma_f32_16x16x32_bf16 v[72:75], a[44:47], v[232:235], v[72:75]
    v_pk_max_i16 v60, v60, 0
    v_pk_max_i16 v61, v61, 0
    v_mfma_f32_16x16x32_bf16 v[76:79], a[44:47], v[236:239], v[76:79]
    ds_write_b64 v255, v[60:61] offset:0
    s_waitcnt vmcnt(16)
    v_mfma_f32_16x16x32_bf16 v[80:83], a[48:51], v[176:179], v[80:83]
    buffer_load_dwordx4 a[8:11], v2, s[8:11], s16 offen offset:2048
    v_mfma_f32_16x16x32_bf16 v[84:87], a[48:51], v[180:183], v[84:87]
    v_cvt_pk_bf16_f32 v64, v64, v65
    v_mfma_f32_16x16x32_bf16 v[88:91], a[48:51], v[184:187], v[88:91]
    v_cvt_pk_bf16_f32 v65, v66, v67
    v_pk_max_i16 v64, v64, 0
    v_mfma_f32_16x16x32_bf16 v[92:95], a[48:51], v[188:191], v[92:95]
    v_pk_max_i16 v65, v65, 0
    ds_write_b64 v248, v[64:65] offset:4096
    s_waitcnt vmcnt(16)
    v_mfma_f32_16x16x32_bf16 v[80:83], a[52:55], v[192:195], v[80:83]
    buffer_load_dwordx4 a[12:15], v2, s[8:11], s16 offen offset:3072
    v_cvt_pk_bf16_f32 v68, v68, v69
    v_mfma_f32_16x16x32_bf16 v[84:87], a[52:55], v[196:199], v[84:87]
    v_cvt_pk_bf16_f32 v69, v70, v71
    v_mfma_f32_16x16x32_bf16 v[88:91], a[52:55], v[200:203], v[88:91]
    v_pk_max_i16 v68, v68, 0
    v_pk_max_i16 v69, v69, 0
    v_mfma_f32_16x16x32_bf16 v[92:95], a[52:55], v[204:207], v[92:95]
    ds_write_b64 v249, v[68:69] offset:4096
    s_waitcnt vmcnt(16)
    v_mfma_f32_16x16x32_bf16 v[80:83], a[56:59], v[208:211], v[80:83]
    buffer_load_dwordx4 a[16:19], v3, s[8:11], s16 offen offset:0
    v_cvt_pk_bf16_f32 v72, v72, v73
    v_mfma_f32_16x16x32_bf16 v[84:87], a[56:59], v[212:215], v[84:87]
    v_cvt_pk_bf16_f32 v73, v74, v75
    v_mfma_f32_16x16x32_bf16 v[88:91], a[56:59], v[216:219], v[88:91]
    v_pk_max_i16 v72, v72, 0
    v_pk_max_i16 v73, v73, 0
    v_mfma_f32_16x16x32_bf16 v[92:95], a[56:59], v[220:223], v[92:95]
    ds_write_b64 v250, v[72:73] offset:4096
    s_waitcnt vmcnt(16)
    v_mfma_f32_16x16x32_bf16 v[80:83], a[60:63], v[224:227], v[80:83]
    buffer_load_dwordx4 a[20:23], v3, s[8:11], s16 offen offset:1024
    v_cvt_pk_bf16_f32 v76, v76, v77
    v_mfma_f32_16x16x32_bf16 v[84:87], a[60:63], v[228:231], v[84:87]
    v_cvt_pk_bf16_f32 v77, v78, v79
    v_mfma_f32_16x16x32_bf16 v[88:91], a[60:63], v[232:235], v[88:91]
    v_pk_max_i16 v76, v76, 0
    v_pk_max_i16 v77, v77, 0
    v_mfma_f32_16x16x32_bf16 v[92:95], a[60:63], v[236:239], v[92:95]
    ds_write_b64 v251, v[76:77] offset:4096
    s_waitcnt vmcnt(16)
    v_mfma_f32_16x16x32_bf16 v[96:99], a[64:67], v[176:179], v[96:99]
    buffer_load_dwordx4 a[24:27], v3, s[8:11], s16 offen offset:2048
    v_mfma_f32_16x16x32_bf16 v[100:103], a[64:67], v[180:183], v[100:103]
    v_cvt_pk_bf16_f32 v80, v80, v81
    v_mfma_f32_16x16x32_bf16 v[104:107], a[64:67], v[184:187], v[104:107]
    v_cvt_pk_bf16_f32 v81, v82, v83
    v_pk_max_i16 v80, v80, 0
    v_mfma_f32_16x16x32_bf16 v[108:111], a[64:67], v[188:191], v[108:111]
    v_pk_max_i16 v81, v81, 0
    ds_write_b64 v252, v[80:81] offset:4096
    s_waitcnt vmcnt(16)
    v_mfma_f32_16x16x32_bf16 v[96:99], a[68:71], v[192:195], v[96:99]
    buffer_load_dwordx4 a[28:31], v3, s[8:11], s16 offen offset:3072
    v_cvt_pk_bf16_f32 v84, v84, v85
    v_mfma_f32_16x16x32_bf16 v[100:103], a[68:71], v[196:199], v[100:103]
    v_cvt_pk_bf16_f32 v85, v86, v87
    v_mfma_f32_16x16x32_bf16 v[104:107], a[68:71], v[200:203], v[104:107]
    v_pk_max_i16 v84, v84, 0
    v_pk_max_i16 v85, v85, 0
    v_mfma_f32_16x16x32_bf16 v[108:111], a[68:71], v[204:207], v[108:111]
    ds_write_b64 v253, v[84:85] offset:4096
    s_waitcnt vmcnt(16)
    v_mfma_f32_16x16x32_bf16 v[96:99], a[72:75], v[208:211], v[96:99]
    buffer_load_dwordx4 a[32:35], v4, s[8:11], s16 offen offset:0
    s_mov_b32 s16, s40
    v_cvt_pk_bf16_f32 v88, v88, v89
    v_mfma_f32_16x16x32_bf16 v[100:103], a[72:75], v[212:215], v[100:103]
    v_cvt_pk_bf16_f32 v89, v90, v91
    v_mfma_f32_16x16x32_bf16 v[104:107], a[72:75], v[216:219], v[104:107]
    v_pk_max_i16 v88, v88, 0
    v_pk_max_i16 v89, v89, 0
    v_mfma_f32_16x16x32_bf16 v[108:111], a[72:75], v[220:223], v[108:111]
    ds_write_b64 v254, v[88:89] offset:4096
    s_waitcnt vmcnt(16)
    v_mfma_f32_16x16x32_bf16 v[96:99], a[76:79], v[224:227], v[96:99]
    buffer_load_dwordx4 a[160:163], v2, s[8:11], s16 offen offset:0
    v_cvt_pk_bf16_f32 v92, v92, v93
    v_mfma_f32_16x16x32_bf16 v[100:103], a[76:79], v[228:231], v[100:103]
    v_cvt_pk_bf16_f32 v93, v94, v95
    v_mfma_f32_16x16x32_bf16 v[104:107], a[76:79], v[232:235], v[104:107]
    v_pk_max_i16 v92, v92, 0
    v_pk_max_i16 v93, v93, 0
    v_mfma_f32_16x16x32_bf16 v[108:111], a[76:79], v[236:239], v[108:111]
    ds_write_b64 v255, v[92:93] offset:4096
    s_waitcnt vmcnt(16)
    v_mfma_f32_16x16x32_bf16 v[112:115], a[80:83], v[176:179], v[112:115]
    buffer_load_dwordx4 a[164:167], v2, s[8:11], s16 offen offset:1024
    v_mfma_f32_16x16x32_bf16 v[116:119], a[80:83], v[180:183], v[116:119]
    v_cvt_pk_bf16_f32 v96, v96, v97
    v_mfma_f32_16x16x32_bf16 v[120:123], a[80:83], v[184:187], v[120:123]
    v_cvt_pk_bf16_f32 v97, v98, v99
    v_pk_max_i16 v96, v96, 0
    v_mfma_f32_16x16x32_bf16 v[124:127], a[80:83], v[188:191], v[124:127]
    v_pk_max_i16 v97, v97, 0
    ds_write_b64 v248, v[96:97] offset:8192
    s_waitcnt vmcnt(16)
    v_mfma_f32_16x16x32_bf16 v[112:115], a[84:87], v[192:195], v[112:115]
    buffer_load_dwordx4 a[168:171], v2, s[8:11], s16 offen offset:2048
    v_cvt_pk_bf16_f32 v100, v100, v101
    v_mfma_f32_16x16x32_bf16 v[116:119], a[84:87], v[196:199], v[116:119]
    v_cvt_pk_bf16_f32 v101, v102, v103
    v_mfma_f32_16x16x32_bf16 v[120:123], a[84:87], v[200:203], v[120:123]
    v_pk_max_i16 v100, v100, 0
    v_pk_max_i16 v101, v101, 0
    v_mfma_f32_16x16x32_bf16 v[124:127], a[84:87], v[204:207], v[124:127]
    ds_write_b64 v249, v[100:101] offset:8192
    s_waitcnt vmcnt(16)
    v_mfma_f32_16x16x32_bf16 v[112:115], a[88:91], v[208:211], v[112:115]
    buffer_load_dwordx4 a[172:175], v2, s[8:11], s16 offen offset:3072
    v_cvt_pk_bf16_f32 v104, v104, v105
    v_mfma_f32_16x16x32_bf16 v[116:119], a[88:91], v[212:215], v[116:119]
    v_cvt_pk_bf16_f32 v105, v106, v107
    v_mfma_f32_16x16x32_bf16 v[120:123], a[88:91], v[216:219], v[120:123]
    v_pk_max_i16 v104, v104, 0
    v_pk_max_i16 v105, v105, 0
    v_mfma_f32_16x16x32_bf16 v[124:127], a[88:91], v[220:223], v[124:127]
    ds_write_b64 v250, v[104:105] offset:8192
    s_waitcnt vmcnt(16)
    v_mfma_f32_16x16x32_bf16 v[112:115], a[92:95], v[224:227], v[112:115]
    buffer_load_dwordx4 a[176:179], v3, s[8:11], s16 offen offset:0
    v_cvt_pk_bf16_f32 v108, v108, v109
    v_mfma_f32_16x16x32_bf16 v[116:119], a[92:95], v[228:231], v[116:119]
    v_cvt_pk_bf16_f32 v109, v110, v111
    v_mfma_f32_16x16x32_bf16 v[120:123], a[92:95], v[232:235], v[120:123]
    v_pk_max_i16 v108, v108, 0
    v_pk_max_i16 v109, v109, 0
    v_mfma_f32_16x16x32_bf16 v[124:127], a[92:95], v[236:239], v[124:127]
    ds_write_b64 v251, v[108:109] offset:8192
    s_waitcnt vmcnt(16)
    v_mfma_f32_16x16x32_bf16 v[128:131], a[96:99], v[176:179], v[128:131]
    buffer_load_dwordx4 a[180:183], v3, s[8:11], s16 offen offset:1024
    v_mfma_f32_16x16x32_bf16 v[132:135], a[96:99], v[180:183], v[132:135]
    v_cvt_pk_bf16_f32 v112, v112, v113
    v_mfma_f32_16x16x32_bf16 v[136:139], a[96:99], v[184:187], v[136:139]
    v_cvt_pk_bf16_f32 v113, v114, v115
    v_pk_max_i16 v112, v112, 0
    v_mfma_f32_16x16x32_bf16 v[140:143], a[96:99], v[188:191], v[140:143]
    v_pk_max_i16 v113, v113, 0
    ds_write_b64 v252, v[112:113] offset:8192
    s_waitcnt vmcnt(16)
    v_mfma_f32_16x16x32_bf16 v[128:131], a[100:103], v[192:195], v[128:131]
    buffer_load_dwordx4 a[184:187], v3, s[8:11], s16 offen offset:2048
    v_cvt_pk_bf16_f32 v116, v116, v117
    v_mfma_f32_16x16x32_bf16 v[132:135], a[100:103], v[196:199], v[132:135]
    v_cvt_pk_bf16_f32 v117, v118, v119
    v_mfma_f32_16x16x32_bf16 v[136:139], a[100:103], v[200:203], v[136:139]
    v_pk_max_i16 v116, v116, 0
    v_pk_max_i16 v117, v117, 0
    v_mfma_f32_16x16x32_bf16 v[140:143], a[100:103], v[204:207], v[140:143]
    ds_write_b64 v253, v[116:117] offset:8192
    s_waitcnt vmcnt(16)
    v_mfma_f32_16x16x32_bf16 v[128:131], a[104:107], v[208:211], v[128:131]
    buffer_load_dwordx4 a[188:191], v3, s[8:11], s16 offen offset:3072
    v_cvt_pk_bf16_f32 v120, v120, v121
    v_mfma_f32_16x16x32_bf16 v[132:135], a[104:107], v[212:215], v[132:135]
    v_cvt_pk_bf16_f32 v121, v122, v123
    v_mfma_f32_16x16x32_bf16 v[136:139], a[104:107], v[216:219], v[136:139]
    v_pk_max_i16 v120, v120, 0
    v_pk_max_i16 v121, v121, 0
    v_mfma_f32_16x16x32_bf16 v[140:143], a[104:107], v[220:223], v[140:143]
    ds_write_b64 v254, v[120:121] offset:8192
    s_waitcnt vmcnt(16)
    v_mfma_f32_16x16x32_bf16 v[128:131], a[0:3], v[224:227], v[128:131]
    buffer_load_dwordx4 a[192:195], v4, s[8:11], s16 offen offset:0
    s_add_u32 s16, s16, 9216
    v_cvt_pk_bf16_f32 v124, v124, v125
    v_mfma_f32_16x16x32_bf16 v[132:135], a[0:3], v[228:231], v[132:135]
    v_cvt_pk_bf16_f32 v125, v126, v127
    v_mfma_f32_16x16x32_bf16 v[136:139], a[0:3], v[232:235], v[136:139]
    v_pk_max_i16 v124, v124, 0
    v_pk_max_i16 v125, v125, 0
    v_mfma_f32_16x16x32_bf16 v[140:143], a[0:3], v[236:239], v[140:143]
    ds_write_b64 v255, v[124:125] offset:8192
    s_waitcnt vmcnt(16)
    v_mfma_f32_16x16x32_bf16 v[144:147], a[4:7], v[176:179], v[144:147]
    buffer_load_dwordx4 a[196:199], v2, s[8:11], s16 offen offset:0
    v_mfma_f32_16x16x32_bf16 v[148:151], a[4:7], v[180:183], v[148:151]
    v_cvt_pk_bf16_f32 v128, v128, v129
    v_mfma_f32_16x16x32_bf16 v[152:155], a[4:7], v[184:187], v[152:155]
    v_cvt_pk_bf16_f32 v129, v130, v131
    v_pk_max_i16 v128, v128, 0
    v_mfma_f32_16x16x32_bf16 v[156:159], a[4:7], v[188:191], v[156:159]
    v_pk_max_i16 v129, v129, 0
    ds_write_b64 v248, v[128:129] offset:12288
    s_waitcnt vmcnt(16)
    v_mfma_f32_16x16x32_bf16 v[144:147], a[8:11], v[192:195], v[144:147]
    buffer_load_dwordx4 a[200:203], v2, s[8:11], s16 offen offset:1024
    v_cvt_pk_bf16_f32 v132, v132, v133
    v_mfma_f32_16x16x32_bf16 v[148:151], a[8:11], v[196:199], v[148:151]
    v_cvt_pk_bf16_f32 v133, v134, v135
    v_mfma_f32_16x16x32_bf16 v[152:155], a[8:11], v[200:203], v[152:155]
    v_pk_max_i16 v132, v132, 0
    v_pk_max_i16 v133, v133, 0
    v_mfma_f32_16x16x32_bf16 v[156:159], a[8:11], v[204:207], v[156:159]
    ds_write_b64 v249, v[132:133] offset:12288
    s_waitcnt vmcnt(16)
    v_mfma_f32_16x16x32_bf16 v[144:147], a[12:15], v[208:211], v[144:147]
    buffer_load_dwordx4 a[204:207], v2, s[8:11], s16 offen offset:2048
    v_cvt_pk_bf16_f32 v136, v136, v137
    v_mfma_f32_16x16x32_bf16 v[148:151], a[12:15], v[212:215], v[148:151]
    v_cvt_pk_bf16_f32 v137, v138, v139
    v_mfma_f32_16x16x32_bf16 v[152:155], a[12:15], v[216:219], v[152:155]
    v_pk_max_i16 v136, v136, 0
    v_pk_max_i16 v137, v137, 0
    v_mfma_f32_16x16x32_bf16 v[156:159], a[12:15], v[220:223], v[156:159]
    ds_write_b64 v250, v[136:137] offset:12288
    s_waitcnt vmcnt(16)
    v_mfma_f32_16x16x32_bf16 v[144:147], a[16:19], v[224:227], v[144:147]
    buffer_load_dwordx4 a[208:211], v2, s[8:11], s16 offen offset:3072
    v_cvt_pk_bf16_f32 v140, v140, v141
    v_mfma_f32_16x16x32_bf16 v[148:151], a[16:19], v[228:231], v[148:151]
    v_cvt_pk_bf16_f32 v141, v142, v143
    v_mfma_f32_16x16x32_bf16 v[152:155], a[16:19], v[232:235], v[152:155]
    v_pk_max_i16 v140, v140, 0
    v_pk_max_i16 v141, v141, 0
    v_mfma_f32_16x16x32_bf16 v[156:159], a[16:19], v[236:239], v[156:159]
    ds_write_b64 v251, v[140:141] offset:12288
    s_waitcnt vmcnt(16)
    v_mfma_f32_16x16x32_bf16 v[160:163], a[20:23], v[176:179], v[160:163]
    buffer_load_dwordx4 a[212:215], v3, s[8:11], s16 offen offset:0
    v_mfma_f32_16x16x32_bf16 v[164:167], a[20:23], v[180:183], v[164:167]
    v_cvt_pk_bf16_f32 v144, v144, v145
    v_mfma_f32_16x16x32_bf16 v[168:171], a[20:23], v[184:187], v[168:171]
    v_cvt_pk_bf16_f32 v145, v146, v147
    v_pk_max_i16 v144, v144, 0
    v_mfma_f32_16x16x32_bf16 v[172:175], a[20:23], v[188:191], v[172:175]
    v_pk_max_i16 v145, v145, 0
    ds_write_b64 v252, v[144:145] offset:12288
    s_waitcnt vmcnt(16)
    v_mfma_f32_16x16x32_bf16 v[160:163], a[24:27], v[192:195], v[160:163]
    buffer_load_dwordx4 a[216:219], v3, s[8:11], s16 offen offset:1024
    v_cvt_pk_bf16_f32 v148, v148, v149
    v_mfma_f32_16x16x32_bf16 v[164:167], a[24:27], v[196:199], v[164:167]
    v_cvt_pk_bf16_f32 v149, v150, v151
    v_mfma_f32_16x16x32_bf16 v[168:171], a[24:27], v[200:203], v[168:171]
    v_pk_max_i16 v148, v148, 0
    v_pk_max_i16 v149, v149, 0
    v_mfma_f32_16x16x32_bf16 v[172:175], a[24:27], v[204:207], v[172:175]
    ds_write_b64 v253, v[148:149] offset:12288
    s_waitcnt vmcnt(16)
    v_mfma_f32_16x16x32_bf16 v[160:163], a[28:31], v[208:211], v[160:163]
    buffer_load_dwordx4 a[220:223], v3, s[8:11], s16 offen offset:2048
    v_cvt_pk_bf16_f32 v152, v152, v153
    v_mfma_f32_16x16x32_bf16 v[164:167], a[28:31], v[212:215], v[164:167]
    v_cvt_pk_bf16_f32 v153, v154, v155
    v_mfma_f32_16x16x32_bf16 v[168:171], a[28:31], v[216:219], v[168:171]
    v_pk_max_i16 v152, v152, 0
    v_pk_max_i16 v153, v153, 0
    v_mfma_f32_16x16x32_bf16 v[172:175], a[28:31], v[220:223], v[172:175]
    ds_write_b64 v254, v[152:153] offset:12288
    s_waitcnt vmcnt(16)
    v_mfma_f32_16x16x32_bf16 v[160:163], a[32:35], v[224:227], v[160:163]
    buffer_load_dwordx4 a[224:227], v3, s[8:11], s16 offen offset:3072
    v_cvt_pk_bf16_f32 v156, v156, v157
    v_mfma_f32_16x16x32_bf16 v[164:167], a[32:35], v[228:231], v[164:167]
    v_cvt_pk_bf16_f32 v157, v158, v159
    v_mfma_f32_16x16x32_bf16 v[168:171], a[32:35], v[232:235], v[168:171]
    v_pk_max_i16 v156, v156, 0
    v_pk_max_i16 v157, v157, 0
    v_mfma_f32_16x16x32_bf16 v[172:175], a[32:35], v[236:239], v[172:175]
    ds_write_b64 v255, v[156:157] offset:12288
    s_nop 3
    v_cvt_pk_bf16_f32 v160, v160, v161
    v_cvt_pk_bf16_f32 v161, v162, v163
    v_pk_max_i16 v160, v160, 0
    v_pk_max_i16 v161, v161, 0
    ds_write_b64 v248, v[160:161] offset:16384
    v_cvt_pk_bf16_f32 v164, v164, v165
    v_cvt_pk_bf16_f32 v165, v166, v167
    v_pk_max_i16 v164, v164, 0
    v_pk_max_i16 v165, v165, 0
    ds_write_b64 v249, v[164:165] offset:16384
    v_cvt_pk_bf16_f32 v168, v168, v169
    v_cvt_pk_bf16_f32 v169, v170, v171
    v_pk_max_i16 v168, v168, 0
    v_pk_max_i16 v169, v169, 0
    ds_write_b64 v250, v[168:169] offset:16384
    v_cvt_pk_bf16_f32 v172, v172, v173
    v_cvt_pk_bf16_f32 v173, v174, v175
    v_pk_max_i16 v172, v172, 0
    v_pk_max_i16 v173, v173, 0
    ds_write_b64 v251, v[172:173] offset:16384
    s_waitcnt lgkmcnt(0)
    s_barrier
    ds_read_b128 a[0:3], v22 offset:0
    ds_read_b128 a[4:7], v22 offset:1024
    ds_read_b128 a[8:11], v22 offset:2048
    ds_read_b128 a[12:15], v22 offset:3072
    ds_read_b128 a[16:19], v22 offset:4096
    ds_read_b128 a[20:23], v22 offset:5120
    ds_read_b128 a[24:27], v22 offset:6144
    ds_read_b128 a[28:31], v22 offset:7168
    ds_read_b128 a[32:35], v22 offset:8192
    ds_read_b128 a[36:39], v22 offset:9216
    ds_read_b128 a[40:43], v22 offset:10240
    ds_read_b128 a[44:47], v22 offset:11264
AL_off2:
    s_waitcnt lgkmcnt(8)
    s_waitcnt vmcnt(16)
    v_mfma_f32_16x16x32_bf16 v[32:35], a[160:163], a[0:3], 0
    buffer_load_dwordx4 a[228:231], v4, s[8:11], s16 offen offset:0
    s_add_u32 s16, s16, 9216
    s_cmp_eq_u32 s16, 340992
    s_cselect_b32 s16, 175104, s16
    ds_read_b128 a[48:51], v22 offset:12288
    v_mfma_f32_16x16x32_bf16 v[36:39], a[160:163], a[4:7], 0
    ds_read_b128 a[52:55], v22 offset:13312
    v_mfma_f32_16x16x32_bf16 v[40:43], a[160:163], a[8:11], 0
    ds_read_b128 a[56:59], v22 offset:14336
    v_mfma_f32_16x16x32_bf16 v[44:47], a[160:163], a[12:15], 0
    ds_read_b128 a[60:63], v22 offset:15360
    s_waitcnt lgkmcnt(8)
    s_waitcnt vmcnt(16)
    v_mfma_f32_16x16x32_bf16 v[32:35], a[164:167], a[16:19], v[32:35]
    buffer_load_dwordx4 a[160:163], v2, s[8:11], s16 offen offset:0
    ds_read_b128 a[64:67], v22 offset:16384
    v_mfma_f32_16x16x32_bf16 v[36:39], a[164:167], a[20:23], v[36:39]
    ds_read_b128 a[68:71], v22 offset:17408
    v_mfma_f32_16x16x32_bf16 v[40:43], a[164:167], a[24:27], v[40:43]
    ds_read_b128 a[72:75], v22 offset:18432
    v_mfma_f32_16x16x32_bf16 v[44:47], a[164:167], a[28:31], v[44:47]
    ds_read_b128 a[76:79], v22 offset:19456
    s_waitcnt lgkmcnt(8)
    s_waitcnt vmcnt(16)
    v_mfma_f32_16x16x32_bf16 v[32:35], a[168:171], a[32:35], v[32:35]
    buffer_load_dwordx4 a[164:167], v2, s[8:11], s16 offen offset:1024
    ds_read_b128 a[80:83], v22 offset:20480
    v_mfma_f32_16x16x32_bf16 v[36:39], a[168:171], a[36:39], v[36:39]
    ds_read_b128 a[84:87], v22 offset:21504
    v_mfma_f32_16x16x32_bf16 v[40:43], a[168:171], a[40:43], v[40:43]
    ds_read_b128 a[88:91], v22 offset:22528
    v_mfma_f32_16x16x32_bf16 v[44:47], a[168:171], a[44:47], v[44:47]
    ds_read_b128 a[92:95], v22 offset:23552
    s_waitcnt lgkmcnt(8)
    s_waitcnt vmcnt(16)
    v_mfma_f32_16x16x32_bf16 v[32:35], a[172:175], a[48:51], v[32:35]
    buffer_load_dwordx4 a[168:171], v2, s[8:11], s16 offen offset:2048
    ds_read_b128 a[96:99], v22 offset:24576
    v_mfma_f32_16x16x32_bf16 v[36:39], a[172:175], a[52:55], v[36:39]
    ds_read_b128 a[100:103], v22 offset:25600
    v_mfma_f32_16x16x32_bf16 v[40:43], a[172:175], a[56:59], v[40:43]
    ds_read_b128 a[104:107], v22 offset:26624
    v_mfma_f32_16x16x32_bf16 v[44:47], a[172:175], a[60:63], v[44:47]
    ds_read_b128 a[108:111], v22 offset:27648
    s_waitcnt lgkmcnt(8)
    s_waitcnt vmcnt(16)
    v_mfma_f32_16x16x32_bf16 v[32:35], a[176:179], a[64:67], v[32:35]
    buffer_load_dwordx4 a[172:175], v2, s[8:11], s16 offen offset:3072
    ds_read_b128 a[112:115], v22 offset:28672
    v_mfma_f32_16x16x32_bf16 v[36:39], a[176:179], a[68:71], v[36:39]
    ds_read_b128 a[116:119], v22 offset:29696
    v_mfma_f32_16x16x32_bf16 v[40:43], a[176:179], a[72:75], v[40:43]
    ds_read_b128 a[120:123], v22 offset:30720
    v_mfma_f32_16x16x32_bf16 v[44:47], a[176:179], a[76:79], v[44:47]
    ds_read_b128 a[124:127], v22 offset:31744
    s_waitcnt lgkmcnt(8)
    s_waitcnt vmcnt(16)
    v_mfma_f32_16x16x32_bf16 v[32:35], a[180:183], a[80:83], v[32:35]
    buffer_load_dwordx4 a[176:179], v3, s[8:11], s16 offen offset:0
    ds_read_b128 a[128:131], v22 offset:32768
    v_mfma_f32_16x16x32_bf16 v[36:39], a[180:183], a[84:87], v[36:39]
    ds_read_b128 a[132:135], v22 offset:33792
    v_mfma_f32_16x16x32_bf16 v[40:43], a[180:183], a[88:91], v[40:43]
    ds_read_b128 a[136:139], v22 offset:34816
    v_mfma_f32_16x16x32_bf16 v[44:47], a[180:183], a[92:95], v[44:47]
    ds_read_b128 a[140:143], v22 offset:35840
    s_waitcnt lgkmcnt(8)
    s_waitcnt vmcnt(16)
    v_mfma_f32_16x16x32_bf16 v[32:35], a[184:187], a[96:99], v[32:35]
    buffer_load_dwordx4 a[180:183], v3, s[8:11], s16 offen offset:1024
    ds_read_b128 a[144:147], v21 offset:0
    v_mfma_f32_16x16x32_bf16 v[36:39], a[184:187], a[100:103], v[36:39]
    ds_read_b128 a[148:151], v21 offset:1024
    v_mfma_f32_16x16x32_bf16 v[40:43], a[184:187], a[104:107], v[40:43]
    ds_read_b128 a[152:155], v21 offset:2048
    v_mfma_f32_16x16x32_bf16 v[44:47], a[184:187], a[108:111], v[44:47]
    ds_read_b128 a[156:159], v21 offset:3072
    s_waitcnt lgkmcnt(8)
    s_waitcnt vmcnt(16)
    v_mfma_f32_16x16x32_bf16 v[32:35], a[188:191], a[112:115], v[32:35]
    buffer_load_dwordx4 a[184:187], v3, s[8:11], s16 offen offset:2048
    ds_read_b128 a[232:235], v21 offset:4096
    v_mfma_f32_16x16x32_bf16 v[36:39], a[188:191], a[116:119], v[36:39]
    ds_read_b128 a[236:239], v21 offset:5120
    v_mfma_f32_16x16x32_bf16 v[40:43], a[188:191], a[120:123], v[40:43]
    ds_read_b128 a[240:243], v21 offset:6144
    v_mfma_f32_16x16x32_bf16 v[44:47], a[188:191], a[124:127], v[44:47]
    ds_read_b128 a[244:247], v21 offset:7168
    s_waitcnt lgkmcnt(8)
    s_waitcnt vmcnt(16)
    v_mfma_f32_16x16x32_bf16 v[32:35], a[192:195], a[128:131], v[32:35]
    buffer_load_dwordx4 a[188:191], v3, s[8:11], s16 offen offset:3072
    ds_read_b128 a[248:251], v21 offset:8192
    v_mfma_f32_16x16x32_bf16 v[36:39], a[192:195], a[132:135], v[36:39]
    ds_read_b128 a[252:255], v21 offset:9216
    v_mfma_f32_16x16x32_bf16 v[40:43], a[192:195], a[136:139], v[40:43]
    ds_read_b128 v[64:67], v21 offset:10240
    v_mfma_f32_16x16x32_bf16 v[44:47], a[192:195], a[140:143], v[44:47]
    ds_read_b128 v[68:71], v21 offset:11264
    s_waitcnt lgkmcnt(8)
    s_waitcnt vmcnt(16)
    v_mfma_f32_16x16x32_bf16 v[32:35], a[196:199], a[144:147], v[32:35]
    buffer_load_dwordx4 a[192:195], v4, s[8:11], s16 offen offset:0
    s_add_u32 s16, s16, 9216
    ds_read_b128 v[72:75], v21 offset:12288
    v_mfma_f32_16x16x32_bf16 v[36:39], a[196:199], a[148:151], v[36:39]
    ds_read_b128 v[76:79], v21 offset:13312
    v_mfma_f32_16x16x32_bf16 v[40:43], a[196:199], a[152:155], v[40:43]
    ds_read_b128 v[80:83], v21 offset:14336
    v_mfma_f32_16x16x32_bf16 v[44:47], a[196:199], a[156:159], v[44:47]
    ds_read_b128 v[84:87], v21 offset:15360
    s_waitcnt lgkmcnt(8)
    s_waitcnt vmcnt(16)
    v_mfma_f32_16x16x32_bf16 v[32:35], a[200:203], a[232:235], v[32:35]
    buffer_load_dwordx4 a[196:199], v2, s[8:11], s16 offen offset:0
    ds_read_b128 v[88:91], v21 offset:16384
    v_mfma_f32_16x16x32_bf16 v[36:39], a[200:203], a[236:239], v[36:39]
    ds_read_b128 v[92:95], v21 offset:17408
    v_mfma_f32_16x16x32_bf16 v[40:43], a[200:203], a[240:243], v[40:43]
    ds_read_b128 v[96:99], v21 offset:18432
    v_mfma_f32_16x16x32_bf16 v[44:47], a[200:203], a[244:247], v[44:47]
    ds_read_b128 v[100:103], v21 offset:19456
    s_waitcnt lgkmcnt(8)
    s_waitcnt vmcnt(16)
    v_mfma_f32_16x16x32_bf16 v[32:35], a[204:207], a[248:251], v[32:35]
    buffer_load_dwordx4 a[200:203], v2, s[8:11], s16 offen offset:1024
    ds_read_b128 v[104:107], v21 offset:20480
    v_mfma_f32_16x16x32_bf16 v[36:39], a[204:207], a[252:255], v[36:39]
    ds_read_b128 v[108:111], v21 offset:21504
    v_mfma_f32_16x16x32_bf16 v[40:43], a[204:207], v[64:67], v[40:43]
    ds_read_b128 v[112:115], v21 offset:22528
    v_mfma_f32_16x16x32_bf16 v[44:47], a[204:207], v[68:71], v[44:47]
    ds_read_b128 v[116:119], v21 offset:23552
    s_waitcnt lgkmcnt(8)
    s_waitcnt vmcnt(16)
    v_mfma_f32_16x16x32_bf16 v[32:35], a[208:211], v[72:75], v[32:35]
    buffer_load_dwordx4 a[204:207], v2, s[8:11], s16 offen offset:2048
    ds_read_b128 v[120:123], v21 offset:24576
    v_mfma_f32_16x16x32_bf16 v[36:39], a[208:211], v[76:79], v[36:39]
    ds_read_b128 v[124:127], v21 offset:25600
    v_mfma_f32_16x16x32_bf16 v[40:43], a[208:211], v[80:83], v[40:43]
    ds_read_b128 v[128:131], v21 offset:26624
    v_mfma_f32_16x16x32_bf16 v[44:47], a[208:211], v[84:87], v[44:47]
    ds_read_b128 v[132:135], v21 offset:27648
    s_waitcnt lgkmcnt(8)
    s_waitcnt vmcnt(16)
    v_mfma_f32_16x16x32_bf16 v[32:35], a[212:215], v[88:91], v[32:35]
    buffer_load_dwordx4 a[208:211], v2, s[8:11], s16 offen offset:3072
    ds_read_b128 v[136:139], v21 offset:28672
    v_mfma_f32_16x16x32_bf16 v[36:39], a[212:215], v[92:95], v[36:39]
    ds_read_b128 v[140:143], v21 offset:29696
    v_mfma_f32_16x16x32_bf16 v[40:43], a[212:215], v[96:99], v[40:43]
    ds_read_b128 v[144:147], v21 offset:30720
    v_mfma_f32_16x16x32_bf16 v[44:47], a[212:215], v[100:103], v[44:47]
    ds_read_b128 v[148:151], v21 offset:31744
    s_waitcnt lgkmcnt(8)
    s_waitcnt vmcnt(16)
    v_mfma_f32_16x16x32_bf16 v[32:35], a[216:219], v[104:107], v[32:35]
    buffer_load_dwordx4 a[212:215], v3, s[8:11], s16 offen offset:0
    ds_read_b128 v[152:155], v21 offset:32768
    v_mfma_f32_16x16x32_bf16 v[36:39], a[216:219], v[108:111], v[36:39]
    ds_read_b128 v[156:159], v21 offset:33792
    v_mfma_f32_16x16x32_bf16 v[40:43], a[216:219], v[112:115], v[40:43]
    ds_read_b128 v[160:163], v21 offset:34816
    v_mfma_f32_16x16x32_bf16 v[44:47], a[216:219], v[116:119], v[44:47]
    ds_read_b128 v[164:167], v21 offset:35840
    s_waitcnt lgkmcnt(8)
    s_waitcnt vmcnt(16)
    v_mfma_f32_16x16x32_bf16 v[32:35], a[220:223], v[120:123], v[32:35]
    buffer_load_dwordx4 a[216:219], v3, s[8:11], s16 offen offset:1024
    v_mfma_f32_16x16x32_bf16 v[36:39], a[220:223], v[124:127], v[36:39]
    v_mfma_f32_16x16x32_bf16 v[40:43], a[220:223], v[128:131], v[40:43]
    v_mfma_f32_16x16x32_bf16 v[44:47], a[220:223], v[132:135], v[44:47]
    s_waitcnt lgkmcnt(4)
    s_waitcnt vmcnt(16)
    v_mfma_f32_16x16x32_bf16 v[32:35], a[224:227], v[136:139], v[32:35]
    buffer_load_dwordx4 a[220:223], v3, s[8:11], s16 offen offset:2048
    v_mfma_f32_16x16x32_bf16 v[36:39], a[224:227], v[140:143], v[36:39]
    v_mfma_f32_16x16x32_bf16 v[40:43], a[224:227], v[144:147], v[40:43]
    v_mfma_f32_16x16x32_bf16 v[44:47], a[224:227], v[148:151], v[44:47]
    s_waitcnt lgkmcnt(0)
    s_waitcnt vmcnt(16)
    v_mfma_f32_16x16x32_bf16 v[32:35], a[228:231], v[152:155], v[32:35]
    buffer_load_dwordx4 a[224:227], v3, s[8:11], s16 offen offset:3072
    v_mfma_f32_16x16x32_bf16 v[36:39], a[228:231], v[156:159], v[36:39]
    v_mfma_f32_16x16x32_bf16 v[40:43], a[228:231], v[160:163], v[40:43]
    v_mfma_f32_16x16x32_bf16 v[44:47], a[228:231], v[164:167], v[44:47]
    s_waitcnt vmcnt(16)
    v_mfma_f32_16x16x32_bf16 v[48:51], a[160:163], a[0:3], 0
    buffer_load_dwordx4 a[228:231], v4, s[8:11], s16 offen offset:0
    s_add_u32 s16, s16, 9216
    s_cmp_eq_u32 s16, 340992
    s_cselect_b32 s16, 175104, s16
    v_mfma_f32_16x16x32_bf16 v[52:55], a[160:163], a[4:7], 0
    v_mfma_f32_16x16x32_bf16 v[56:59], a[160:163], a[8:11], 0
    v_mfma_f32_16x16x32_bf16 v[60:63], a[160:163], a[12:15], 0
    v_cvt_pk_bf16_f32 v244, v32, v33
    s_waitcnt vmcnt(16)
    v_mfma_f32_16x16x32_bf16 v[48:51], a[164:167], a[16:19], v[48:51]
    buffer_load_dwordx4 a[160:163], v2, s[8:11], s16 offen offset:0
    v_mfma_f32_16x16x32_bf16 v[52:55], a[164:167], a[20:23], v[52:55]
    v_cvt_pk_bf16_f32 v245, v34, v35
    v_mfma_f32_16x16x32_bf16 v[56:59], a[164:167], a[24:27], v[56:59]
    v_cvt_pk_bf16_f32 v246, v36, v37
    v_mfma_f32_16x16x32_bf16 v[60:63], a[164:167], a[28:31], v[60:63]
    v_cvt_pk_bf16_f32 v247, v38, v39
    s_waitcnt vmcnt(16)
    v_mfma_f32_16x16x32_bf16 v[48:51], a[168:171], a[32:35], v[48:51]
    buffer_load_dwordx4 a[164:167], v2, s[8:11], s16 offen offset:1024
    v_mfma_f32_16x16x32_bf16 v[52:55], a[168:171], a[36:39], v[52:55]
    buffer_store_dwordx4 v[244:247], v20, s[12:15], s31 offen offset:0 sc1
    v_mfma_f32_16x16x32_bf16 v[56:59], a[168:171], a[40:43], v[56:59]
    v_cvt_pk_bf16_f32 v248, v40, v41
    v_mfma_f32_16x16x32_bf16 v[60:63], a[168:171], a[44:47], v[60:63]
    v_cvt_pk_bf16_f32 v249, v42, v43
    s_waitcnt vmcnt(17)
    v_mfma_f32_16x16x32_bf16 v[48:51], a[172:175], a[48:51], v[48:51]
    buffer_load_dwordx4 a[168:171], v2, s[8:11], s16 offen offset:2048
    v_mfma_f32_16x16x32_bf16 v[52:55], a[172:175], a[52:55], v[52:55]
    v_cvt_pk_bf16_f32 v250, v44, v45
    v_mfma_f32_16x16x32_bf16 v[56:59], a[172:175], a[56:59], v[56:59]
    v_cvt_pk_bf16_f32 v251, v46, v47
    v_mfma_f32_16x16x32_bf16 v[60:63], a[172:175], a[60:63], v[60:63]
    buffer_store_dwordx4 v[248:251], v20, s[12:15], s31 offen offset:1024 sc1
    s_add_u32 s31, s31, 8192
    s_cmp_eq_u32 s31, s42
    s_cselect_b32 s31, s41, s31
    s_waitcnt vmcnt(18)
    v_mfma_f32_16x16x32_bf16 v[48:51], a[176:179], a[64:67], v[48:51]
    buffer_load_dwordx4 a[172:175], v2, s[8:11], s16 offen offset:3072
    v_mfma_f32_16x16x32_bf16 v[52:55], a[176:179], a[68:71], v[52:55]
    v_and_b32 v12, 3, v0
    v_mfma_f32_16x16x32_bf16 v[56:59], a[176:179], a[72:75], v[56:59]
    v_lshrrev_b32 v13, 5, v0
    v_mfma_f32_16x16x32_bf16 v[60:63], a[176:179], a[76:79], v[60:63]
    v_and_b32 v14, 1, v10
    s_waitcnt vmcnt(18)
    v_mfma_f32_16x16x32_bf16 v[48:51], a[180:183], a[80:83], v[48:51]
    buffer_load_dwordx4 a[176:179], v3, s[8:11], s16 offen offset:0
    v_mfma_f32_16x16x32_bf16 v[52:55], a[180:183], a[84:87], v[52:55]
    s_lshr_b32 s48, s19, 2
    v_mfma_f32_16x16x32_bf16 v[56:59], a[180:183], a[88:91], v[56:59]
    s_and_b32 s49, s19, 3
    v_mfma_f32_16x16x32_bf16 v[60:63], a[180:183], a[92:95], v[60:63]
    s_lshl_b32 s50, s48, 1
    s_waitcnt vmcnt(18)
    v_mfma_f32_16x16x32_bf16 v[48:51], a[184:187], a[96:99], v[48:51]
    buffer_load_dwordx4 a[180:183], v3, s[8:11], s16 offen offset:1024
    v_mfma_f32_16x16x32_bf16 v[52:55], a[184:187], a[100:103], v[52:55]
    s_lshl_b32 s51, s49, 2
    v_mfma_f32_16x16x32_bf16 v[56:59], a[184:187], a[104:107], v[56:59]
    v_add_u32 v13, s50, v13
    v_mfma_f32_16x16x32_bf16 v[60:63], a[184:187], a[108:111], v[60:63]
    v_add_u32 v15, s51, v12
    s_waitcnt vmcnt(18)
    v_mfma_f32_16x16x32_bf16 v[48:51], a[188:191], a[112:115], v[48:51]
    buffer_load_dwordx4 a[184:187], v3, s[8:11], s16 offen offset:2048
    v_mfma_f32_16x16x32_bf16 v[52:55], a[188:191], a[116:119], v[52:55]
    v_lshl_add_u32 v16, v11, 1, v14
    v_mfma_f32_16x16x32_bf16 v[56:59], a[188:191], a[120:123], v[56:59]
    v_lshlrev_b32 v17, 1, v14
    v_mfma_f32_16x16x32_bf16 v[60:63], a[188:191], a[124:127], v[60:63]
    v_xor_b32 v17, v13, v17
    s_waitcnt vmcnt(18)
    v_mfma_f32_16x16x32_bf16 v[48:51], a[192:195], a[128:131], v[48:51]
    buffer_load_dwordx4 a[188:191], v3, s[8:11], s16 offen offset:3072
    v_mfma_f32_16x16x32_bf16 v[52:55], a[192:195], a[132:135], v[52:55]
    v_lshlrev_b32 v18, 10, v16
    v_mfma_f32_16x16x32_bf16 v[56:59], a[192:195], a[136:139], v[56:59]
    v_lshl_add_u32 v18, v15, 1, v18
    v_mfma_f32_16x16x32_bf16 v[60:63], a[192:195], a[140:143], v[60:63]
    v_lshl_add_u32 v18, v17, 5, v18
    s_waitcnt vmcnt(18)
    v_mfma_f32_16x16x32_bf16 v[48:51], a[196:199], a[144:147], v[48:51]
    buffer_load_dwordx4 a[192:195], v4, s[8:11], s16 offen offset:0
    s_add_u32 s16, s16, 9216
    v_mfma_f32_16x16x32_bf16 v[52:55], a[196:199], a[148:151], v[52:55]
    v_lshl_add_u32 v13, v13, 4, v15
    v_mfma_f32_16x16x32_bf16 v[56:59], a[196:199], a[152:155], v[56:59]
    v_lshlrev_b32 v17, 4, v13
    v_mfma_f32_16x16x32_bf16 v[60:63], a[196:199], a[156:159], v[60:63]
    v_add_u32 v17, 147456, v17
    s_waitcnt vmcnt(18)
    v_mfma_f32_16x16x32_bf16 v[48:51], a[200:203], a[232:235], v[48:51]
    buffer_load_dwordx4 a[196:199], v2, s[8:11], s16 offen offset:0
    v_mfma_f32_16x16x32_bf16 v[52:55], a[200:203], a[236:239], v[52:55]
    v_mov_b32 v23, 0
    v_mfma_f32_16x16x32_bf16 v[56:59], a[200:203], a[240:243], v[56:59]
    ds_read_u16_d16_hi v23, v17
    v_mfma_f32_16x16x32_bf16 v[60:63], a[200:203], a[244:247], v[60:63]
    v_mul_u32_u24 v13, 1152, v13
    s_waitcnt vmcnt(18)
    v_mfma_f32_16x16x32_bf16 v[48:51], a[204:207], a[248:251], v[48:51]
    buffer_load_dwordx4 a[200:203], v2, s[8:11], s16 offen offset:1024
    v_mfma_f32_16x16x32_bf16 v[52:55], a[204:207], a[252:255], v[52:55]
    v_lshl_add_u32 v13, v16, 4, v13
    v_mfma_f32_16x16x32_bf16 v[56:59], a[204:207], v[64:67], v[56:59]
    v_lshlrev_b32 v16, 5, v16
    v_mfma_f32_16x16x32_bf16 v[60:63], a[204:207], v[68:71], v[60:63]
    v_mul_u32_u24 v14, 2359296 >> 4, v10
    s_waitcnt vmcnt(18)
    v_mfma_f32_16x16x32_bf16 v[48:51], a[208:211], v[72:75], v[48:51]
    buffer_load_dwordx4 a[204:207], v2, s[8:11], s16 offen offset:2048
    v_mfma_f32_16x16x32_bf16 v[52:55], a[208:211], v[76:79], v[52:55]
    v_and_b32 v15, 15, v0
    v_mfma_f32_16x16x32_bf16 v[56:59], a[208:211], v[80:83], v[56:59]
    v_add_u32 v14, v14, v15
    v_mfma_f32_16x16x32_bf16 v[60:63], a[208:211], v[84:87], v[60:63]
    v_lshlrev_b32 v14, 4, v14
    s_waitcnt vmcnt(18)
    v_mfma_f32_16x16x32_bf16 v[48:51], a[212:215], v[88:91], v[48:51]
    buffer_load_dwordx4 a[208:211], v2, s[8:11], s16 offen offset:3072
    v_mfma_f32_16x16x32_bf16 v[52:55], a[212:215], v[92:95], v[52:55]
    v_add_u32 v15, 4096, v14
    v_mfma_f32_16x16x32_bf16 v[56:59], a[212:215], v[96:99], v[56:59]
    s_mul_i32 s52, s3, 73728
    v_mfma_f32_16x16x32_bf16 v[60:63], a[212:215], v[100:103], v[60:63]
    s_lshl_b32 s48, s48, 10
    s_waitcnt vmcnt(18)
    v_mfma_f32_16x16x32_bf16 v[48:51], a[216:219], v[104:107], v[48:51]
    buffer_load_dwordx4 a[212:215], v3, s[8:11], s16 offen offset:0
    v_mfma_f32_16x16x32_bf16 v[52:55], a[216:219], v[108:111], v[52:55]
    s_lshl_b32 s49, s49, 8
    v_mfma_f32_16x16x32_bf16 v[56:59], a[216:219], v[112:115], v[56:59]
    s_add_u32 s53, s52, s48
    v_mfma_f32_16x16x32_bf16 v[60:63], a[216:219], v[116:119], v[60:63]
    s_add_u32 s53, s53, s49
    s_waitcnt vmcnt(18)
    v_mfma_f32_16x16x32_bf16 v[48:51], a[220:223], v[120:123], v[48:51]
    buffer_load_dwordx4 a[216:219], v3, s[8:11], s16 offen offset:1024
    v_mfma_f32_16x16x32_bf16 v[52:55], a[220:223], v[124:127], v[52:55]
    s_add_u32 s53, s53, 23330816
    v_mfma_f32_16x16x32_bf16 v[56:59], a[220:223], v[128:131], v[56:59]
    s_add_u32 s48, s43, s6
    s_add_u32 s48, s48, 0
    s_cmp_ge_u32 s48, 9
    s_cselect_b32 s49, 9, 0
    s_sub_u32 s48, s48, s49
    v_mfma_f32_16x16x32_bf16 v[60:63], a[220:223], v[132:135], v[60:63]
    s_lshl_b32 s49, s48, 13
    s_waitcnt vmcnt(18)
    v_mfma_f32_16x16x32_bf16 v[48:51], a[224:227], v[136:139], v[48:51]
    buffer_load_dwordx4 a[220:223], v3, s[8:11], s16 offen offset:2048
    v_mfma_f32_16x16x32_bf16 v[52:55], a[224:227], v[140:143], v[52:55]
    s_add_u32 s24, s53, s49
    v_mfma_f32_16x16x32_bf16 v[56:59], a[224:227], v[144:147], v[56:59]
    v_add_u32 v216, s49, v18
    v_mfma_f32_16x16x32_bf16 v[60:63], a[224:227], v[148:151], v[60:63]
    v_xor_b32 v217, 32, v216
    s_waitcnt vmcnt(18)
    v_mfma_f32_16x16x32_bf16 v[48:51], a[228:231], v[152:155], v[48:51]
    buffer_load_dwordx4 a[224:227], v3, s[8:11], s16 offen offset:3072
    v_mfma_f32_16x16x32_bf16 v[52:55], a[228:231], v[156:159], v[52:55]
    s_lshl_b32 s49, s48, 7
    v_mfma_f32_16x16x32_bf16 v[56:59], a[228:231], v[160:163], v[56:59]
    s_add_u32 s27, s52, s49
    v_mfma_f32_16x16x32_bf16 v[60:63], a[228:231], v[164:167], v[60:63]
    s_lshl_b32 s49, s48, 8
    s_waitcnt vmcnt(18)
    v_mfma_f32_16x16x32_bf16 v[32:35], a[160:163], a[0:3], 0
    buffer_load_dwordx4 a[228:231], v4, s[8:11], s16 offen offset:0
    s_add_u32 s16, s16, 9216
    s_cmp_eq_u32 s16, 340992
    s_cselect_b32 s16, 175104, s16
    v_mfma_f32_16x16x32_bf16 v[36:39], a[160:163], a[4:7], 0
    v_mfma_f32_16x16x32_bf16 v[40:43], a[160:163], a[8:11], 0
    v_mfma_f32_16x16x32_bf16 v[44:47], a[160:163], a[12:15], 0
    v_cvt_pk_bf16_f32 v244, v48, v49
    s_waitcnt vmcnt(18)
    v_mfma_f32_16x16x32_bf16 v[32:35], a[164:167], a[16:19], v[32:35]
    buffer_load_dwordx4 a[160:163], v2, s[8:11], s16 offen offset:0
    v_mfma_f32_16x16x32_bf16 v[36:39], a[164:167], a[20:23], v[36:39]
    v_cvt_pk_bf16_f32 v245, v50, v51
    v_mfma_f32_16x16x32_bf16 v[40:43], a[164:167], a[24:27], v[40:43]
    v_cvt_pk_bf16_f32 v246, v52, v53
    v_mfma_f32_16x16x32_bf16 v[44:47], a[164:167], a[28:31], v[44:47]
    v_cvt_pk_bf16_f32 v247, v54, v55
    s_waitcnt vmcnt(17)
    v_mfma_f32_16x16x32_bf16 v[32:35], a[168:171], a[32:35], v[32:35]
    buffer_load_dwordx4 a[164:167], v2, s[8:11], s16 offen offset:1024
    v_mfma_f32_16x16x32_bf16 v[36:39], a[168:171], a[36:39], v[36:39]
    buffer_store_dwordx4 v[244:247], v20, s[12:15], s31 offen offset:0 sc1
    v_mfma_f32_16x16x32_bf16 v[40:43], a[168:171], a[40:43], v[40:43]
    v_cvt_pk_bf16_f32 v248, v56, v57
    v_mfma_f32_16x16x32_bf16 v[44:47], a[168:171], a[44:47], v[44:47]
    v_cvt_pk_bf16_f32 v249, v58, v59
    s_waitcnt vmcnt(17)
    v_mfma_f32_16x16x32_bf16 v[32:35], a[172:175], a[48:51], v[32:35]
    buffer_load_dwordx4 a[168:171], v2, s[8:11], s16 offen offset:2048
    v_mfma_f32_16x16x32_bf16 v[36:39], a[172:175], a[52:55], v[36:39]
    v_cvt_pk_bf16_f32 v250, v60, v61
    v_mfma_f32_16x16x32_bf16 v[40:43], a[172:175], a[56:59], v[40:43]
    v_cvt_pk_bf16_f32 v251, v62, v63
    v_mfma_f32_16x16x32_bf16 v[44:47], a[172:175], a[60:63], v[44:47]
    buffer_store_dwordx4 v[248:251], v20, s[12:15], s31 offen offset:1024 sc1
    s_add_u32 s31, s31, 8192
    s_cmp_eq_u32 s31, s42
    s_cselect_b32 s31, s41, s31
    s_waitcnt vmcnt(18)
    v_mfma_f32_16x16x32_bf16 v[32:35], a[176:179], a[64:67], v[32:35]
    buffer_load_dwordx4 a[172:175], v2, s[8:11], s16 offen offset:3072
    v_mfma_f32_16x16x32_bf16 v[36:39], a[176:179], a[68:71], v[36:39]
    s_add_u32 s32, s49, 7340032
    v_mfma_f32_16x16x32_bf16 v[40:43], a[176:179], a[72:75], v[40:43]
    s_add_u32 s48, s43, s6
    s_add_u32 s48, s48, 5
    s_cmp_ge_u32 s48, 9
    s_cselect_b32 s49, 9, 0
    s_sub_u32 s48, s48, s49
    v_mfma_f32_16x16x32_bf16 v[44:47], a[176:179], a[76:79], v[44:47]
    s_lshl_b32 s49, s48, 13
    s_waitcnt vmcnt(18)
    v_mfma_f32_16x16x32_bf16 v[32:35], a[180:183], a[80:83], v[32:35]
    buffer_load_dwordx4 a[176:179], v3, s[8:11], s16 offen offset:0
    v_mfma_f32_16x16x32_bf16 v[36:39], a[180:183], a[84:87], v[36:39]
    s_add_u32 s25, s53, s49
    v_mfma_f32_16x16x32_bf16 v[40:43], a[180:183], a[88:91], v[40:43]
    v_add_u32 v218, s49, v18
    v_mfma_f32_16x16x32_bf16 v[44:47], a[180:183], a[92:95], v[44:47]
    v_xor_b32 v219, 32, v218
    s_waitcnt vmcnt(18)
    v_mfma_f32_16x16x32_bf16 v[32:35], a[184:187], a[96:99], v[32:35]
    buffer_load_dwordx4 a[180:183], v3, s[8:11], s16 offen offset:1024
    v_mfma_f32_16x16x32_bf16 v[36:39], a[184:187], a[100:103], v[36:39]
    s_lshl_b32 s49, s48, 7
    v_mfma_f32_16x16x32_bf16 v[40:43], a[184:187], a[104:107], v[40:43]
    s_add_u32 s28, s52, s49
    v_mfma_f32_16x16x32_bf16 v[44:47], a[184:187], a[108:111], v[44:47]
    s_lshl_b32 s49, s48, 8
    s_waitcnt vmcnt(18)
    v_mfma_f32_16x16x32_bf16 v[32:35], a[188:191], a[112:115], v[32:35]
    buffer_load_dwordx4 a[184:187], v3, s[8:11], s16 offen offset:2048
    v_mfma_f32_16x16x32_bf16 v[36:39], a[188:191], a[116:119], v[36:39]
    s_add_u32 s33, s49, 7340032
    v_mfma_f32_16x16x32_bf16 v[40:43], a[188:191], a[120:123], v[40:43]
    s_add_u32 s48, s43, 4
    s_add_u32 s48, s48, 0
    s_cmp_ge_u32 s48, 9
    s_cselect_b32 s49, 9, 0
    s_sub_u32 s48, s48, s49
    v_mfma_f32_16x16x32_bf16 v[44:47], a[188:191], a[124:127], v[44:47]
    s_lshl_b32 s49, s48, 13
    s_waitcnt vmcnt(18)
    v_mfma_f32_16x16x32_bf16 v[32:35], a[192:195], a[128:131], v[32:35]
    buffer_load_dwordx4 a[188:191], v3, s[8:11], s16 offen offset:3072
    v_mfma_f32_16x16x32_bf16 v[36:39], a[192:195], a[132:135], v[36:39]
    s_add_u32 s26, s53, s49
    v_mfma_f32_16x16x32_bf16 v[40:43], a[192:195], a[136:139], v[40:43]
    v_add_u32 v220, s49, v18
    v_mfma_f32_16x16x32_bf16 v[44:47], a[192:195], a[140:143], v[44:47]
    v_xor_b32 v221, 32, v220
    s_waitcnt vmcnt(18)
    v_mfma_f32_16x16x32_bf16 v[32:35], a[196:199], a[144:147], v[32:35]
    buffer_load_dwordx4 a[192:195], v4, s[8:11], s16 offen offset:0
    s_add_u32 s16, s16, 9216
    v_mfma_f32_16x16x32_bf16 v[36:39], a[196:199], a[148:151], v[36:39]
    s_lshl_b32 s49, s48, 7
    v_mfma_f32_16x16x32_bf16 v[40:43], a[196:199], a[152:155], v[40:43]
    s_add_u32 s29, s52, s49
    v_mfma_f32_16x16x32_bf16 v[44:47], a[196:199], a[156:159], v[44:47]
    s_lshl_b32 s49, s48, 8
    s_waitcnt vmcnt(18)
    v_mfma_f32_16x16x32_bf16 v[32:35], a[200:203], a[232:235], v[32:35]
    buffer_load_dwordx4 a[196:199], v2, s[8:11], s16 offen offset:0
    v_mfma_f32_16x16x32_bf16 v[36:39], a[200:203], a[236:239], v[36:39]
    s_add_u32 s34, s49, 7340032
    v_mfma_f32_16x16x32_bf16 v[40:43], a[200:203], a[240:243], v[40:43]
    s_lshl_b32 s56, s3, 10
    v_mfma_f32_16x16x32_bf16 v[44:47], a[200:203], a[244:247], v[44:47]
    s_add_u32 s56, s56, 393216
    s_waitcnt vmcnt(18)
    v_mfma_f32_16x16x32_bf16 v[32:35], a[204:207], a[248:251], v[32:35]
    buffer_load_dwordx4 a[200:203], v2, s[8:11], s16 offen offset:1024
    v_mfma_f32_16x16x32_bf16 v[36:39], a[204:207], a[252:255], v[36:39]
    s_lshl_b32 s57, s19, 7
    v_mfma_f32_16x16x32_bf16 v[40:43], a[204:207], v[64:67], v[40:43]
    s_add_u32 s57, s57, s56
    v_mfma_f32_16x16x32_bf16 v[44:47], a[204:207], v[68:71], v[44:47]
    v_and_b32 v5, 7, v0
    s_waitcnt vmcnt(18)
    v_mfma_f32_16x16x32_bf16 v[32:35], a[208:211], v[72:75], v[32:35]
    buffer_load_dwordx4 a[204:207], v2, s[8:11], s16 offen offset:2048
    v_mfma_f32_16x16x32_bf16 v[36:39], a[208:211], v[76:79], v[36:39]
    v_lshlrev_b32 v5, 7, v5
    v_mfma_f32_16x16x32_bf16 v[40:43], a[208:211], v[80:83], v[40:43]
    v_mov_b32 v168, 0
    v_mfma_f32_16x16x32_bf16 v[44:47], a[208:211], v[84:87], v[44:47]
    v_mov_b32 v169, 0
    s_waitcnt vmcnt(18)
    v_mfma_f32_16x16x32_bf16 v[32:35], a[212:215], v[88:91], v[32:35]
    buffer_load_dwordx4 a[208:211], v2, s[8:11], s16 offen offset:3072
    v_mfma_f32_16x16x32_bf16 v[36:39], a[212:215], v[92:95], v[36:39]
    v_mov_b32 v170, 0
    v_mfma_f32_16x16x32_bf16 v[40:43], a[212:215], v[96:99], v[40:43]
    v_mov_b32 v171, 0
    v_mfma_f32_16x16x32_bf16 v[44:47], a[212:215], v[100:103], v[44:47]
    v_mov_b32 v172, 0
    s_waitcnt vmcnt(18)
    v_mfma_f32_16x16x32_bf16 v[32:35], a[216:219], v[104:107], v[32:35]
    buffer_load_dwordx4 a[212:215], v3, s[8:11], s16 offen offset:0
    v_mfma_f32_16x16x32_bf16 v[36:39], a[216:219], v[108:111], v[36:39]
    v_mov_b32 v173, 0
    v_mfma_f32_16x16x32_bf16 v[40:43], a[216:219], v[112:115], v[40:43]
    v_mov_b32 v174, 0
    v_mfma_f32_16x16x32_bf16 v[44:47], a[216:219], v[116:119], v[44:47]
    v_mov_b32 v175, 0
    s_waitcnt vmcnt(18)
    v_mfma_f32_16x16x32_bf16 v[32:35], a[220:223], v[120:123], v[32:35]
    buffer_load_dwordx4 a[216:219], v3, s[8:11], s16 offen offset:1024
    v_mfma_f32_16x16x32_bf16 v[36:39], a[220:223], v[124:127], v[36:39]
    v_mov_b32 v176, 0
    v_mfma_f32_16x16x32_bf16 v[40:43], a[220:223], v[128:131], v[40:43]
    v_mov_b32 v177, 0
    v_mfma_f32_16x16x32_bf16 v[44:47], a[220:223], v[132:135], v[44:47]
    v_mov_b32 v178, 0
    s_waitcnt vmcnt(18)
    v_mfma_f32_16x16x32_bf16 v[32:35], a[224:227], v[136:139], v[32:35]
    buffer_load_dwordx4 a[220:223], v3, s[8:11], s16 offen offset:2048
    v_mfma_f32_16x16x32_bf16 v[36:39], a[224:227], v[140:143], v[36:39]
    v_mov_b32 v179, 0
    v_mfma_f32_16x16x32_bf16 v[40:43], a[224:227], v[144:147], v[40:43]
    v_mov_b32 v180, 0
    v_mfma_f32_16x16x32_bf16 v[44:47], a[224:227], v[148:151], v[44:47]
    v_mov_b32 v181, 0
    s_waitcnt vmcnt(18)
    v_mfma_f32_16x16x32_bf16 v[32:35], a[228:231], v[152:155], v[32:35]
    buffer_load_dwordx4 a[224:227], v3, s[8:11], s16 offen offset:3072
    v_mfma_f32_16x16x32_bf16 v[36:39], a[228:231], v[156:159], v[36:39]
    v_mov_b32 v182, 0
    v_mfma_f32_16x16x32_bf16 v[40:43], a[228:231], v[160:163], v[40:43]
    v_mov_b32 v183, 0
    v_mfma_f32_16x16x32_bf16 v[44:47], a[228:231], v[164:167], v[44:47]
    v_mov_b32 v184, 0
    s_waitcnt vmcnt(18)
    v_mfma_f32_16x16x32_bf16 v[48:51], a[160:163], a[0:3], 0
    buffer_load_dwordx4 a[228:231], v4, s[8:11], s16 offen offset:0
    s_add_u32 s16, s16, 9216
    s_cmp_eq_u32 s16, 340992
    s_cselect_b32 s16, 175104, s16
    v_mfma_f32_16x16x32_bf16 v[52:55], a[160:163], a[4:7], 0
    v_mfma_f32_16x16x32_bf16 v[56:59], a[160:163], a[8:11], 0
    v_mfma_f32_16x16x32_bf16 v[60:63], a[160:163], a[12:15], 0
    v_cvt_pk_bf16_f32 v244, v32, v33
    s_waitcnt vmcnt(18)
    v_mfma_f32_16x16x32_bf16 v[48:51], a[164:167], a[16:19], v[48:51]
    buffer_load_dwordx4 a[160:163], v2, s[8:11], s16 offen offset:0
    v_mfma_f32_16x16x32_bf16 v[52:55], a[164:167], a[20:23], v[52:55]
    v_cvt_pk_bf16_f32 v245, v34, v35
    v_mfma_f32_16x16x32_bf16 v[56:59], a[164:167], a[24:27], v[56:59]
    v_cvt_pk_bf16_f32 v246, v36, v37
    v_mfma_f32_16x16x32_bf16 v[60:63], a[164:167], a[28:31], v[60:63]
    v_cvt_pk_bf16_f32 v247, v38, v39
    s_waitcnt vmcnt(17)
    v_mfma_f32_16x16x32_bf16 v[48:51], a[168:171], a[32:35], v[48:51]
    buffer_load_dwordx4 a[164:167], v2, s[8:11], s16 offen offset:1024
    v_mfma_f32_16x16x32_bf16 v[52:55], a[168:171], a[36:39], v[52:55]
    buffer_store_dwordx4 v[244:247], v20, s[12:15], s31 offen offset:0 sc1
    v_mfma_f32_16x16x32_bf16 v[56:59], a[168:171], a[40:43], v[56:59]
    v_cvt_pk_bf16_f32 v248, v40, v41
    v_mfma_f32_16x16x32_bf16 v[60:63], a[168:171], a[44:47], v[60:63]
    v_cvt_pk_bf16_f32 v249, v42, v43
    s_waitcnt vmcnt(17)
    v_mfma_f32_16x16x32_bf16 v[48:51], a[172:175], a[48:51], v[48:51]
    buffer_load_dwordx4 a[168:171], v2, s[8:11], s16 offen offset:2048
    v_mfma_f32_16x16x32_bf16 v[52:55], a[172:175], a[52:55], v[52:55]
    v_cvt_pk_bf16_f32 v250, v44, v45
    v_mfma_f32_16x16x32_bf16 v[56:59], a[172:175], a[56:59], v[56:59]
    v_cvt_pk_bf16_f32 v251, v46, v47
    v_mfma_f32_16x16x32_bf16 v[60:63], a[172:175], a[60:63], v[60:63]
    buffer_store_dwordx4 v[248:251], v20, s[12:15], s31 offen offset:1024 sc1
    s_add_u32 s31, s31, 8192
    s_cmp_eq_u32 s31, s42
    s_cselect_b32 s31, s41, s31
    s_waitcnt vmcnt(18)
    v_mfma_f32_16x16x32_bf16 v[48:51], a[176:179], a[64:67], v[48:51]
    buffer_load_dwordx4 a[172:175], v2, s[8:11], s16 offen offset:3072
    v_mfma_f32_16x16x32_bf16 v[52:55], a[176:179], a[68:71], v[52:55]
    v_mov_b32 v185, 0
    v_mfma_f32_16x16x32_bf16 v[56:59], a[176:179], a[72:75], v[56:59]
    v_mov_b32 v186, 0
    v_mfma_f32_16x16x32_bf16 v[60:63], a[176:179], a[76:79], v[60:63]
    v_mov_b32 v187, 0
    s_waitcnt vmcnt(18)
    v_mfma_f32_16x16x32_bf16 v[48:51], a[180:183], a[80:83], v[48:51]
    buffer_load_dwordx4 a[176:179], v3, s[8:11], s16 offen offset:0
    v_mfma_f32_16x16x32_bf16 v[52:55], a[180:183], a[84:87], v[52:55]
    v_mov_b32 v188, 0
    v_mfma_f32_16x16x32_bf16 v[56:59], a[180:183], a[88:91], v[56:59]
    v_mov_b32 v189, 0
    v_mfma_f32_16x16x32_bf16 v[60:63], a[180:183], a[92:95], v[60:63]
    v_mov_b32 v190, 0
    s_waitcnt vmcnt(18)
    v_mfma_f32_16x16x32_bf16 v[48:51], a[184:187], a[96:99], v[48:51]
    buffer_load_dwordx4 a[180:183], v3, s[8:11], s16 offen offset:1024
    v_mfma_f32_16x16x32_bf16 v[52:55], a[184:187], a[100:103], v[52:55]
    v_mov_b32 v191, 0
    v_mfma_f32_16x16x32_bf16 v[56:59], a[184:187], a[104:107], v[56:59]
    ds_read_u16_d16_hi v168, v216 offset:0
    v_mfma_f32_16x16x32_bf16 v[60:63], a[184:187], a[108:111], v[60:63]
    ds_read_u16_d16_hi v169, v216 offset:128
    s_waitcnt vmcnt(18)
    v_mfma_f32_16x16x32_bf16 v[48:51], a[188:191], a[112:115], v[48:51]
    buffer_load_dwordx4 a[184:187], v3, s[8:11], s16 offen offset:2048
    v_mfma_f32_16x16x32_bf16 v[52:55], a[188:191], a[116:119], v[52:55]
    ds_read_u16_d16_hi v170, v217 offset:256
    v_mfma_f32_16x16x32_bf16 v[56:59], a[188:191], a[120:123], v[56:59]
    ds_read_u16_d16_hi v171, v217 offset:384
    v_mfma_f32_16x16x32_bf16 v[60:63], a[188:191], a[124:127], v[60:63]
    ds_read_u16_d16_hi v172, v216 offset:512
    s_waitcnt vmcnt(18)
    v_mfma_f32_16x16x32_bf16 v[48:51], a[192:195], a[128:131], v[48:51]
    buffer_load_dwordx4 a[188:191], v3, s[8:11], s16 offen offset:3072
    v_mfma_f32_16x16x32_bf16 v[52:55], a[192:195], a[132:135], v[52:55]
    ds_read_u16_d16_hi v173, v216 offset:640
    v_mfma_f32_16x16x32_bf16 v[56:59], a[192:195], a[136:139], v[56:59]
    ds_read_u16_d16_hi v174, v217 offset:768
    v_mfma_f32_16x16x32_bf16 v[60:63], a[192:195], a[140:143], v[60:63]
    ds_read_u16_d16_hi v175, v217 offset:896
    s_waitcnt vmcnt(18)
    v_mfma_f32_16x16x32_bf16 v[48:51], a[196:199], a[144:147], v[48:51]
    buffer_load_dwordx4 a[192:195], v4, s[8:11], s16 offen offset:0
    s_add_u32 s16, s16, 9216
    v_mfma_f32_16x16x32_bf16 v[52:55], a[196:199], a[148:151], v[52:55]
    ds_read_u16_d16_hi v176, v218 offset:0
    v_mfma_f32_16x16x32_bf16 v[56:59], a[196:199], a[152:155], v[56:59]
    ds_read_u16_d16_hi v177, v218 offset:128
    v_mfma_f32_16x16x32_bf16 v[60:63], a[196:199], a[156:159], v[60:63]
    ds_read_u16_d16_hi v178, v219 offset:256
    s_waitcnt vmcnt(18)
    v_mfma_f32_16x16x32_bf16 v[48:51], a[200:203], a[232:235], v[48:51]
    buffer_load_dwordx4 a[196:199], v2, s[8:11], s16 offen offset:0
    v_mfma_f32_16x16x32_bf16 v[52:55], a[200:203], a[236:239], v[52:55]
    ds_read_u16_d16_hi v179, v219 offset:384
    v_mfma_f32_16x16x32_bf16 v[56:59], a[200:203], a[240:243], v[56:59]
    ds_read_u16_d16_hi v180, v218 offset:512
    v_mfma_f32_16x16x32_bf16 v[60:63], a[200:203], a[244:247], v[60:63]
    ds_read_u16_d16_hi v181, v218 offset:640
    s_waitcnt vmcnt(18)
    v_mfma_f32_16x16x32_bf16 v[48:51], a[204:207], a[248:251], v[48:51]
    buffer_load_dwordx4 a[200:203], v2, s[8:11], s16 offen offset:1024
    v_mfma_f32_16x16x32_bf16 v[52:55], a[204:207], a[252:255], v[52:55]
    ds_read_u16_d16_hi v182, v219 offset:768
    v_mfma_f32_16x16x32_bf16 v[56:59], a[204:207], v[64:67], v[56:59]
    ds_read_u16_d16_hi v183, v219 offset:896
    v_mfma_f32_16x16x32_bf16 v[60:63], a[204:207], v[68:71], v[60:63]
    ds_read_u16_d16_hi v184, v220 offset:0
    s_waitcnt vmcnt(18)
    v_mfma_f32_16x16x32_bf16 v[48:51], a[208:211], v[72:75], v[48:51]
    buffer_load_dwordx4 a[204:207], v2, s[8:11], s16 offen offset:2048
    v_mfma_f32_16x16x32_bf16 v[52:55], a[208:211], v[76:79], v[52:55]
    ds_read_u16_d16_hi v185, v220 offset:128
    v_mfma_f32_16x16x32_bf16 v[56:59], a[208:211], v[80:83], v[56:59]
    ds_read_u16_d16_hi v186, v221 offset:256
    v_mfma_f32_16x16x32_bf16 v[60:63], a[208:211], v[84:87], v[60:63]
    ds_read_u16_d16_hi v187, v221 offset:384
    s_waitcnt vmcnt(18)
    v_mfma_f32_16x16x32_bf16 v[48:51], a[212:215], v[88:91], v[48:51]
    buffer_load_dwordx4 a[208:211], v2, s[8:11], s16 offen offset:3072
    v_mfma_f32_16x16x32_bf16 v[52:55], a[212:215], v[92:95], v[52:55]
    ds_read_u16_d16_hi v188, v220 offset:512
    v_mfma_f32_16x16x32_bf16 v[56:59], a[212:215], v[96:99], v[56:59]
    ds_read_u16_d16_hi v189, v220 offset:640
    v_mfma_f32_16x16x32_bf16 v[60:63], a[212:215], v[100:103], v[60:63]
    ds_read_u16_d16_hi v190, v221 offset:768
    s_waitcnt vmcnt(18)
    v_mfma_f32_16x16x32_bf16 v[48:51], a[216:219], v[104:107], v[48:51]
    buffer_load_dwordx4 a[212:215], v3, s[8:11], s16 offen offset:0
    v_mfma_f32_16x16x32_bf16 v[52:55], a[216:219], v[108:111], v[52:55]
    ds_read_u16_d16_hi v191, v221 offset:896
    v_mfma_f32_16x16x32_bf16 v[56:59], a[216:219], v[112:115], v[56:59]
    v_and_b32 v8, 1, v0
    v_mfma_f32_16x16x32_bf16 v[60:63], a[216:219], v[116:119], v[60:63]
    v_lshlrev_b32 v8, 4, v8
    s_waitcnt vmcnt(18)
    v_mfma_f32_16x16x32_bf16 v[48:51], a[220:223], v[120:123], v[48:51]
    buffer_load_dwordx4 a[216:219], v3, s[8:11], s16 offen offset:1024
    v_mfma_f32_16x16x32_bf16 v[52:55], a[220:223], v[124:127], v[52:55]
    v_mov_b32 v9, 0x3f80
    v_mfma_f32_16x16x32_bf16 v[56:59], a[220:223], v[128:131], v[56:59]
    v_lshlrev_b32 v8, v8, v9
    v_mfma_f32_16x16x32_bf16 v[60:63], a[220:223], v[132:135], v[60:63]
    v_bfe_u32 v9, v0, 1, 3
    s_waitcnt vmcnt(18)
    v_mfma_f32_16x16x32_bf16 v[48:51], a[224:227], v[136:139], v[48:51]
    buffer_load_dwordx4 a[220:223], v3, s[8:11], s16 offen offset:2048
    v_mfma_f32_16x16x32_bf16 v[52:55], a[224:227], v[140:143], v[52:55]
    v_lshlrev_b32 v17, 1, v10
    v_mfma_f32_16x16x32_bf16 v[56:59], a[224:227], v[144:147], v[56:59]
    v_sub_u32 v9, v9, v17
    v_mfma_f32_16x16x32_bf16 v[60:63], a[224:227], v[148:151], v[60:63]
    v_cmp_eq_u32 vcc, 0, v9
    s_waitcnt vmcnt(18)
    v_mfma_f32_16x16x32_bf16 v[48:51], a[228:231], v[152:155], v[48:51]
    buffer_load_dwordx4 a[224:227], v3, s[8:11], s16 offen offset:3072
    v_mfma_f32_16x16x32_bf16 v[52:55], a[228:231], v[156:159], v[52:55]
    v_cmp_eq_u32 s[58:59], 1, v9
    v_mfma_f32_16x16x32_bf16 v[56:59], a[228:231], v[160:163], v[56:59]
    v_mov_b32 v26, 0
    v_mfma_f32_16x16x32_bf16 v[60:63], a[228:231], v[164:167], v[60:63]
    v_mov_b32 v27, 0
    s_waitcnt vmcnt(18)
    v_mfma_f32_16x16x32_bf16 v[32:35], a[160:163], a[0:3], 0
    buffer_load_dwordx4 a[228:231], v4, s[8:11], s16 offen offset:0
    s_add_u32 s16, s16, 9216
    s_cmp_eq_u32 s16, 340992
    s_cselect_b32 s16, 175104, s16
    v_mfma_f32_16x16x32_bf16 v[36:39], a[160:163], a[4:7], 0
    v_mfma_f32_16x16x32_bf16 v[40:43], a[160:163], a[8:11], 0
    v_mfma_f32_16x16x32_bf16 v[44:47], a[160:163], a[12:15], 0
    v_cvt_pk_bf16_f32 v244, v48, v49
    s_waitcnt vmcnt(18)
    v_mfma_f32_16x16x32_bf16 v[32:35], a[164:167], a[16:19], v[32:35]
    buffer_load_dwordx4 a[160:163], v2, s[8:11], s16 offen offset:0
    v_mfma_f32_16x16x32_bf16 v[36:39], a[164:167], a[20:23], v[36:39]
    v_cvt_pk_bf16_f32 v245, v50, v51
    v_mfma_f32_16x16x32_bf16 v[40:43], a[164:167], a[24:27], v[40:43]
    v_cvt_pk_bf16_f32 v246, v52, v53
    v_mfma_f32_16x16x32_bf16 v[44:47], a[164:167], a[28:31], v[44:47]
    v_cvt_pk_bf16_f32 v247, v54, v55
    s_waitcnt vmcnt(17)
    v_mfma_f32_16x16x32_bf16 v[32:35], a[168:171], a[32:35], v[32:35]
    buffer_load_dwordx4 a[164:167], v2, s[8:11], s16 offen offset:1024
    v_mfma_f32_16x16x32_bf16 v[36:39], a[168:171], a[36:39], v[36:39]
    buffer_store_dwordx4 v[244:247], v20, s[12:15], s31 offen offset:0 sc1
    v_mfma_f32_16x16x32_bf16 v[40:43], a[168:171], a[40:43], v[40:43]
    v_cvt_pk_bf16_f32 v248, v56, v57
    v_mfma_f32_16x16x32_bf16 v[44:47], a[168:171], a[44:47], v[44:47]
    v_cvt_pk_bf16_f32 v249, v58, v59
    s_waitcnt vmcnt(17)
    v_mfma_f32_16x16x32_bf16 v[32:35], a[172:175], a[48:51], v[32:35]
    buffer_load_dwordx4 a[168:171], v2, s[8:11], s16 offen offset:2048
    v_mfma_f32_16x16x32_bf16 v[36:39], a[172:175], a[52:55], v[36:39]
    v_cvt_pk_bf16_f32 v250, v60, v61
    v_mfma_f32_16x16x32_bf16 v[40:43], a[172:175], a[56:59], v[40:43]
    v_cvt_pk_bf16_f32 v251, v62, v63
    v_mfma_f32_16x16x32_bf16 v[44:47], a[172:175], a[60:63], v[44:47]
    buffer_store_dwordx4 v[248:251], v20, s[12:15], s31 offen offset:1024 sc1
    s_add_u32 s31, s31, 8192
    s_cmp_eq_u32 s31, s42
    s_cselect_b32 s31, s41, s31
    s_waitcnt vmcnt(18)
    v_mfma_f32_16x16x32_bf16 v[32:35], a[176:179], a[64:67], v[32:35]
    buffer_load_dwordx4 a[172:175], v2, s[8:11], s16 offen offset:3072
    v_mfma_f32_16x16x32_bf16 v[36:39], a[176:179], a[68:71], v[36:39]
    v_mov_b32 v28, 0
    v_mfma_f32_16x16x32_bf16 v[40:43], a[176:179], a[72:75], v[40:43]
    v_mov_b32 v29, 0
    v_mfma_f32_16x16x32_bf16 v[44:47], a[176:179], a[76:79], v[44:47]
    v_cndmask_b32 v24, 0, v8, vcc
    s_waitcnt vmcnt(18)
    v_mfma_f32_16x16x32_bf16 v[32:35], a[180:183], a[80:83], v[32:35]
    buffer_load_dwordx4 a[176:179], v3, s[8:11], s16 offen offset:0
    v_mfma_f32_16x16x32_bf16 v[36:39], a[180:183], a[84:87], v[36:39]
    v_cndmask_b32 v25, 0, v8, s[58:59]
    v_mfma_f32_16x16x32_bf16 v[40:43], a[180:183], a[88:91], v[40:43]
    v_cndmask_b32 v30, 0, v8, vcc
    v_mfma_f32_16x16x32_bf16 v[44:47], a[180:183], a[92:95], v[44:47]
    v_cndmask_b32 v31, 0, v8, s[58:59]
    s_waitcnt vmcnt(18)
    v_mfma_f32_16x16x32_bf16 v[32:35], a[184:187], a[96:99], v[32:35]
    buffer_load_dwordx4 a[180:183], v3, s[8:11], s16 offen offset:1024
    v_mfma_f32_16x16x32_bf16 v[36:39], a[184:187], a[100:103], v[36:39]
    s_min_u32 s62, s6, 1
    v_mfma_f32_16x16x32_bf16 v[40:43], a[184:187], a[104:107], v[40:43]
    s_mul_i32 s62, s62, 0x70000000
    v_mfma_f32_16x16x32_bf16 v[44:47], a[184:187], a[108:111], v[44:47]
    v_add_u32 v240, s62, v14
    s_waitcnt vmcnt(18)
    v_mfma_f32_16x16x32_bf16 v[32:35], a[188:191], a[112:115], v[32:35]
    buffer_load_dwordx4 a[184:187], v3, s[8:11], s16 offen offset:2048
    v_mfma_f32_16x16x32_bf16 v[36:39], a[188:191], a[116:119], v[36:39]
    v_add_u32 v241, s62, v15
    v_mfma_f32_16x16x32_bf16 v[40:43], a[188:191], a[120:123], v[40:43]
    v_lshl_add_u32 v242, v0, 24, s62
    v_mfma_f32_16x16x32_bf16 v[44:47], a[188:191], a[124:127], v[44:47]
    v_mov_b32 v243, s7
    s_waitcnt vmcnt(18)
    v_mfma_f32_16x16x32_bf16 v[32:35], a[192:195], a[128:131], v[32:35]
    buffer_load_dwordx4 a[188:191], v3, s[8:11], s16 offen offset:3072
    v_mfma_f32_16x16x32_bf16 v[36:39], a[192:195], a[132:135], v[36:39]
    s_mov_b32 s22, 0x1000000
    v_mfma_f32_16x16x32_bf16 v[40:43], a[192:195], a[136:139], v[40:43]
    s_mov_b32 s23, s15
    v_mfma_f32_16x16x32_bf16 v[44:47], a[192:195], a[140:143], v[44:47]
    s_mov_b32 s21, s13
    s_waitcnt vmcnt(18)
    v_mfma_f32_16x16x32_bf16 v[32:35], a[196:199], a[144:147], v[32:35]
    buffer_load_dwordx4 a[192:195], v4, s[8:11], s16 offen offset:0
    s_add_u32 s16, s16, 9216
    v_mfma_f32_16x16x32_bf16 v[36:39], a[196:199], a[148:151], v[36:39]
    s_mov_b32 s20, s12
    v_mfma_f32_16x16x32_bf16 v[40:43], a[196:199], a[152:155], v[40:43]
    buffer_load_dwordx4 v[192:195], v16, s[12:15], s32 offen offset:0
    v_mfma_f32_16x16x32_bf16 v[44:47], a[196:199], a[156:159], v[44:47]
    buffer_load_dwordx4 v[196:199], v16, s[12:15], s32 offen offset:16
    s_waitcnt vmcnt(20)
    v_mfma_f32_16x16x32_bf16 v[32:35], a[200:203], a[232:235], v[32:35]
    buffer_load_dwordx4 a[196:199], v2, s[8:11], s16 offen offset:0
    v_mfma_f32_16x16x32_bf16 v[36:39], a[200:203], a[236:239], v[36:39]
    buffer_load_dwordx4 v[200:203], v16, s[12:15], s33 offen offset:0
    v_mfma_f32_16x16x32_bf16 v[40:43], a[200:203], a[240:243], v[40:43]
    buffer_load_dwordx4 v[204:207], v16, s[12:15], s33 offen offset:16
    v_mfma_f32_16x16x32_bf16 v[44:47], a[200:203], a[244:247], v[44:47]
    buffer_load_dwordx4 v[208:211], v16, s[12:15], s34 offen offset:0
    s_waitcnt vmcnt(23)
    v_mfma_f32_16x16x32_bf16 v[32:35], a[204:207], a[248:251], v[32:35]
    buffer_load_dwordx4 a[200:203], v2, s[8:11], s16 offen offset:1024
    v_mfma_f32_16x16x32_bf16 v[36:39], a[204:207], a[252:255], v[36:39]
    buffer_load_dwordx4 v[212:215], v16, s[12:15], s34 offen offset:16
    v_mfma_f32_16x16x32_bf16 v[40:43], a[204:207], v[64:67], v[40:43]
    v_mfma_f32_16x16x32_bf16 v[44:47], a[204:207], v[68:71], v[44:47]
    s_waitcnt vmcnt(24)
    v_mfma_f32_16x16x32_bf16 v[32:35], a[208:211], v[72:75], v[32:35]
    buffer_load_dwordx4 a[204:207], v2, s[8:11], s16 offen offset:2048
    v_mfma_f32_16x16x32_bf16 v[36:39], a[208:211], v[76:79], v[36:39]
    v_mfma_f32_16x16x32_bf16 v[40:43], a[208:211], v[80:83], v[40:43]
    v_mfma_f32_16x16x32_bf16 v[44:47], a[208:211], v[84:87], v[44:47]
    s_waitcnt vmcnt(24)
    v_mfma_f32_16x16x32_bf16 v[32:35], a[212:215], v[88:91], v[32:35]
    buffer_load_dwordx4 a[208:211], v2, s[8:11], s16 offen offset:3072
    v_mfma_f32_16x16x32_bf16 v[36:39], a[212:215], v[92:95], v[36:39]
    v_mfma_f32_16x16x32_bf16 v[40:43], a[212:215], v[96:99], v[40:43]
    v_mfma_f32_16x16x32_bf16 v[44:47], a[212:215], v[100:103], v[44:47]
    s_waitcnt vmcnt(24)
    v_mfma_f32_16x16x32_bf16 v[32:35], a[216:219], v[104:107], v[32:35]
    buffer_load_dwordx4 a[212:215], v3, s[8:11], s16 offen offset:0
    v_mfma_f32_16x16x32_bf16 v[36:39], a[216:219], v[108:111], v[36:39]
    v_mfma_f32_16x16x32_bf16 v[40:43], a[216:219], v[112:115], v[40:43]
    v_mfma_f32_16x16x32_bf16 v[44:47], a[216:219], v[116:119], v[44:47]
    s_waitcnt vmcnt(24)
    v_mfma_f32_16x16x32_bf16 v[32:35], a[220:223], v[120:123], v[32:35]
    buffer_load_dwordx4 a[216:219], v3, s[8:11], s16 offen offset:1024
    v_mfma_f32_16x16x32_bf16 v[36:39], a[220:223], v[124:127], v[36:39]
    v_mfma_f32_16x16x32_bf16 v[40:43], a[220:223], v[128:131], v[40:43]
    v_mfma_f32_16x16x32_bf16 v[44:47], a[220:223], v[132:135], v[44:47]
    s_waitcnt vmcnt(24)
    v_mfma_f32_16x16x32_bf16 v[32:35], a[224:227], v[136:139], v[32:35]
    buffer_load_dwordx4 a[220:223], v3, s[8:11], s16 offen offset:2048
    v_mfma_f32_16x16x32_bf16 v[36:39], a[224:227], v[140:143], v[36:39]
    v_mfma_f32_16x16x32_bf16 v[40:43], a[224:227], v[144:147], v[40:43]
    v_mfma_f32_16x16x32_bf16 v[44:47], a[224:227], v[148:151], v[44:47]
    s_waitcnt vmcnt(24)
    v_mfma_f32_16x16x32_bf16 v[32:35], a[228:231], v[152:155], v[32:35]
    buffer_load_dwordx4 a[224:227], v3, s[8:11], s16 offen offset:3072
    v_mfma_f32_16x16x32_bf16 v[36:39], a[228:231], v[156:159], v[36:39]
    v_mfma_f32_16x16x32_bf16 v[40:43], a[228:231], v[160:163], v[40:43]
    v_mfma_f32_16x16x32_bf16 v[44:47], a[228:231], v[164:167], v[44:47]
    s_waitcnt vmcnt(24)
    v_mfma_f32_16x16x32_bf16 v[48:51], a[160:163], a[0:3], 0
    buffer_load_dwordx4 a[228:231], v4, s[8:11], s16 offen offset:0
    s_add_u32 s16, s16, 9216
    s_cmp_eq_u32 s16, 340992
    s_cselect_b32 s16, 175104, s16
    v_mfma_f32_16x16x32_bf16 v[52:55], a[160:163], a[4:7], 0
    v_mfma_f32_16x16x32_bf16 v[56:59], a[160:163], a[8:11], 0
    v_mfma_f32_16x16x32_bf16 v[60:63], a[160:163], a[12:15], 0
    v_cvt_pk_bf16_f32 v244, v32, v33
    s_waitcnt vmcnt(24)
    v_mfma_f32_16x16x32_bf16 v[48:51], a[164:167], a[16:19], v[48:51]
    buffer_load_dwordx4 a[160:163], v2, s[8:11], s16 offen offset:0
    v_mfma_f32_16x16x32_bf16 v[52:55], a[164:167], a[20:23], v[52:55]
    v_cvt_pk_bf16_f32 v245, v34, v35
    v_mfma_f32_16x16x32_bf16 v[56:59], a[164:167], a[24:27], v[56:59]
    v_cvt_pk_bf16_f32 v246, v36, v37
    v_mfma_f32_16x16x32_bf16 v[60:63], a[164:167], a[28:31], v[60:63]
    v_cvt_pk_bf16_f32 v247, v38, v39
    s_waitcnt vmcnt(23)
    v_mfma_f32_16x16x32_bf16 v[48:51], a[168:171], a[32:35], v[48:51]
    buffer_load_dwordx4 a[164:167], v2, s[8:11], s16 offen offset:1024
    v_mfma_f32_16x16x32_bf16 v[52:55], a[168:171], a[36:39], v[52:55]
    buffer_store_dwordx4 v[244:247], v20, s[12:15], s31 offen offset:0 sc1
    v_mfma_f32_16x16x32_bf16 v[56:59], a[168:171], a[40:43], v[56:59]
    v_cvt_pk_bf16_f32 v248, v40, v41
    v_mfma_f32_16x16x32_bf16 v[60:63], a[168:171], a[44:47], v[60:63]
    v_cvt_pk_bf16_f32 v249, v42, v43
    s_waitcnt vmcnt(23)
    v_mfma_f32_16x16x32_bf16 v[48:51], a[172:175], a[48:51], v[48:51]
    buffer_load_dwordx4 a[168:171], v2, s[8:11], s16 offen offset:2048
    v_mfma_f32_16x16x32_bf16 v[52:55], a[172:175], a[52:55], v[52:55]
    v_cvt_pk_bf16_f32 v250, v44, v45
    v_mfma_f32_16x16x32_bf16 v[56:59], a[172:175], a[56:59], v[56:59]
    v_cvt_pk_bf16_f32 v251, v46, v47
    v_mfma_f32_16x16x32_bf16 v[60:63], a[172:175], a[60:63], v[60:63]
    buffer_store_dwordx4 v[248:251], v20, s[12:15], s31 offen offset:1024 sc1
    s_add_u32 s31, s31, 8192
    s_cmp_eq_u32 s31, s42
    s_cselect_b32 s31, s41, s31
    s_waitcnt vmcnt(24)
    v_mfma_f32_16x16x32_bf16 v[48:51], a[176:179], a[64:67], v[48:51]
    buffer_load_dwordx4 a[172:175], v2, s[8:11], s16 offen offset:3072
    v_mfma_f32_16x16x32_bf16 v[52:55], a[176:179], a[68:71], v[52:55]
    v_mfma_f32_16x16x32_bf16 v[56:59], a[176:179], a[72:75], v[56:59]
    v_mfma_f32_16x16x32_bf16 v[60:63], a[176:179], a[76:79], v[60:63]
    s_waitcnt vmcnt(24)
    v_mfma_f32_16x16x32_bf16 v[48:51], a[180:183], a[80:83], v[48:51]
    buffer_load_dwordx4 a[176:179], v3, s[8:11], s16 offen offset:0
    v_mfma_f32_16x16x32_bf16 v[52:55], a[180:183], a[84:87], v[52:55]
    v_mfma_f32_16x16x32_bf16 v[56:59], a[180:183], a[88:91], v[56:59]
    v_mfma_f32_16x16x32_bf16 v[60:63], a[180:183], a[92:95], v[60:63]
    s_waitcnt vmcnt(24)
    v_mfma_f32_16x16x32_bf16 v[48:51], a[184:187], a[96:99], v[48:51]
    buffer_load_dwordx4 a[180:183], v3, s[8:11], s16 offen offset:1024
    v_mfma_f32_16x16x32_bf16 v[52:55], a[184:187], a[100:103], v[52:55]
    v_mfma_f32_16x16x32_bf16 v[56:59], a[184:187], a[104:107], v[56:59]
    v_mfma_f32_16x16x32_bf16 v[60:63], a[184:187], a[108:111], v[60:63]
    s_waitcnt vmcnt(24)
    v_mfma_f32_16x16x32_bf16 v[48:51], a[188:191], a[112:115], v[48:51]
    buffer_load_dwordx4 a[184:187], v3, s[8:11], s16 offen offset:2048
    v_mfma_f32_16x16x32_bf16 v[52:55], a[188:191], a[116:119], v[52:55]
    v_mfma_f32_16x16x32_bf16 v[56:59], a[188:191], a[120:123], v[56:59]
    v_mfma_f32_16x16x32_bf16 v[60:63], a[188:191], a[124:127], v[60:63]
    s_waitcnt vmcnt(24)
    v_mfma_f32_16x16x32_bf16 v[48:51], a[192:195], a[128:131], v[48:51]
    buffer_load_dwordx4 a[188:191], v3, s[8:11], s16 offen offset:3072
    v_mfma_f32_16x16x32_bf16 v[52:55], a[192:195], a[132:135], v[52:55]
    v_mfma_f32_16x16x32_bf16 v[56:59], a[192:195], a[136:139], v[56:59]
    v_mfma_f32_16x16x32_bf16 v[60:63], a[192:195], a[140:143], v[60:63]
    s_waitcnt vmcnt(22)
    v_mfma_f32_16x16x32_bf16 v[48:51], a[196:199], a[144:147], v[48:51]
    buffer_load_dwordx4 a[192:195], v4, s[8:11], s16 offen offset:0
    s_add_u32 s16, s16, 9216
    v_mfma_f32_16x16x32_bf16 v[52:55], a[196:199], a[148:151], v[52:55]
    v_mfma_f32_16x16x32_bf16 v[56:59], a[196:199], a[152:155], v[56:59]
    v_mfma_f32_16x16x32_bf16 v[60:63], a[196:199], a[156:159], v[60:63]
    s_waitcnt vmcnt(19)
    v_mfma_f32_16x16x32_bf16 v[48:51], a[200:203], a[232:235], v[48:51]
    buffer_load_dwordx4 a[196:199], v2, s[8:11], s16 offen offset:0
    v_mfma_f32_16x16x32_bf16 v[52:55], a[200:203], a[236:239], v[52:55]
    v_mfma_f32_16x16x32_bf16 v[56:59], a[200:203], a[240:243], v[56:59]
    v_mfma_f32_16x16x32_bf16 v[60:63], a[200:203], a[244:247], v[60:63]
    s_waitcnt vmcnt(18)
    v_mfma_f32_16x16x32_bf16 v[48:51], a[204:207], a[248:251], v[48:51]
    buffer_load_dwordx4 a[200:203], v2, s[8:11], s16 offen offset:1024
    v_mfma_f32_16x16x32_bf16 v[52:55], a[204:207], a[252:255], v[52:55]
    v_mfma_f32_16x16x32_bf16 v[56:59], a[204:207], v[64:67], v[56:59]
    v_mfma_f32_16x16x32_bf16 v[60:63], a[204:207], v[68:71], v[60:63]
    s_waitcnt vmcnt(18)
    v_mfma_f32_16x16x32_bf16 v[48:51], a[208:211], v[72:75], v[48:51]
    buffer_load_dwordx4 a[204:207], v2, s[8:11], s16 offen offset:2048
    v_mfma_f32_16x16x32_bf16 v[52:55], a[208:211], v[76:79], v[52:55]
    v_mfma_f32_16x16x32_bf16 v[56:59], a[208:211], v[80:83], v[56:59]
    v_mfma_f32_16x16x32_bf16 v[60:63], a[208:211], v[84:87], v[60:63]
    s_waitcnt vmcnt(18)
    v_mfma_f32_16x16x32_bf16 v[48:51], a[212:215], v[88:91], v[48:51]
    buffer_load_dwordx4 a[208:211], v2, s[8:11], s16 offen offset:3072
    v_mfma_f32_16x16x32_bf16 v[52:55], a[212:215], v[92:95], v[52:55]
    v_mfma_f32_16x16x32_bf16 v[56:59], a[212:215], v[96:99], v[56:59]
    v_mfma_f32_16x16x32_bf16 v[60:63], a[212:215], v[100:103], v[60:63]
    s_waitcnt vmcnt(18)
    v_mfma_f32_16x16x32_bf16 v[48:51], a[216:219], v[104:107], v[48:51]
    buffer_load_dwordx4 a[212:215], v3, s[8:11], s16 offen offset:0
    v_mfma_f32_16x16x32_bf16 v[52:55], a[216:219], v[108:111], v[52:55]
    v_mfma_f32_16x16x32_bf16 v[56:59], a[216:219], v[112:115], v[56:59]
    v_mfma_f32_16x16x32_bf16 v[60:63], a[216:219], v[116:119], v[60:63]
    s_waitcnt vmcnt(18)
    v_mfma_f32_16x16x32_bf16 v[48:51], a[220:223], v[120:123], v[48:51]
    buffer_load_dwordx4 a[216:219], v3, s[8:11], s16 offen offset:1024
    v_mfma_f32_16x16x32_bf16 v[52:55], a[220:223], v[124:127], v[52:55]
    v_mfma_f32_16x16x32_bf16 v[56:59], a[220:223], v[128:131], v[56:59]
    v_mfma_f32_16x16x32_bf16 v[60:63], a[220:223], v[132:135], v[60:63]
    s_waitcnt vmcnt(18)
    v_mfma_f32_16x16x32_bf16 v[48:51], a[224:227], v[136:139], v[48:51]
    buffer_load_dwordx4 a[220:223], v3, s[8:11], s16 offen offset:2048
    v_mfma_f32_16x16x32_bf16 v[52:55], a[224:227], v[140:143], v[52:55]
    v_mfma_f32_16x16x32_bf16 v[56:59], a[224:227], v[144:147], v[56:59]
    v_mfma_f32_16x16x32_bf16 v[60:63], a[224:227], v[148:151], v[60:63]
    s_waitcnt vmcnt(18)
    v_mfma_f32_16x16x32_bf16 v[48:51], a[228:231], v[152:155], v[48:51]
    buffer_load_dwordx4 a[224:227], v3, s[8:11], s16 offen offset:3072
    v_mfma_f32_16x16x32_bf16 v[52:55], a[228:231], v[156:159], v[52:55]
    v_mfma_f32_16x16x32_bf16 v[56:59], a[228:231], v[160:163], v[56:59]
    v_mfma_f32_16x16x32_bf16 v[60:63], a[228:231], v[164:167], v[60:63]
    s_waitcnt lgkmcnt(0)
    s_waitcnt vmcnt(18)
    v_mfma_f32_16x16x32_bf16 v[32:35], a[160:163], a[0:3], 0
    buffer_load_dwordx4 a[228:231], v4, s[8:11], s16 offen offset:0
    s_add_u32 s16, s16, 9216
    s_cmp_eq_u32 s16, 340992
    s_cselect_b32 s16, 175104, s16
    v_mfma_f32_16x16x32_bf16 v[36:39], a[160:163], a[4:7], 0
    v_mfma_f32_16x16x32_bf16 v[40:43], a[160:163], a[8:11], 0
    v_mfma_f32_16x16x32_bf16 v[44:47], a[160:163], a[12:15], 0
    v_cvt_pk_bf16_f32 v244, v48, v49
    s_waitcnt vmcnt(18)
    v_mfma_f32_16x16x32_bf16 v[32:35], a[164:167], a[16:19], v[32:35]
    buffer_load_dwordx4 a[160:163], v2, s[8:11], s16 offen offset:0
    v_mfma_f32_16x16x32_bf16 v[36:39], a[164:167], a[20:23], v[36:39]
    v_cvt_pk_bf16_f32 v245, v50, v51
    v_mfma_f32_16x16x32_bf16 v[40:43], a[164:167], a[24:27], v[40:43]
    v_cvt_pk_bf16_f32 v246, v52, v53
    v_mfma_f32_16x16x32_bf16 v[44:47], a[164:167], a[28:31], v[44:47]
    v_cvt_pk_bf16_f32 v247, v54, v55
    s_waitcnt vmcnt(17)
    v_mfma_f32_16x16x32_bf16 v[32:35], a[168:171], a[32:35], v[32:35]
    buffer_load_dwordx4 a[164:167], v2, s[8:11], s16 offen offset:1024
    v_mfma_f32_16x16x32_bf16 v[36:39], a[168:171], a[36:39], v[36:39]
    buffer_store_dwordx4 v[244:247], v20, s[12:15], s31 offen offset:0 sc1
    v_mfma_f32_16x16x32_bf16 v[40:43], a[168:171], a[40:43], v[40:43]
    v_cvt_pk_bf16_f32 v248, v56, v57
    v_mfma_f32_16x16x32_bf16 v[44:47], a[168:171], a[44:47], v[44:47]
    v_cvt_pk_bf16_f32 v249, v58, v59
    s_waitcnt vmcnt(17)
    v_mfma_f32_16x16x32_bf16 v[32:35], a[172:175], a[48:51], v[32:35]
    buffer_load_dwordx4 a[168:171], v2, s[8:11], s16 offen offset:2048
    v_mfma_f32_16x16x32_bf16 v[36:39], a[172:175], a[52:55], v[36:39]
    v_cvt_pk_bf16_f32 v250, v60, v61
    v_mfma_f32_16x16x32_bf16 v[40:43], a[172:175], a[56:59], v[40:43]
    v_cvt_pk_bf16_f32 v251, v62, v63
    v_mfma_f32_16x16x32_bf16 v[44:47], a[172:175], a[60:63], v[44:47]
    buffer_store_dwordx4 v[248:251], v20, s[12:15], s31 offen offset:1024 sc1
    s_add_u32 s31, s31, 8192
    s_cmp_eq_u32 s31, s42
    s_cselect_b32 s31, s41, s31
    s_waitcnt vmcnt(18)
    v_mfma_f32_16x16x32_bf16 v[32:35], a[176:179], a[64:67], v[32:35]
    buffer_load_dwordx4 a[172:175], v2, s[8:11], s16 offen offset:3072
    v_mfma_f32_16x16x32_bf16 v[36:39], a[176:179], a[68:71], v[36:39]
    v_mfma_f32_16x16x32_bf16 v[40:43], a[176:179], a[72:75], v[40:43]
    v_mfma_f32_16x16x32_bf16 v[44:47], a[176:179], a[76:79], v[44:47]
    s_waitcnt vmcnt(18)
    v_mfma_f32_16x16x32_bf16 v[32:35], a[180:183], a[80:83], v[32:35]
    buffer_load_dwordx4 a[176:179], v3, s[8:11], s16 offen offset:0
    v_mfma_f32_16x16x32_bf16 v[36:39], a[180:183], a[84:87], v[36:39]
    v_mfma_f32_16x16x32_bf16 v[40:43], a[180:183], a[88:91], v[40:43]
    v_mfma_f32_16x16x32_bf16 v[44:47], a[180:183], a[92:95], v[44:47]
    s_waitcnt vmcnt(18)
    v_mfma_f32_16x16x32_bf16 v[32:35], a[184:187], a[96:99], v[32:35]
    buffer_load_dwordx4 a[180:183], v3, s[8:11], s16 offen offset:1024
    v_mfma_f32_16x16x32_bf16 v[36:39], a[184:187], a[100:103], v[36:39]
    v_mfma_f32_16x16x32_bf16 v[40:43], a[184:187], a[104:107], v[40:43]
    v_mfma_f32_16x16x32_bf16 v[44:47], a[184:187], a[108:111], v[44:47]
    s_waitcnt vmcnt(18)
    v_mfma_f32_16x16x32_bf16 v[32:35], a[188:191], a[112:115], v[32:35]
    buffer_load_dwordx4 a[184:187], v3, s[8:11], s16 offen offset:2048
    v_mfma_f32_16x16x32_bf16 v[36:39], a[188:191], a[116:119], v[36:39]
    v_mfma_f32_16x16x32_bf16 v[40:43], a[188:191], a[120:123], v[40:43]
    v_mfma_f32_16x16x32_bf16 v[44:47], a[188:191], a[124:127], v[44:47]
    s_waitcnt vmcnt(18)
    v_mfma_f32_16x16x32_bf16 v[32:35], a[192:195], a[128:131], v[32:35]
    buffer_load_dwordx4 a[188:191], v3, s[8:11], s16 offen offset:3072
    v_mfma_f32_16x16x32_bf16 v[36:39], a[192:195], a[132:135], v[36:39]
    v_mfma_f32_16x16x32_bf16 v[40:43], a[192:195], a[136:139], v[40:43]
    v_mfma_f32_16x16x32_bf16 v[44:47], a[192:195], a[140:143], v[44:47]
    s_waitcnt vmcnt(18)
    v_mfma_f32_16x16x32_bf16 v[32:35], a[196:199], a[144:147], v[32:35]
    buffer_load_dwordx4 a[192:195], v4, s[8:11], s16 offen offset:0
    s_add_u32 s16, s16, 9216
    v_mfma_f32_16x16x32_bf16 v[36:39], a[196:199], a[148:151], v[36:39]
    v_mfma_f32_16x16x32_bf16 v[40:43], a[196:199], a[152:155], v[40:43]
    v_mfma_f32_16x16x32_bf16 v[44:47], a[196:199], a[156:159], v[44:47]
    s_waitcnt vmcnt(18)
    v_mfma_f32_16x16x32_bf16 v[32:35], a[200:203], a[232:235], v[32:35]
    buffer_load_dwordx4 a[196:199], v2, s[8:11], s16 offen offset:0
    v_mfma_f32_16x16x32_bf16 v[36:39], a[200:203], a[236:239], v[36:39]
    s_barrier
    buffer_store_dword v243, v242, s[20:23], s57 offen offset:0 sc1
    v_mfma_f32_16x16x32_bf16 v[40:43], a[200:203], a[240:243], v[40:43]
    v_rcp_f32 v23, v23
    v_mfma_f32_16x16x32_bf16 v[44:47], a[200:203], a[244:247], v[44:47]
    s_waitcnt vmcnt(19)
    v_mfma_f32_16x16x32_bf16 v[32:35], a[204:207], a[248:251], v[32:35]
    buffer_load_dwordx4 a[200:203], v2, s[8:11], s16 offen offset:1024
    v_mfma_f32_16x16x32_bf16 v[36:39], a[204:207], a[252:255], v[36:39]
    v_mfma_f32_16x16x32_bf16 v[40:43], a[204:207], v[64:67], v[40:43]
    v_mfma_f32_16x16x32_bf16 v[44:47], a[204:207], v[68:71], v[44:47]
    s_waitcnt vmcnt(19)
    v_mfma_f32_16x16x32_bf16 v[32:35], a[208:211], v[72:75], v[32:35]
    buffer_load_dwordx4 a[204:207], v2, s[8:11], s16 offen offset:2048
    v_mfma_f32_16x16x32_bf16 v[36:39], a[208:211], v[76:79], v[36:39]
    v_mfma_f32_16x16x32_bf16 v[40:43], a[208:211], v[80:83], v[40:43]
    v_mfma_f32_16x16x32_bf16 v[44:47], a[208:211], v[84:87], v[44:47]
    s_waitcnt vmcnt(19)
    v_mfma_f32_16x16x32_bf16 v[32:35], a[212:215], v[88:91], v[32:35]
    buffer_load_dwordx4 a[208:211], v2, s[8:11], s16 offen offset:3072
    v_mfma_f32_16x16x32_bf16 v[36:39], a[212:215], v[92:95], v[36:39]
    v_mfma_f32_16x16x32_bf16 v[40:43], a[212:215], v[96:99], v[40:43]
    v_mfma_f32_16x16x32_bf16 v[44:47], a[212:215], v[100:103], v[44:47]
    s_waitcnt vmcnt(19)
    v_mfma_f32_16x16x32_bf16 v[32:35], a[216:219], v[104:107], v[32:35]
    buffer_load_dwordx4 a[212:215], v3, s[8:11], s16 offen offset:0
    v_mfma_f32_16x16x32_bf16 v[36:39], a[216:219], v[108:111], v[36:39]
    v_mfma_f32_16x16x32_bf16 v[40:43], a[216:219], v[112:115], v[40:43]
    v_mfma_f32_16x16x32_bf16 v[44:47], a[216:219], v[116:119], v[44:47]
    s_waitcnt vmcnt(19)
    v_mfma_f32_16x16x32_bf16 v[32:35], a[220:223], v[120:123], v[32:35]
    buffer_load_dwordx4 a[216:219], v3, s[8:11], s16 offen offset:1024
    v_mfma_f32_16x16x32_bf16 v[36:39], a[220:223], v[124:127], v[36:39]
    v_mfma_f32_16x16x32_bf16 v[40:43], a[220:223], v[128:131], v[40:43]
    v_mfma_f32_16x16x32_bf16 v[44:47], a[220:223], v[132:135], v[44:47]
    s_waitcnt vmcnt(19)
    v_mfma_f32_16x16x32_bf16 v[32:35], a[224:227], v[136:139], v[32:35]
    buffer_load_dwordx4 a[220:223], v3, s[8:11], s16 offen offset:2048
    v_mfma_f32_16x16x32_bf16 v[36:39], a[224:227], v[140:143], v[36:39]
    v_mfma_f32_16x16x32_bf16 v[40:43], a[224:227], v[144:147], v[40:43]
    v_mfma_f32_16x16x32_bf16 v[44:47], a[224:227], v[148:151], v[44:47]
    s_waitcnt vmcnt(19)
    v_mfma_f32_16x16x32_bf16 v[32:35], a[228:231], v[152:155], v[32:35]
    buffer_load_dwordx4 a[224:227], v3, s[8:11], s16 offen offset:3072
    v_mfma_f32_16x16x32_bf16 v[36:39], a[228:231], v[156:159], v[36:39]
    v_mfma_f32_16x16x32_bf16 v[40:43], a[228:231], v[160:163], v[40:43]
    v_mfma_f32_16x16x32_bf16 v[44:47], a[228:231], v[164:167], v[44:47]
    s_waitcnt vmcnt(19)
    v_mfma_f32_16x16x32_bf16 v[48:51], a[160:163], a[0:3], 0
    buffer_load_dwordx4 a[228:231], v4, s[8:11], s16 offen offset:0
    s_add_u32 s16, s16, 9216
    s_cmp_eq_u32 s16, 340992
    s_cselect_b32 s16, 175104, s16
    v_mfma_f32_16x16x32_bf16 v[52:55], a[160:163], a[4:7], 0
    v_mfma_f32_16x16x32_bf16 v[56:59], a[160:163], a[8:11], 0
    v_mfma_f32_16x16x32_bf16 v[60:63], a[160:163], a[12:15], 0
    v_cvt_pk_bf16_f32 v244, v32, v33
    s_waitcnt vmcnt(19)
    v_mfma_f32_16x16x32_bf16 v[48:51], a[164:167], a[16:19], v[48:51]
    buffer_load_dwordx4 a[160:163], v2, s[8:11], s16 offen offset:0
    v_mfma_f32_16x16x32_bf16 v[52:55], a[164:167], a[20:23], v[52:55]
    v_cvt_pk_bf16_f32 v245, v34, v35
    v_mfma_f32_16x16x32_bf16 v[56:59], a[164:167], a[24:27], v[56:59]
    v_cvt_pk_bf16_f32 v246, v36, v37
    v_mfma_f32_16x16x32_bf16 v[60:63], a[164:167], a[28:31], v[60:63]
    v_cvt_pk_bf16_f32 v247, v38, v39
    s_waitcnt vmcnt(18)
    v_mfma_f32_16x16x32_bf16 v[48:51], a[168:171], a[32:35], v[48:51]
    buffer_load_dwordx4 a[164:167], v2, s[8:11], s16 offen offset:1024
    v_mfma_f32_16x16x32_bf16 v[52:55], a[168:171], a[36:39], v[52:55]
    buffer_store_dwordx4 v[244:247], v20, s[12:15], s31 offen offset:0 sc1
    v_mfma_f32_16x16x32_bf16 v[56:59], a[168:171], a[40:43], v[56:59]
    v_cvt_pk_bf16_f32 v248, v40, v41
    v_mfma_f32_16x16x32_bf16 v[60:63], a[168:171], a[44:47], v[60:63]
    v_cvt_pk_bf16_f32 v249, v42, v43
    s_waitcnt vmcnt(18)
    v_mfma_f32_16x16x32_bf16 v[48:51], a[172:175], a[48:51], v[48:51]
    buffer_load_dwordx4 a[168:171], v2, s[8:11], s16 offen offset:2048
    v_mfma_f32_16x16x32_bf16 v[52:55], a[172:175], a[52:55], v[52:55]
    v_cvt_pk_bf16_f32 v250, v44, v45
    v_mfma_f32_16x16x32_bf16 v[56:59], a[172:175], a[56:59], v[56:59]
    v_cvt_pk_bf16_f32 v251, v46, v47
    v_mfma_f32_16x16x32_bf16 v[60:63], a[172:175], a[60:63], v[60:63]
    buffer_store_dwordx4 v[248:251], v20, s[12:15], s31 offen offset:1024 sc1
    s_add_u32 s31, s31, 8192
    s_cmp_eq_u32 s31, s42
    s_cselect_b32 s31, s41, s31
    s_waitcnt vmcnt(19)
    v_mfma_f32_16x16x32_bf16 v[48:51], a[176:179], a[64:67], v[48:51]
    buffer_load_dwordx4 a[172:175], v2, s[8:11], s16 offen offset:3072
    v_mfma_f32_16x16x32_bf16 v[52:55], a[176:179], a[68:71], v[52:55]
    v_mfma_f32_16x16x32_bf16 v[56:59], a[176:179], a[72:75], v[56:59]
    v_mfma_f32_16x16x32_bf16 v[60:63], a[176:179], a[76:79], v[60:63]
    s_waitcnt vmcnt(19)
    v_mfma_f32_16x16x32_bf16 v[48:51], a[180:183], a[80:83], v[48:51]
    buffer_load_dwordx4 a[176:179], v3, s[8:11], s16 offen offset:0
    v_mfma_f32_16x16x32_bf16 v[52:55], a[180:183], a[84:87], v[52:55]
    v_mfma_f32_16x16x32_bf16 v[56:59], a[180:183], a[88:91], v[56:59]
    v_mfma_f32_16x16x32_bf16 v[60:63], a[180:183], a[92:95], v[60:63]
    s_waitcnt vmcnt(19)
    v_mfma_f32_16x16x32_bf16 v[48:51], a[184:187], a[96:99], v[48:51]
    buffer_load_dwordx4 a[180:183], v3, s[8:11], s16 offen offset:1024
    v_mfma_f32_16x16x32_bf16 v[52:55], a[184:187], a[100:103], v[52:55]
    v_mfma_f32_16x16x32_bf16 v[56:59], a[184:187], a[104:107], v[56:59]
    v_mfma_f32_16x16x32_bf16 v[60:63], a[184:187], a[108:111], v[60:63]
    s_waitcnt vmcnt(19)
    v_mfma_f32_16x16x32_bf16 v[48:51], a[188:191], a[112:115], v[48:51]
    buffer_load_dwordx4 a[184:187], v3, s[8:11], s16 offen offset:2048
    v_mfma_f32_16x16x32_bf16 v[52:55], a[188:191], a[116:119], v[52:55]
    v_mfma_f32_16x16x32_bf16 v[56:59], a[188:191], a[120:123], v[56:59]
    v_mfma_f32_16x16x32_bf16 v[60:63], a[188:191], a[124:127], v[60:63]
    s_waitcnt vmcnt(19)
    v_mfma_f32_16x16x32_bf16 v[48:51], a[192:195], a[128:131], v[48:51]
    buffer_load_dwordx4 a[188:191], v3, s[8:11], s16 offen offset:3072
    v_mfma_f32_16x16x32_bf16 v[52:55], a[192:195], a[132:135], v[52:55]
    v_mfma_f32_16x16x32_bf16 v[56:59], a[192:195], a[136:139], v[56:59]
    v_mfma_f32_16x16x32_bf16 v[60:63], a[192:195], a[140:143], v[60:63]
    s_waitcnt vmcnt(19)
    v_mfma_f32_16x16x32_bf16 v[48:51], a[196:199], a[144:147], v[48:51]
    buffer_load_dwordx4 a[192:195], v4, s[8:11], s16 offen offset:0
    s_add_u32 s16, s16, 9216
    v_mfma_f32_16x16x32_bf16 v[52:55], a[196:199], a[148:151], v[52:55]
    v_mfma_f32_16x16x32_bf16 v[56:59], a[196:199], a[152:155], v[56:59]
    v_mfma_f32_16x16x32_bf16 v[60:63], a[196:199], a[156:159], v[60:63]
    s_waitcnt vmcnt(18)
    v_mfma_f32_16x16x32_bf16 v[48:51], a[200:203], a[232:235], v[48:51]
    buffer_load_dwordx4 a[196:199], v2, s[8:11], s16 offen offset:0
    v_mfma_f32_16x16x32_bf16 v[52:55], a[200:203], a[236:239], v[52:55]
    v_mfma_f32_16x16x32_bf16 v[56:59], a[200:203], a[240:243], v[56:59]
    v_mfma_f32_16x16x32_bf16 v[60:63], a[200:203], a[244:247], v[60:63]
    s_waitcnt vmcnt(18)
    v_mfma_f32_16x16x32_bf16 v[48:51], a[204:207], a[248:251], v[48:51]
    buffer_load_dwordx4 a[200:203], v2, s[8:11], s16 offen offset:1024
    v_mfma_f32_16x16x32_bf16 v[52:55], a[204:207], a[252:255], v[52:55]
    v_mfma_f32_16x16x32_bf16 v[56:59], a[204:207], v[64:67], v[56:59]
    v_mfma_f32_16x16x32_bf16 v[60:63], a[204:207], v[68:71], v[60:63]
    s_waitcnt vmcnt(18)
    v_mfma_f32_16x16x32_bf16 v[48:51], a[208:211], v[72:75], v[48:51]
    buffer_load_dwordx4 a[204:207], v2, s[8:11], s16 offen offset:2048
    v_mfma_f32_16x16x32_bf16 v[52:55], a[208:211], v[76:79], v[52:55]
    v_mfma_f32_16x16x32_bf16 v[56:59], a[208:211], v[80:83], v[56:59]
    v_mfma_f32_16x16x32_bf16 v[60:63], a[208:211], v[84:87], v[60:63]
    s_waitcnt vmcnt(18)
    v_mfma_f32_16x16x32_bf16 v[48:51], a[212:215], v[88:91], v[48:51]
    buffer_load_dwordx4 a[208:211], v2, s[8:11], s16 offen offset:3072
    v_mfma_f32_16x16x32_bf16 v[52:55], a[212:215], v[92:95], v[52:55]
    buffer_load_dword v1, v5, s[12:15], s56 offen sc1
    v_mfma_f32_16x16x32_bf16 v[56:59], a[212:215], v[96:99], v[56:59]
    v_mfma_f32_16x16x32_bf16 v[60:63], a[212:215], v[100:103], v[60:63]
    s_waitcnt vmcnt(19)
    v_mfma_f32_16x16x32_bf16 v[48:51], a[216:219], v[104:107], v[48:51]
    buffer_load_dwordx4 a[212:215], v3, s[8:11], s16 offen offset:0
    v_mfma_f32_16x16x32_bf16 v[52:55], a[216:219], v[108:111], v[52:55]
    v_mfma_f32_16x16x32_bf16 v[56:59], a[216:219], v[112:115], v[56:59]
    v_mfma_f32_16x16x32_bf16 v[60:63], a[216:219], v[116:119], v[60:63]
    s_waitcnt vmcnt(19)
    v_mfma_f32_16x16x32_bf16 v[48:51], a[220:223], v[120:123], v[48:51]
    buffer_load_dwordx4 a[216:219], v3, s[8:11], s16 offen offset:1024
    v_mfma_f32_16x16x32_bf16 v[52:55], a[220:223], v[124:127], v[52:55]
    v_mfma_f32_16x16x32_bf16 v[56:59], a[220:223], v[128:131], v[56:59]
    v_mfma_f32_16x16x32_bf16 v[60:63], a[220:223], v[132:135], v[60:63]
    s_waitcnt vmcnt(19)
    v_mfma_f32_16x16x32_bf16 v[48:51], a[224:227], v[136:139], v[48:51]
    buffer_load_dwordx4 a[220:223], v3, s[8:11], s16 offen offset:2048
    v_mfma_f32_16x16x32_bf16 v[52:55], a[224:227], v[140:143], v[52:55]
    v_mfma_f32_16x16x32_bf16 v[56:59], a[224:227], v[144:147], v[56:59]
    v_mfma_f32_16x16x32_bf16 v[60:63], a[224:227], v[148:151], v[60:63]
    s_waitcnt vmcnt(19)
    v_mfma_f32_16x16x32_bf16 v[48:51], a[228:231], v[152:155], v[48:51]
    buffer_load_dwordx4 a[224:227], v3, s[8:11], s16 offen offset:3072
    v_mfma_f32_16x16x32_bf16 v[52:55], a[228:231], v[156:159], v[52:55]
    v_mfma_f32_16x16x32_bf16 v[56:59], a[228:231], v[160:163], v[56:59]
    v_mfma_f32_16x16x32_bf16 v[60:63], a[228:231], v[164:167], v[60:63]
    s_waitcnt vmcnt(4)
    v_cmp_ne_u32 vcc, s7, v1
    s_nop 4
    s_cbranch_vccz KB_pa_ok
    s_mov_b32 s60, 0
KB_pa:
    buffer_load_dword v1, v5, s[12:15], s56 offen sc1
KB_pa_w:
    s_add_u32 s60, s60, 1
    s_waitcnt vmcnt(0)
    v_cmpx_eq_u32 vcc, s7, v1
    s_nop 4
    s_cmp_eq_u64 exec, -1
    s_mov_b64 exec, -1
    s_cbranch_scc1 KB_pa_ok
    s_sleep 1
    s_cmp_lt_u32 s60, 0x8000
    s_cbranch_scc1 KB_pa
KB_pa_ok:
    s_barrier
    buffer_store_dword v243, v242, s[20:23], s57 offen offset:64 sc1
    s_waitcnt vmcnt(20)
    v_mfma_f32_16x16x32_bf16 v[32:35], a[160:163], a[0:3], 0
    buffer_load_dwordx4 a[228:231], v4, s[8:11], s16 offen offset:0
    s_add_u32 s16, s16, 9216
    s_cmp_eq_u32 s16, 340992
    s_cselect_b32 s16, 175104, s16
    v_mfma_f32_16x16x32_bf16 v[36:39], a[160:163], a[4:7], 0
    v_mfma_f32_16x16x32_bf16 v[40:43], a[160:163], a[8:11], 0
    v_mfma_f32_16x16x32_bf16 v[44:47], a[160:163], a[12:15], 0
    v_cvt_pk_bf16_f32 v244, v48, v49
    s_waitcnt vmcnt(20)
    v_mfma_f32_16x16x32_bf16 v[32:35], a[164:167], a[16:19], v[32:35]
    s_add_u32 s30, s24, 0
    buffer_load_dwordx4 a[160:163], v14, s[12:15], s30 offen offset:0 sc1
    v_mfma_f32_16x16x32_bf16 v[36:39], a[164:167], a[20:23], v[36:39]
    v_cvt_pk_bf16_f32 v245, v50, v51
    v_mfma_f32_16x16x32_bf16 v[40:43], a[164:167], a[24:27], v[40:43]
    v_cvt_pk_bf16_f32 v246, v52, v53
    v_mfma_f32_16x16x32_bf16 v[44:47], a[164:167], a[28:31], v[44:47]
    v_cvt_pk_bf16_f32 v247, v54, v55
    s_waitcnt vmcnt(19)
    v_mfma_f32_16x16x32_bf16 v[32:35], a[168:171], a[32:35], v[32:35]
    buffer_load_dwordx4 a[164:167], v14, s[12:15], s30 offen offset:2048 sc1
    v_mfma_f32_16x16x32_bf16 v[36:39], a[168:171], a[36:39], v[36:39]
    buffer_store_dwordx4 v[244:247], v20, s[12:15], s31 offen offset:0 sc1
    v_mfma_f32_16x16x32_bf16 v[40:43], a[168:171], a[40:43], v[40:43]
    v_cvt_pk_bf16_f32 v248, v56, v57
    v_mfma_f32_16x16x32_bf16 v[44:47], a[168:171], a[44:47], v[44:47]
    v_cvt_pk_bf16_f32 v249, v58, v59
    s_waitcnt vmcnt(19)
    v_mfma_f32_16x16x32_bf16 v[32:35], a[172:175], a[48:51], v[32:35]
    buffer_load_dwordx4 a[168:171], v15, s[12:15], s30 offen offset:0 sc1
    v_mfma_f32_16x16x32_bf16 v[36:39], a[172:175], a[52:55], v[36:39]
    v_cvt_pk_bf16_f32 v250, v60, v61
    v_mfma_f32_16x16x32_bf16 v[40:43], a[172:175], a[56:59], v[40:43]
    v_cvt_pk_bf16_f32 v251, v62, v63
    v_mfma_f32_16x16x32_bf16 v[44:47], a[172:175], a[60:63], v[44:47]
    buffer_store_dwordx4 v[248:251], v20, s[12:15], s31 offen offset:1024 sc1
    s_add_u32 s31, s31, 8192
    s_cmp_eq_u32 s31, s42
    s_cselect_b32 s31, s41, s31
    s_waitcnt vmcnt(20)
    v_mfma_f32_16x16x32_bf16 v[32:35], a[176:179], a[64:67], v[32:35]
    buffer_load_dwordx4 a[172:175], v15, s[12:15], s30 offen offset:2048 sc1
    v_mfma_f32_16x16x32_bf16 v[36:39], a[176:179], a[68:71], v[36:39]
    v_mfma_f32_16x16x32_bf16 v[40:43], a[176:179], a[72:75], v[40:43]
    v_mfma_f32_16x16x32_bf16 v[44:47], a[176:179], a[76:79], v[44:47]
    s_waitcnt vmcnt(20)
    v_mfma_f32_16x16x32_bf16 v[32:35], a[180:183], a[80:83], v[32:35]
    s_add_u32 s30, s24, 9437184
    buffer_load_dwordx4 a[176:179], v14, s[12:15], s30 offen offset:0 sc1
    v_mfma_f32_16x16x32_bf16 v[36:39], a[180:183], a[84:87], v[36:39]
    v_mfma_f32_16x16x32_bf16 v[40:43], a[180:183], a[88:91], v[40:43]
    v_mfma_f32_16x16x32_bf16 v[44:47], a[180:183], a[92:95], v[44:47]
    s_waitcnt vmcnt(20)
    v_mfma_f32_16x16x32_bf16 v[32:35], a[184:187], a[96:99], v[32:35]
    buffer_load_dwordx4 a[180:183], v14, s[12:15], s30 offen offset:2048 sc1
    v_mfma_f32_16x16x32_bf16 v[36:39], a[184:187], a[100:103], v[36:39]
    v_mfma_f32_16x16x32_bf16 v[40:43], a[184:187], a[104:107], v[40:43]
    v_mfma_f32_16x16x32_bf16 v[44:47], a[184:187], a[108:111], v[44:47]
    s_waitcnt vmcnt(20)
    v_mfma_f32_16x16x32_bf16 v[32:35], a[188:191], a[112:115], v[32:35]
    buffer_load_dwordx4 a[184:187], v15, s[12:15], s30 offen offset:0 sc1
    v_mfma_f32_16x16x32_bf16 v[36:39], a[188:191], a[116:119], v[36:39]
    v_mfma_f32_16x16x32_bf16 v[40:43], a[188:191], a[120:123], v[40:43]
    v_mfma_f32_16x16x32_bf16 v[44:47], a[188:191], a[124:127], v[44:47]
    s_waitcnt vmcnt(20)
    v_mfma_f32_16x16x32_bf16 v[32:35], a[192:195], a[128:131], v[32:35]
    buffer_load_dwordx4 a[188:191], v15, s[12:15], s30 offen offset:2048 sc1
    v_mfma_f32_16x16x32_bf16 v[36:39], a[192:195], a[132:135], v[36:39]
    v_mfma_f32_16x16x32_bf16 v[40:43], a[192:195], a[136:139], v[40:43]
    v_mfma_f32_16x16x32_bf16 v[44:47], a[192:195], a[140:143], v[44:47]
    s_waitcnt vmcnt(20)
    v_mfma_f32_16x16x32_bf16 v[32:35], a[196:199], a[144:147], v[32:35]
    s_add_u32 s30, s26, 0
    buffer_load_dwordx4 a[192:195], v240, s[12:15], s30 offen offset:0 sc1
    v_mfma_f32_16x16x32_bf16 v[36:39], a[196:199], a[148:151], v[36:39]
    v_mfma_f32_16x16x32_bf16 v[40:43], a[196:199], a[152:155], v[40:43]
    v_mfma_f32_16x16x32_bf16 v[44:47], a[196:199], a[156:159], v[44:47]
    s_waitcnt vmcnt(20)
    v_mfma_f32_16x16x32_bf16 v[32:35], a[200:203], a[232:235], v[32:35]
    buffer_load_dwordx4 a[196:199], v240, s[12:15], s30 offen offset:2048 sc1
    v_mfma_f32_16x16x32_bf16 v[36:39], a[200:203], a[236:239], v[36:39]
    v_mfma_f32_16x16x32_bf16 v[40:43], a[200:203], a[240:243], v[40:43]
    v_mfma_f32_16x16x32_bf16 v[44:47], a[200:203], a[244:247], v[44:47]
    s_waitcnt vmcnt(20)
    v_mfma_f32_16x16x32_bf16 v[32:35], a[204:207], a[248:251], v[32:35]
    buffer_load_dwordx4 a[200:203], v241, s[12:15], s30 offen offset:0 sc1
    v_mfma_f32_16x16x32_bf16 v[36:39], a[204:207], a[252:255], v[36:39]
    v_mfma_f32_16x16x32_bf16 v[40:43], a[204:207], v[64:67], v[40:43]
    v_mfma_f32_16x16x32_bf16 v[44:47], a[204:207], v[68:71], v[44:47]
    s_waitcnt vmcnt(20)
    v_mfma_f32_16x16x32_bf16 v[32:35], a[208:211], v[72:75], v[32:35]
    buffer_load_dwordx4 a[204:207], v241, s[12:15], s30 offen offset:2048 sc1
    v_mfma_f32_16x16x32_bf16 v[36:39], a[208:211], v[76:79], v[36:39]
    v_mfma_f32_16x16x32_bf16 v[40:43], a[208:211], v[80:83], v[40:43]
    v_mfma_f32_16x16x32_bf16 v[44:47], a[208:211], v[84:87], v[44:47]
    s_waitcnt vmcnt(19)
    v_mfma_f32_16x16x32_bf16 v[32:35], a[212:215], v[88:91], v[32:35]
    s_add_u32 s30, s26, 9437184
    buffer_load_dwordx4 a[208:211], v240, s[12:15], s30 offen offset:0 sc1
    v_mfma_f32_16x16x32_bf16 v[36:39], a[212:215], v[92:95], v[36:39]
    v_mfma_f32_16x16x32_bf16 v[40:43], a[212:215], v[96:99], v[40:43]
    v_mfma_f32_16x16x32_bf16 v[44:47], a[212:215], v[100:103], v[44:47]
    s_waitcnt vmcnt(19)
    v_mfma_f32_16x16x32_bf16 v[32:35], a[216:219], v[104:107], v[32:35]
    buffer_load_dwordx4 a[212:215], v240, s[12:15], s30 offen offset:2048 sc1
    v_mfma_f32_16x16x32_bf16 v[36:39], a[216:219], v[108:111], v[36:39]
    v_mfma_f32_16x16x32_bf16 v[40:43], a[216:219], v[112:115], v[40:43]
    v_mfma_f32_16x16x32_bf16 v[44:47], a[216:219], v[116:119], v[44:47]
    s_waitcnt vmcnt(19)
    v_mfma_f32_16x16x32_bf16 v[32:35], a[220:223], v[120:123], v[32:35]
    buffer_load_dwordx4 a[216:219], v241, s[12:15], s30 offen offset:0 sc1
    v_mfma_f32_16x16x32_bf16 v[36:39], a[220:223], v[124:127], v[36:39]
    v_mfma_f32_16x16x32_bf16 v[40:43], a[220:223], v[128:131], v[40:43]
    v_mfma_f32_16x16x32_bf16 v[44:47], a[220:223], v[132:135], v[44:47]
    s_waitcnt vmcnt(19)
    v_mfma_f32_16x16x32_bf16 v[32:35], a[224:227], v[136:139], v[32:35]
    buffer_load_dwordx4 a[220:223], v241, s[12:15], s30 offen offset:2048 sc1
    v_mfma_f32_16x16x32_bf16 v[36:39], a[224:227], v[140:143], v[36:39]
    v_mfma_f32_16x16x32_bf16 v[40:43], a[224:227], v[144:147], v[40:43]
    v_mfma_f32_16x16x32_bf16 v[44:47], a[224:227], v[148:151], v[44:47]
    s_waitcnt vmcnt(18)
    v_mfma_f32_16x16x32_bf16 v[32:35], a[228:231], v[152:155], v[32:35]
    buffer_load_dword v1, v5, s[12:15], s56 offen offset:64 sc1
    v_mfma_f32_16x16x32_bf16 v[36:39], a[228:231], v[156:159], v[36:39]
    v_mfma_f32_16x16x32_bf16 v[40:43], a[228:231], v[160:163], v[40:43]
    v_mfma_f32_16x16x32_bf16 v[44:47], a[228:231], v[164:167], v[44:47]
    s_nop 3
    v_cvt_pk_bf16_f32 v244, v32, v33
    v_cvt_pk_bf16_f32 v245, v34, v35
    v_cvt_pk_bf16_f32 v246, v36, v37
    v_cvt_pk_bf16_f32 v247, v38, v39
    buffer_store_dwordx4 v[244:247], v20, s[12:15], s31 offen offset:0 sc1
    v_cvt_pk_bf16_f32 v248, v40, v41
    v_cvt_pk_bf16_f32 v249, v42, v43
    v_cvt_pk_bf16_f32 v250, v44, v45
    v_cvt_pk_bf16_f32 v251, v46, v47
    buffer_store_dwordx4 v[248:251], v20, s[12:15], s31 offen offset:1024 sc1
    s_add_u32 s31, s31, 8192
    s_cmp_eq_u32 s31, s42
    s_cselect_b32 s31, s41, s31
    s_add_u32 s8, s46, 0
    s_addc_u32 s9, s47, 0
    s_mov_b32 s10, 2359296
    s_mov_b32 s11, 0x20000
    s_mov_b32 s60, 0
    s_waitcnt vmcnt(2)
    v_mfma_f32_16x16x32_bf16 v[64:67], v[24:27], a[160:163], 0
    v_mfma_f32_16x16x32_bf16 v[80:83], v[28:31], a[160:163], 0
    v_mfma_f32_16x16x32_bf16 v[68:71], v[24:27], a[164:167], 0
    v_mfma_f32_16x16x32_bf16 v[84:87], v[28:31], a[164:167], 0
    v_mfma_f32_16x16x32_bf16 v[72:75], v[24:27], a[168:171], 0
    v_mfma_f32_16x16x32_bf16 v[88:91], v[28:31], a[168:171], 0
    v_mfma_f32_16x16x32_bf16 v[76:79], v[24:27], a[172:175], 0
    v_mfma_f32_16x16x32_bf16 v[92:95], v[28:31], a[172:175], 0
    v_mfma_f32_16x16x32_bf16 v[64:67], v[24:27], a[176:179], v[64:67]
    v_mfma_f32_16x16x32_bf16 v[80:83], v[28:31], a[176:179], v[80:83]
    v_mfma_f32_16x16x32_bf16 v[68:71], v[24:27], a[180:183], v[68:71]
    v_mfma_f32_16x16x32_bf16 v[84:87], v[28:31], a[180:183], v[84:87]
    v_mfma_f32_16x16x32_bf16 v[72:75], v[24:27], a[184:187], v[72:75]
    v_mfma_f32_16x16x32_bf16 v[88:91], v[28:31], a[184:187], v[88:91]
    v_mfma_f32_16x16x32_bf16 v[76:79], v[24:27], a[188:191], v[76:79]
    v_mfma_f32_16x16x32_bf16 v[92:95], v[28:31], a[188:191], v[92:95]
    s_nop 7
    v_permlane32_swap_b32 v64, v80
    v_permlane32_swap_b32 v65, v81
    v_permlane32_swap_b32 v66, v82
    v_permlane32_swap_b32 v67, v83
    v_permlane32_swap_b32 v68, v84
    v_permlane32_swap_b32 v69, v85
    v_permlane32_swap_b32 v70, v86
    v_permlane32_swap_b32 v71, v87
    v_permlane32_swap_b32 v72, v88
    v_permlane32_swap_b32 v73, v89
    v_permlane32_swap_b32 v74, v90
    v_permlane32_swap_b32 v75, v91
    v_permlane32_swap_b32 v76, v92
    v_permlane32_swap_b32 v77, v93
    v_permlane32_swap_b32 v78, v94
    v_permlane32_swap_b32 v79, v95
    v_add_f32 v64, v64, v80
    v_add_f32 v65, v65, v81
    v_add_f32 v66, v66, v82
    v_add_f32 v67, v67, v83
    v_add_f32 v68, v68, v84
    v_add_f32 v69, v69, v85
    v_add_f32 v70, v70, v86
    v_add_f32 v71, v71, v87
    v_add_f32 v72, v72, v88
    v_add_f32 v73, v73, v89
    v_add_f32 v74, v74, v90
    v_add_f32 v75, v75, v91
    v_add_f32 v76, v76, v92
    v_add_f32 v77, v77, v93
    v_add_f32 v78, v78, v94
    v_add_f32 v79, v79, v95
    v_permlane16_swap_b32 v64, v66
    v_permlane16_swap_b32 v65, v67
    v_permlane16_swap_b32 v68, v70
    v_permlane16_swap_b32 v69, v71
    v_permlane16_swap_b32 v72, v74
    v_permlane16_swap_b32 v73, v75
    v_permlane16_swap_b32 v76, v78
    v_permlane16_swap_b32 v77, v79
    v_add_f32 v80, v64, v66
    v_add_f32 v81, v68, v70
    v_add_f32 v82, v72, v74
    v_add_f32 v83, v76, v78
    v_add_f32 v84, v65, v67
    v_add_f32 v85, v69, v71
    v_add_f32 v86, v73, v75
    v_add_f32 v87, v77, v79
    v_mul_f32 v80, v23, v80
    v_mul_f32 v81, v23, v81
    v_mul_f32 v82, v23, v82
    v_mul_f32 v83, v23, v83
    v_mul_f32 v84, v23, v84
    v_mul_f32 v85, v23, v85
    v_mul_f32 v86, v23, v86
    v_mul_f32 v87, v23, v87
    v_cvt_pk_bf16_f32 v81, v80, v81
    v_cvt_pk_bf16_f32 v83, v82, v83
    v_cvt_pk_bf16_f32 v85, v84, v85
    v_cvt_pk_bf16_f32 v87, v86, v87
    v_lshlrev_b32 v80, 16, v81
    v_and_b32 v81, 0xffff0000, v81
    v_lshlrev_b32 v82, 16, v83
    v_and_b32 v83, 0xffff0000, v83
    v_lshlrev_b32 v84, 16, v85
    v_and_b32 v85, 0xffff0000, v85
    v_lshlrev_b32 v86, 16, v87
    v_and_b32 v87, 0xffff0000, v87
    v_mul_f32 v80, v192, v80
    v_mul_f32 v81, v193, v81
    v_mul_f32 v82, v194, v82
    v_mul_f32 v83, v195, v83
    v_mul_f32 v84, v196, v84
    v_mul_f32 v85, v197, v85
    v_mul_f32 v86, v198, v86
    v_mul_f32 v87, v199, v87
    v_cvt_pk_bf16_f32 v81, v80, v81
    v_cvt_pk_bf16_f32 v83, v82, v83
    v_cvt_pk_bf16_f32 v85, v84, v85
    v_cvt_pk_bf16_f32 v87, v86, v87
    v_lshlrev_b32 v80, 16, v81
    v_and_b32 v81, 0xffff0000, v81
    v_lshlrev_b32 v82, 16, v83
    v_and_b32 v83, 0xffff0000, v83
    v_lshlrev_b32 v84, 16, v85
    v_and_b32 v85, 0xffff0000, v85
    v_lshlrev_b32 v86, 16, v87
    v_and_b32 v87, 0xffff0000, v87
    v_add_f32 v80, v168, v80
    v_add_f32 v81, v169, v81
    v_add_f32 v82, v170, v82
    v_add_f32 v83, v171, v83
    v_add_f32 v84, v172, v84
    v_add_f32 v85, v173, v85
    v_add_f32 v86, v174, v86
    v_add_f32 v87, v175, v87
    v_cvt_pk_bf16_f32 v64, v80, v81
    v_cvt_pk_bf16_f32 v65, v82, v83
    v_cvt_pk_bf16_f32 v66, v84, v85
    v_cvt_pk_bf16_f32 v67, v86, v87
    buffer_store_dwordx4 v[64:67], v13, s[8:11], s27 offen sc1
    s_cmp_eq_u32 s6, 0
    s_cbranch_scc0 KB_j3
    v_mfma_f32_16x16x32_bf16 v[128:131], v[24:27], a[192:195], 0
    v_mfma_f32_16x16x32_bf16 v[144:147], v[28:31], a[192:195], 0
    v_mfma_f32_16x16x32_bf16 v[132:135], v[24:27], a[196:199], 0
    v_mfma_f32_16x16x32_bf16 v[148:151], v[28:31], a[196:199], 0
    v_mfma_f32_16x16x32_bf16 v[136:139], v[24:27], a[200:203], 0
    v_mfma_f32_16x16x32_bf16 v[152:155], v[28:31], a[200:203], 0
    v_mfma_f32_16x16x32_bf16 v[140:143], v[24:27], a[204:207], 0
    v_mfma_f32_16x16x32_bf16 v[156:159], v[28:31], a[204:207], 0
    v_mfma_f32_16x16x32_bf16 v[128:131], v[24:27], a[208:211], v[128:131]
    v_mfma_f32_16x16x32_bf16 v[144:147], v[28:31], a[208:211], v[144:147]
    v_mfma_f32_16x16x32_bf16 v[132:135], v[24:27], a[212:215], v[132:135]
    v_mfma_f32_16x16x32_bf16 v[148:151], v[28:31], a[212:215], v[148:151]
    v_mfma_f32_16x16x32_bf16 v[136:139], v[24:27], a[216:219], v[136:139]
    v_mfma_f32_16x16x32_bf16 v[152:155], v[28:31], a[216:219], v[152:155]
    v_mfma_f32_16x16x32_bf16 v[140:143], v[24:27], a[220:223], v[140:143]
    v_mfma_f32_16x16x32_bf16 v[156:159], v[28:31], a[220:223], v[156:159]
    s_nop 7
    v_permlane32_swap_b32 v128, v144
    v_permlane32_swap_b32 v129, v145
    v_permlane32_swap_b32 v130, v146
    v_permlane32_swap_b32 v131, v147
    v_permlane32_swap_b32 v132, v148
    v_permlane32_swap_b32 v133, v149
    v_permlane32_swap_b32 v134, v150
    v_permlane32_swap_b32 v135, v151
    v_permlane32_swap_b32 v136, v152
    v_permlane32_swap_b32 v137, v153
    v_permlane32_swap_b32 v138, v154
    v_permlane32_swap_b32 v139, v155
    v_permlane32_swap_b32 v140, v156
    v_permlane32_swap_b32 v141, v157
    v_permlane32_swap_b32 v142, v158
    v_permlane32_swap_b32 v143, v159
    v_add_f32 v128, v128, v144
    v_add_f32 v129, v129, v145
    v_add_f32 v130, v130, v146
    v_add_f32 v131, v131, v147
    v_add_f32 v132, v132, v148
    v_add_f32 v133, v133, v149
    v_add_f32 v134, v134, v150
    v_add_f32 v135, v135, v151
    v_add_f32 v136, v136, v152
    v_add_f32 v137, v137, v153
    v_add_f32 v138, v138, v154
    v_add_f32 v139, v139, v155
    v_add_f32 v140, v140, v156
    v_add_f32 v141, v141, v157
    v_add_f32 v142, v142, v158
    v_add_f32 v143, v143, v159
    v_permlane16_swap_b32 v128, v130
    v_permlane16_swap_b32 v129, v131
    v_permlane16_swap_b32 v132, v134
    v_permlane16_swap_b32 v133, v135
    v_permlane16_swap_b32 v136, v138
    v_permlane16_swap_b32 v137, v139
    v_permlane16_swap_b32 v140, v142
    v_permlane16_swap_b32 v141, v143
    v_add_f32 v144, v128, v130
    v_add_f32 v145, v132, v134
    v_add_f32 v146, v136, v138
    v_add_f32 v147, v140, v142
    v_add_f32 v148, v129, v131
    v_add_f32 v149, v133, v135
    v_add_f32 v150, v137, v139
    v_add_f32 v151, v141, v143
    v_mul_f32 v144, v23, v144
    v_mul_f32 v145, v23, v145
    v_mul_f32 v146, v23, v146
    v_mul_f32 v147, v23, v147
    v_mul_f32 v148, v23, v148
    v_mul_f32 v149, v23, v149
    v_mul_f32 v150, v23, v150
    v_mul_f32 v151, v23, v151
    v_cvt_pk_bf16_f32 v145, v144, v145
    v_cvt_pk_bf16_f32 v147, v146, v147
    v_cvt_pk_bf16_f32 v149, v148, v149
    v_cvt_pk_bf16_f32 v151, v150, v151
    v_lshlrev_b32 v144, 16, v145
    v_and_b32 v145, 0xffff0000, v145
    v_lshlrev_b32 v146, 16, v147
    v_and_b32 v147, 0xffff0000, v147
    v_lshlrev_b32 v148, 16, v149
    v_and_b32 v149, 0xffff0000, v149
    v_lshlrev_b32 v150, 16, v151
    v_and_b32 v151, 0xffff0000, v151
    v_mul_f32 v144, v208, v144
    v_mul_f32 v145, v209, v145
    v_mul_f32 v146, v210, v146
    v_mul_f32 v147, v211, v147
    v_mul_f32 v148, v212, v148
    v_mul_f32 v149, v213, v149
    v_mul_f32 v150, v214, v150
    v_mul_f32 v151, v215, v151
    v_cvt_pk_bf16_f32 v145, v144, v145
    v_cvt_pk_bf16_f32 v147, v146, v147
    v_cvt_pk_bf16_f32 v149, v148, v149
    v_cvt_pk_bf16_f32 v151, v150, v151
    v_lshlrev_b32 v144, 16, v145
    v_and_b32 v145, 0xffff0000, v145
    v_lshlrev_b32 v146, 16, v147
    v_and_b32 v147, 0xffff0000, v147
    v_lshlrev_b32 v148, 16, v149
    v_and_b32 v149, 0xffff0000, v149
    v_lshlrev_b32 v150, 16, v151
    v_and_b32 v151, 0xffff0000, v151
    v_add_f32 v144, v184, v144
    v_add_f32 v145, v185, v145
    v_add_f32 v146, v186, v146
    v_add_f32 v147, v187, v147
    v_add_f32 v148, v188, v148
    v_add_f32 v149, v189, v149
    v_add_f32 v150, v190, v150
    v_add_f32 v151, v191, v151
    v_cvt_pk_bf16_f32 v128, v144, v145
    v_cvt_pk_bf16_f32 v129, v146, v147
    v_cvt_pk_bf16_f32 v130, v148, v149
    v_cvt_pk_bf16_f32 v131, v150, v151
    buffer_store_dwordx4 v[128:131], v13, s[8:11], s29 offen sc1
KB_j3:
    v_cmp_ne_u32 vcc, s7, v1
    s_nop 4
    s_cbranch_vccz KB_pb_ok
    s_mov_b32 s60, 0
KB_pb:
    buffer_load_dword v1, v5, s[12:15], s56 offen offset:64 sc1
KB_pb_w:
    s_add_u32 s60, s60, 1
    s_waitcnt vmcnt(0)
    v_cmpx_eq_u32 vcc, s7, v1
    s_nop 4
    s_cmp_eq_u64 exec, -1
    s_mov_b64 exec, -1
    s_cbranch_scc1 KB_pb_ok
    s_sleep 1
    s_cmp_lt_u32 s60, 0x8000
    s_cbranch_scc1 KB_pb
KB_pb_ok:
    s_mov_b32 s60, 0
KB_pl:
    s_add_u32 s30, s25, 0
    buffer_load_dwordx4 v[32:35], v14, s[12:15], s30 offen offset:0 sc1
    buffer_load_dwordx4 v[36:39], v14, s[12:15], s30 offen offset:2048 sc1
    buffer_load_dwordx4 v[40:43], v15, s[12:15], s30 offen offset:0 sc1
    buffer_load_dwordx4 v[44:47], v15, s[12:15], s30 offen offset:2048 sc1
    s_add_u32 s30, s25, 9437184
    buffer_load_dwordx4 v[48:51], v14, s[12:15], s30 offen offset:0 sc1
    buffer_load_dwordx4 v[52:55], v14, s[12:15], s30 offen offset:2048 sc1
    buffer_load_dwordx4 v[56:59], v15, s[12:15], s30 offen offset:0 sc1
    buffer_load_dwordx4 v[60:63], v15, s[12:15], s30 offen offset:2048 sc1
KB_pw:
    s_add_u32 s60, s60, 1
    s_waitcnt vmcnt(7)
    v_max3_u32 v5, v32, v33, v34
    v_mov_b32 v7, v35
    s_waitcnt vmcnt(6)
    v_max3_u32 v6, v36, v37, v38
    v_mov_b32 v8, v39
    s_waitcnt vmcnt(5)
    v_max3_u32 v5, v40, v41, v5
    v_max3_u32 v7, v42, v43, v7
    s_waitcnt vmcnt(4)
    v_max3_u32 v6, v44, v45, v6
    v_max3_u32 v8, v46, v47, v8
    s_waitcnt vmcnt(3)
    v_max3_u32 v5, v48, v49, v5
    v_max3_u32 v7, v50, v51, v7
    s_waitcnt vmcnt(2)
    v_max3_u32 v6, v52, v53, v6
    v_max3_u32 v8, v54, v55, v8
    s_waitcnt vmcnt(1)
    v_max3_u32 v5, v56, v57, v5
    v_max3_u32 v7, v58, v59, v7
    s_waitcnt vmcnt(0)
    v_max3_u32 v6, v60, v61, v6
    v_max3_u32 v8, v62, v63, v8
    v_max3_u32 v5, v5, v6, v7
    v_max_u32 v5, v5, v8
    v_cmp_eq_u32 vcc, -1, v5
    s_nop 4
    s_cbranch_vccz KB_pk
    s_cmp_lt_u32 s60, 0x8000
    s_cbranch_scc1 KB_pl
KB_pk:
    v_mfma_f32_16x16x32_bf16 v[96:99], v[24:27], v[32:35], 0
    v_mfma_f32_16x16x32_bf16 v[112:115], v[28:31], v[32:35], 0
    v_mfma_f32_16x16x32_bf16 v[100:103], v[24:27], v[36:39], 0
    v_mfma_f32_16x16x32_bf16 v[116:119], v[28:31], v[36:39], 0
    v_mfma_f32_16x16x32_bf16 v[104:107], v[24:27], v[40:43], 0
    v_mfma_f32_16x16x32_bf16 v[120:123], v[28:31], v[40:43], 0
    v_mfma_f32_16x16x32_bf16 v[108:111], v[24:27], v[44:47], 0
    v_mfma_f32_16x16x32_bf16 v[124:127], v[28:31], v[44:47], 0
    v_mfma_f32_16x16x32_bf16 v[96:99], v[24:27], v[48:51], v[96:99]
    v_mfma_f32_16x16x32_bf16 v[112:115], v[28:31], v[48:51], v[112:115]
    v_mfma_f32_16x16x32_bf16 v[100:103], v[24:27], v[52:55], v[100:103]
    v_mfma_f32_16x16x32_bf16 v[116:119], v[28:31], v[52:55], v[116:119]
    v_mfma_f32_16x16x32_bf16 v[104:107], v[24:27], v[56:59], v[104:107]
    v_mfma_f32_16x16x32_bf16 v[120:123], v[28:31], v[56:59], v[120:123]
    v_mfma_f32_16x16x32_bf16 v[108:111], v[24:27], v[60:63], v[108:111]
    v_mfma_f32_16x16x32_bf16 v[124:127], v[28:31], v[60:63], v[124:127]
    s_nop 7
    v_permlane32_swap_b32 v96, v112
    v_permlane32_swap_b32 v97, v113
    v_permlane32_swap_b32 v98, v114
    v_permlane32_swap_b32 v99, v115
    v_permlane32_swap_b32 v100, v116
    v_permlane32_swap_b32 v101, v117
    v_permlane32_swap_b32 v102, v118
    v_permlane32_swap_b32 v103, v119
    v_permlane32_swap_b32 v104, v120
    v_permlane32_swap_b32 v105, v121
    v_permlane32_swap_b32 v106, v122
    v_permlane32_swap_b32 v107, v123
    v_permlane32_swap_b32 v108, v124
    v_permlane32_swap_b32 v109, v125
    v_permlane32_swap_b32 v110, v126
    v_permlane32_swap_b32 v111, v127
    v_add_f32 v96, v96, v112
    v_add_f32 v97, v97, v113
    v_add_f32 v98, v98, v114
    v_add_f32 v99, v99, v115
    v_add_f32 v100, v100, v116
    v_add_f32 v101, v101, v117
    v_add_f32 v102, v102, v118
    v_add_f32 v103, v103, v119
    v_add_f32 v104, v104, v120
    v_add_f32 v105, v105, v121
    v_add_f32 v106, v106, v122
    v_add_f32 v107, v107, v123
    v_add_f32 v108, v108, v124
    v_add_f32 v109, v109, v125
    v_add_f32 v110, v110, v126
    v_add_f32 v111, v111, v127
    v_permlane16_swap_b32 v96, v98
    v_permlane16_swap_b32 v97, v99
    v_permlane16_swap_b32 v100, v102
    v_permlane16_swap_b32 v101, v103
    v_permlane16_swap_b32 v104, v106
    v_permlane16_swap_b32 v105, v107
    v_permlane16_swap_b32 v108, v110
    v_permlane16_swap_b32 v109, v111
    v_add_f32 v112, v96, v98
    v_add_f32 v113, v100, v102
    v_add_f32 v114, v104, v106
    v_add_f32 v115, v108, v110
    v_add_f32 v116, v97, v99
    v_add_f32 v117, v101, v103
    v_add_f32 v118, v105, v107
    v_add_f32 v119, v109, v111
    v_mul_f32 v112, v23, v112
    v_mul_f32 v113, v23, v113
    v_mul_f32 v114, v23, v114
    v_mul_f32 v115, v23, v115
    v_mul_f32 v116, v23, v116
    v_mul_f32 v117, v23, v117
    v_mul_f32 v118, v23, v118
    v_mul_f32 v119, v23, v119
    v_cvt_pk_bf16_f32 v113, v112, v113
    v_cvt_pk_bf16_f32 v115, v114, v115
    v_cvt_pk_bf16_f32 v117, v116, v117
    v_cvt_pk_bf16_f32 v119, v118, v119
    v_lshlrev_b32 v112, 16, v113
    v_and_b32 v113, 0xffff0000, v113
    v_lshlrev_b32 v114, 16, v115
    v_and_b32 v115, 0xffff0000, v115
    v_lshlrev_b32 v116, 16, v117
    v_and_b32 v117, 0xffff0000, v117
    v_lshlrev_b32 v118, 16, v119
    v_and_b32 v119, 0xffff0000, v119
    v_mul_f32 v112, v200, v112
    v_mul_f32 v113, v201, v113
    v_mul_f32 v114, v202, v114
    v_mul_f32 v115, v203, v115
    v_mul_f32 v116, v204, v116
    v_mul_f32 v117, v205, v117
    v_mul_f32 v118, v206, v118
    v_mul_f32 v119, v207, v119
    v_cvt_pk_bf16_f32 v113, v112, v113
    v_cvt_pk_bf16_f32 v115, v114, v115
    v_cvt_pk_bf16_f32 v117, v116, v117
    v_cvt_pk_bf16_f32 v119, v118, v119
    v_lshlrev_b32 v112, 16, v113
    v_and_b32 v113, 0xffff0000, v113
    v_lshlrev_b32 v114, 16, v115
    v_and_b32 v115, 0xffff0000, v115
    v_lshlrev_b32 v116, 16, v117
    v_and_b32 v117, 0xffff0000, v117
    v_lshlrev_b32 v118, 16, v119
    v_and_b32 v119, 0xffff0000, v119
    v_add_f32 v112, v176, v112
    v_add_f32 v113, v177, v113
    v_add_f32 v114, v178, v114
    v_add_f32 v115, v179, v115
    v_add_f32 v116, v180, v116
    v_add_f32 v117, v181, v117
    v_add_f32 v118, v182, v118
    v_add_f32 v119, v183, v119
    v_cvt_pk_bf16_f32 v96, v112, v113
    v_cvt_pk_bf16_f32 v97, v114, v115
    v_cvt_pk_bf16_f32 v98, v116, v117
    v_cvt_pk_bf16_f32 v99, v118, v119
    buffer_store_dwordx4 v[96:99], v13, s[8:11], s28 offen sc1
KB_done:
    s_endpgm
.section .rodata,"a"
.p2align 6
.amdhsa_kernel kb_kernel
  .amdhsa_next_free_vgpr 512
  .amdhsa_next_free_sgpr 102
  .amdhsa_accum_offset 256
  .amdhsa_group_segment_fixed_size 0
  .amdhsa_kernarg_size 120
  .amdhsa_user_sgpr_count 2
  .amdhsa_user_sgpr_kernarg_segment_ptr 1
  .amdhsa_system_sgpr_workgroup_id_x 1
  .amdhsa_float_denorm_mode_32 3
.end_amdhsa_kernel
.text
CODE_END:
    s_endpgm
```
